```python
import torch

def _softmax(x, axis=-1):
    return torch.softmax(x, dim=axis)
def _gelu(x):
    return torch.nn.functional.gelu(x, approximate="tanh")
def _silu(x):
    return torch.nn.functional.silu(x)
def _sigmoid(x):
    return torch.sigmoid(x)
def _layernorm(x, axis=-1, eps=1e-5):
    m = x.mean(dim=axis, keepdim=True)
    v = x.var(dim=axis, keepdim=True, unbiased=False)
    return (x - m) / torch.sqrt(v + eps)
def _scatter_add(tgt, idx, src, axis=0):
    return tgt.clone().index_add_(axis, idx, src)
def _segment_sum(src, seg, n):
    out = torch.zeros((n,) + src.shape[1:], dtype=src.dtype)
    return out.index_add_(0, seg, src)
def _pad(x, pw):
    flat = tuple(v for pair in reversed(pw) for v in pair)
    return torch.nn.functional.pad(x, flat)

kernel_name = 'concat_heads__gqa_block_cached__gqa_block_cached__near_ridge'

def setup_inputs():

    _w = (lambda a: (lambda t: t.to(torch.bfloat16) if t.is_floating_point() else t)(torch.as_tensor(a)))
    def _A_setup():
        B, Sq, D = 8, 80, 448
        Hq, Hkv, Sk, Dh = 16, 8, 1024, 256
        assert Hq % Hkv == 0, (Hq, Hkv)
        return {
            "x": _w((lambda *s: torch.randn(*s, dtype=torch.bfloat16) * 0.8)(B, Sq, D)),
            "k_cache": _w((lambda *s: torch.randn(*s, dtype=torch.bfloat16) * 0.8)(B, Hkv, Sk, Dh)),
            "v_cache": _w((lambda *s: torch.randn(*s, dtype=torch.bfloat16) * 0.05)(B, Hkv, Sk, Dh)),
            "wq": _w((lambda *s: torch.randn(*s, dtype=torch.bfloat16) * 0.8)(D, Hq * Dh) * (D ** -0.5)),
            "wo": _w((lambda *s: torch.randn(*s, dtype=torch.bfloat16) * 0.05)(Hq * Dh, D) * ((Hq * Dh) ** -0.5)),
        }
    _A_in = _A_setup()

    def _B_setup():
        B, Sq, D = 8, 80, 448
        Hq, Hkv, Sk, Dh = 16, 8, 1024, 256
        assert Hq % Hkv == 0, (Hq, Hkv)
        return {
            "x": _w((lambda *s: torch.randn(*s, dtype=torch.bfloat16) * 0.8)(B, Sq, D)),
            "k_cache": _w((lambda *s: torch.randn(*s, dtype=torch.bfloat16) * 0.8)(B, Hkv, Sk, Dh)),
            "v_cache": _w((lambda *s: torch.randn(*s, dtype=torch.bfloat16) * 0.05)(B, Hkv, Sk, Dh)),
            "wq": _w((lambda *s: torch.randn(*s, dtype=torch.bfloat16) * 0.8)(D, Hq * Dh) * (D ** -0.5)),
            "wo": _w((lambda *s: torch.randn(*s, dtype=torch.bfloat16) * 0.05)(Hq * Dh, D) * ((Hq * Dh) ** -0.5)),
        }
    _B_in = _B_setup()

    return {
        "A_x": _A_in["x"],
        "A_k_cache": _A_in["k_cache"],
        "A_v_cache": _A_in["v_cache"],
        "A_wq": _A_in["wq"],
        "A_wo": _A_in["wo"],
        "B_x": _B_in["x"],
        "B_k_cache": _B_in["k_cache"],
        "B_v_cache": _B_in["v_cache"],
        "B_wq": _B_in["wq"],
        "B_wo": _B_in["wo"],
    }

def reference(A_x, A_k_cache, A_v_cache, A_wq, A_wo, B_x, B_k_cache, B_v_cache, B_wq, B_wo):
    def _A_ref(x, k_cache, v_cache, wq, wo):
        B, Sq, D = x.shape
        Hq, Dh = 16, 256
        Hkv = k_cache.shape[1]
        rep = Hq // Hkv
        q = (lambda x, *d: x.permute(*d))((x @ wq).reshape(B, Sq, Hq, Dh), 0, 2, 1, 3)
        k = (lambda x, n, axis: torch.repeat_interleave(x, n, dim=axis))(k_cache, rep, axis=1)
        v = (lambda x, n, axis: torch.repeat_interleave(x, n, dim=axis))(v_cache, rep, axis=1)
        scores = torch.einsum("bhqd,bhkd->bhqk", q, k) * (Dh ** -0.5)
        p = _softmax(scores, axis=-1)
        o = torch.einsum("bhqk,bhkd->bhqd", p, v)
        return (lambda x, *d: x.permute(*d))(o, 0, 2, 1, 3).reshape(B, Sq, Hq * Dh) @ wo

    def _B_ref(x, k_cache, v_cache, wq, wo):
        B, Sq, D = x.shape
        Hq, Dh = 16, 256
        Hkv = k_cache.shape[1]
        rep = Hq // Hkv
        q = (lambda x, *d: x.permute(*d))((x @ wq).reshape(B, Sq, Hq, Dh), 0, 2, 1, 3)
        k = (lambda x, n, axis: torch.repeat_interleave(x, n, dim=axis))(k_cache, rep, axis=1)
        v = (lambda x, n, axis: torch.repeat_interleave(x, n, dim=axis))(v_cache, rep, axis=1)
        scores = torch.einsum("bhqd,bhkd->bhqk", q, k) * (Dh ** -0.5)
        p = _softmax(scores, axis=-1)
        o = torch.einsum("bhqk,bhkd->bhqd", p, v)
        return (lambda x, *d: x.permute(*d))(o, 0, 2, 1, 3).reshape(B, Sq, Hq * Dh) @ wo

    a = _A_ref(A_x, A_k_cache, A_v_cache, A_wq, A_wo)
    b = _B_ref(B_x, B_k_cache, B_v_cache, B_wq, B_wo)
    return torch.concatenate([a, b], axis=-1)
```

```asm
; @launch grid=(256,1,1) block=(768,1,1) lds=163840
.amdgcn_target "amdgcn-amd-amdhsa--gfx950"
.text
.globl concat_heads__gqa_block_cached__gqa_block_cached__near_ridge_kernel
.p2align 8
.type concat_heads__gqa_block_cached__gqa_block_cached__near_ridge_kernel,@function
concat_heads__gqa_block_cached__gqa_block_cached__near_ridge_kernel:
  s_cmp_ge_u32 s2, 256
  s_cbranch_scc1 L_end
  s_and_b32 s3, s2, 7
  s_lshr_b32 s4, s2, 3
  s_and_b32 s5, s4, 1
  s_lshr_b32 s6, s4, 1
  s_and_b32 s6, s6, 7
  s_lshr_b32 s7, s4, 4
  s_mul_i32 s9, s7, 40
  s_add_u32 s10, s0, s9
  s_addc_u32 s11, s1, 0
  s_load_dwordx8 s[12:19], s[10:11], 0
  s_load_dwordx2 s[20:21], s[10:11], 32
  s_load_dwordx4 s[56:59], s[0:1], 80
  s_load_dwordx2 s[22:23], s[0:1], 96
  v_lshrrev_b32 v1, 6, v0
  v_and_b32 v0, 63, v0
  v_readfirstlane_b32 s24, v1
  s_lshl_b32 s8, s3, 1
  s_add_u32 s8, s8, s5
  s_cmp_eq_u32 s6, 7
  s_cselect_b32 s29, 0, s6
  s_cmp_ge_u32 s24, 10
  s_cbranch_scc1 L_loader
  s_cmp_ge_u32 s24, 5
  s_cselect_b32 s26, 1, 0
  s_mul_i32 s27, s26, 5
  s_sub_u32 s25, s24, s27
  v_and_b32 v10, 15, v0
  v_lshrrev_b32 v11, 4, v0
  v_lshlrev_b32 v5, 4, v0
  v_and_b32 v8, 7, v10
  v_mul_u32_u24 v8, 1056, v8
  v_lshrrev_b32 v9, 3, v10
  v_lshl_add_u32 v8, v9, 9, v8
  v_lshl_add_u32 v1, v11, 4, v8
  v_lshrrev_b32 v8, 2, v10
  v_and_b32 v9, 1, v11
  v_lshl_add_u32 v8, v9, 2, v8
  v_mul_u32_u24 v8, 1056, v8
  v_and_b32 v9, 3, v10
  v_lshl_add_u32 v8, v9, 3, v8
  v_lshrrev_b32 v9, 1, v11
  v_lshl_add_u32 v2, v9, 7, v8
  s_lshl_b32 s27, s26, 9
  v_add_u32 v2, s27, v2
  v_mul_u32_u24 v9, 8448, v9
  v_add_u32 v3, v9, v8
  s_lshl_b32 s27, s24, 6
  v_add_u32 v3, s27, v3
  v_lshrrev_b32 v8, 2, v10
  v_lshl_add_u32 v8, v11, 2, v8
  v_mul_u32_u24 v8, 928, v8
  v_and_b32 v9, 3, v10
  v_lshl_add_u32 v8, v9, 3, v8
  s_sub_u32 s31, s24, 3
  s_lshl_b32 s27, s31, 7
  v_add_u32 v4, s27, v8
  v_lshlrev_b32 v6, 7, v10
  v_lshrrev_b32 v7, 1, v10
  v_xor_b32 v7, v7, v11
  v_lshl_add_u32 v6, v7, 4, v6
  v_xor_b32 v7, 64, v6
  s_mov_b32 s40, 0x3db8aa3b
  s_waitcnt lgkmcnt(0)
  s_mov_b32 s36, s22
  s_mov_b32 s37, s23
  s_mov_b32 s38, 67108864
  s_mov_b32 s39, 0x00020000
  s_mov_b32 s32, s58
  s_mov_b32 s33, s59
  s_mov_b32 s34, 256
  s_mov_b32 s35, 0x00020000
  s_cmp_ge_u32 s24, 8
  s_cbranch_scc1 L_qskip_1
  s_barrier
  v_add_u32 v9, 10240, v3
  v_add_u32 v8, 0, v6
  ds_read_b128 v[16:19], v8
  ds_read_b64_tr_b16 v[112:113], v9
  ds_read_b64_tr_b16 v[114:115], v9 offset:512
  ds_read_b64_tr_b16 v[116:117], v9 offset:32
  ds_read_b64_tr_b16 v[118:119], v9 offset:544
  ds_read_b128 v[20:23], v8 offset:2048
  ds_read_b128 v[24:27], v8 offset:4096
  ds_read_b128 v[28:31], v8 offset:6144
  ds_read_b128 v[32:35], v8 offset:8192
  v_add_u32 v9, 27136, v3
  v_add_u32 v8, 0, v7
  ds_read_b128 v[128:131], v8
  ds_read_b64_tr_b16 v[120:121], v9
  ds_read_b64_tr_b16 v[122:123], v9 offset:512
  ds_read_b64_tr_b16 v[124:125], v9 offset:32
  ds_read_b64_tr_b16 v[126:127], v9 offset:544
  ds_read_b128 v[132:135], v8 offset:2048
  s_waitcnt lgkmcnt(14)
  ds_read_b128 v[136:139], v8 offset:4096
  s_waitcnt lgkmcnt(14)
  ds_read_b128 v[140:143], v8 offset:6144
  s_waitcnt lgkmcnt(14)
  ds_read_b128 v[144:147], v8 offset:8192
  v_mfma_f32_16x16x32_bf16 v[48:51], v[112:115], v[16:19], 0
  s_waitcnt lgkmcnt(13)
  v_mfma_f32_16x16x32_bf16 v[52:55], v[116:119], v[16:19], 0
  s_waitcnt lgkmcnt(12)
  v_mfma_f32_16x16x32_bf16 v[56:59], v[112:115], v[20:23], 0
  v_mfma_f32_16x16x32_bf16 v[60:63], v[116:119], v[20:23], 0
  s_waitcnt lgkmcnt(11)
  v_mfma_f32_16x16x32_bf16 v[64:67], v[112:115], v[24:27], 0
  v_mfma_f32_16x16x32_bf16 v[68:71], v[116:119], v[24:27], 0
  s_waitcnt lgkmcnt(10)
  v_mfma_f32_16x16x32_bf16 v[72:75], v[112:115], v[28:31], 0
  v_mfma_f32_16x16x32_bf16 v[76:79], v[116:119], v[28:31], 0
  s_waitcnt lgkmcnt(9)
  v_mfma_f32_16x16x32_bf16 v[80:83], v[112:115], v[32:35], 0
  v_mfma_f32_16x16x32_bf16 v[84:87], v[116:119], v[32:35], 0
  s_waitcnt lgkmcnt(6)
  v_mfma_f32_16x16x32_bf16 v[48:51], v[120:123], v[128:131], v[48:51]
  s_waitcnt lgkmcnt(4)
  v_mfma_f32_16x16x32_bf16 v[52:55], v[124:127], v[128:131], v[52:55]
  s_waitcnt lgkmcnt(3)
  v_mfma_f32_16x16x32_bf16 v[56:59], v[120:123], v[132:135], v[56:59]
  v_mfma_f32_16x16x32_bf16 v[60:63], v[124:127], v[132:135], v[60:63]
  s_waitcnt lgkmcnt(2)
  v_mfma_f32_16x16x32_bf16 v[64:67], v[120:123], v[136:139], v[64:67]
  v_mfma_f32_16x16x32_bf16 v[68:71], v[124:127], v[136:139], v[68:71]
  s_waitcnt lgkmcnt(1)
  v_mfma_f32_16x16x32_bf16 v[72:75], v[120:123], v[140:143], v[72:75]
  v_mfma_f32_16x16x32_bf16 v[76:79], v[124:127], v[140:143], v[76:79]
  s_waitcnt lgkmcnt(0)
  v_mfma_f32_16x16x32_bf16 v[80:83], v[120:123], v[144:147], v[80:83]
  v_mfma_f32_16x16x32_bf16 v[84:87], v[124:127], v[144:147], v[84:87]
  s_barrier
  v_add_u32 v9, 54272, v3
  v_add_u32 v8, 44032, v6
  ds_read_b128 v[16:19], v8
  ds_read_b64_tr_b16 v[112:113], v9
  ds_read_b64_tr_b16 v[114:115], v9 offset:512
  ds_read_b64_tr_b16 v[116:117], v9 offset:32
  ds_read_b64_tr_b16 v[118:119], v9 offset:544
  ds_read_b128 v[20:23], v8 offset:2048
  ds_read_b128 v[24:27], v8 offset:4096
  ds_read_b128 v[28:31], v8 offset:6144
  ds_read_b128 v[32:35], v8 offset:8192
  v_add_u32 v9, 71168, v3
  v_add_u32 v8, 44032, v7
  ds_read_b128 v[128:131], v8
  ds_read_b64_tr_b16 v[120:121], v9
  ds_read_b64_tr_b16 v[122:123], v9 offset:512
  ds_read_b64_tr_b16 v[124:125], v9 offset:32
  ds_read_b64_tr_b16 v[126:127], v9 offset:544
  ds_read_b128 v[132:135], v8 offset:2048
  s_waitcnt lgkmcnt(14)
  ds_read_b128 v[136:139], v8 offset:4096
  s_waitcnt lgkmcnt(14)
  ds_read_b128 v[140:143], v8 offset:6144
  s_waitcnt lgkmcnt(14)
  ds_read_b128 v[144:147], v8 offset:8192
  v_mfma_f32_16x16x32_bf16 v[48:51], v[112:115], v[16:19], v[48:51]
  s_waitcnt lgkmcnt(13)
  v_mfma_f32_16x16x32_bf16 v[52:55], v[116:119], v[16:19], v[52:55]
  s_waitcnt lgkmcnt(12)
  v_mfma_f32_16x16x32_bf16 v[56:59], v[112:115], v[20:23], v[56:59]
  v_mfma_f32_16x16x32_bf16 v[60:63], v[116:119], v[20:23], v[60:63]
  s_waitcnt lgkmcnt(11)
  v_mfma_f32_16x16x32_bf16 v[64:67], v[112:115], v[24:27], v[64:67]
  v_mfma_f32_16x16x32_bf16 v[68:71], v[116:119], v[24:27], v[68:71]
  s_waitcnt lgkmcnt(10)
  v_mfma_f32_16x16x32_bf16 v[72:75], v[112:115], v[28:31], v[72:75]
  v_mfma_f32_16x16x32_bf16 v[76:79], v[116:119], v[28:31], v[76:79]
  s_waitcnt lgkmcnt(9)
  v_mfma_f32_16x16x32_bf16 v[80:83], v[112:115], v[32:35], v[80:83]
  v_mfma_f32_16x16x32_bf16 v[84:87], v[116:119], v[32:35], v[84:87]
  s_waitcnt lgkmcnt(6)
  v_mfma_f32_16x16x32_bf16 v[48:51], v[120:123], v[128:131], v[48:51]
  s_waitcnt lgkmcnt(4)
  v_mfma_f32_16x16x32_bf16 v[52:55], v[124:127], v[128:131], v[52:55]
  s_waitcnt lgkmcnt(3)
  v_mfma_f32_16x16x32_bf16 v[56:59], v[120:123], v[132:135], v[56:59]
  v_mfma_f32_16x16x32_bf16 v[60:63], v[124:127], v[132:135], v[60:63]
  s_waitcnt lgkmcnt(2)
  v_mfma_f32_16x16x32_bf16 v[64:67], v[120:123], v[136:139], v[64:67]
  v_mfma_f32_16x16x32_bf16 v[68:71], v[124:127], v[136:139], v[68:71]
  s_waitcnt lgkmcnt(1)
  v_mfma_f32_16x16x32_bf16 v[72:75], v[120:123], v[140:143], v[72:75]
  v_mfma_f32_16x16x32_bf16 v[76:79], v[124:127], v[140:143], v[76:79]
  s_waitcnt lgkmcnt(0)
  v_mfma_f32_16x16x32_bf16 v[80:83], v[120:123], v[144:147], v[80:83]
  v_mfma_f32_16x16x32_bf16 v[84:87], v[124:127], v[144:147], v[84:87]
  s_barrier
  v_add_u32 v9, 98304, v3
  v_add_u32 v8, 88064, v6
  ds_read_b128 v[16:19], v8
  ds_read_b64_tr_b16 v[112:113], v9
  ds_read_b64_tr_b16 v[114:115], v9 offset:512
  ds_read_b64_tr_b16 v[116:117], v9 offset:32
  ds_read_b64_tr_b16 v[118:119], v9 offset:544
  ds_read_b128 v[20:23], v8 offset:2048
  ds_read_b128 v[24:27], v8 offset:4096
  ds_read_b128 v[28:31], v8 offset:6144
  ds_read_b128 v[32:35], v8 offset:8192
  v_add_u32 v9, 115200, v3
  v_add_u32 v8, 88064, v7
  ds_read_b128 v[128:131], v8
  ds_read_b64_tr_b16 v[120:121], v9
  ds_read_b64_tr_b16 v[122:123], v9 offset:512
  ds_read_b64_tr_b16 v[124:125], v9 offset:32
  ds_read_b64_tr_b16 v[126:127], v9 offset:544
  ds_read_b128 v[132:135], v8 offset:2048
  s_waitcnt lgkmcnt(14)
  ds_read_b128 v[136:139], v8 offset:4096
  s_waitcnt lgkmcnt(14)
  ds_read_b128 v[140:143], v8 offset:6144
  s_waitcnt lgkmcnt(14)
  ds_read_b128 v[144:147], v8 offset:8192
  v_mfma_f32_16x16x32_bf16 v[48:51], v[112:115], v[16:19], v[48:51]
  s_waitcnt lgkmcnt(13)
  v_mfma_f32_16x16x32_bf16 v[52:55], v[116:119], v[16:19], v[52:55]
  s_waitcnt lgkmcnt(12)
  v_mfma_f32_16x16x32_bf16 v[56:59], v[112:115], v[20:23], v[56:59]
  v_mfma_f32_16x16x32_bf16 v[60:63], v[116:119], v[20:23], v[60:63]
  s_waitcnt lgkmcnt(11)
  v_mfma_f32_16x16x32_bf16 v[64:67], v[112:115], v[24:27], v[64:67]
  v_mfma_f32_16x16x32_bf16 v[68:71], v[116:119], v[24:27], v[68:71]
  s_waitcnt lgkmcnt(10)
  v_mfma_f32_16x16x32_bf16 v[72:75], v[112:115], v[28:31], v[72:75]
  v_mfma_f32_16x16x32_bf16 v[76:79], v[116:119], v[28:31], v[76:79]
  s_waitcnt lgkmcnt(9)
  v_mfma_f32_16x16x32_bf16 v[80:83], v[112:115], v[32:35], v[80:83]
  v_mfma_f32_16x16x32_bf16 v[84:87], v[116:119], v[32:35], v[84:87]
  s_waitcnt lgkmcnt(6)
  v_mfma_f32_16x16x32_bf16 v[48:51], v[120:123], v[128:131], v[48:51]
  s_waitcnt lgkmcnt(4)
  v_mfma_f32_16x16x32_bf16 v[52:55], v[124:127], v[128:131], v[52:55]
  s_waitcnt lgkmcnt(3)
  v_mfma_f32_16x16x32_bf16 v[56:59], v[120:123], v[132:135], v[56:59]
  v_mfma_f32_16x16x32_bf16 v[60:63], v[124:127], v[132:135], v[60:63]
  s_waitcnt lgkmcnt(2)
  v_mfma_f32_16x16x32_bf16 v[64:67], v[120:123], v[136:139], v[64:67]
  v_mfma_f32_16x16x32_bf16 v[68:71], v[124:127], v[136:139], v[68:71]
  s_waitcnt lgkmcnt(1)
  v_mfma_f32_16x16x32_bf16 v[72:75], v[120:123], v[140:143], v[72:75]
  v_mfma_f32_16x16x32_bf16 v[76:79], v[124:127], v[140:143], v[76:79]
  s_waitcnt lgkmcnt(0)
  v_mfma_f32_16x16x32_bf16 v[80:83], v[120:123], v[144:147], v[80:83]
  v_mfma_f32_16x16x32_bf16 v[84:87], v[124:127], v[144:147], v[84:87]
  s_barrier
  v_add_u32 v9, 10240, v3
  v_add_u32 v8, 0, v6
  ds_read_b128 v[16:19], v8
  ds_read_b64_tr_b16 v[112:113], v9
  ds_read_b64_tr_b16 v[114:115], v9 offset:512
  ds_read_b64_tr_b16 v[116:117], v9 offset:32
  ds_read_b64_tr_b16 v[118:119], v9 offset:544
  ds_read_b128 v[20:23], v8 offset:2048
  ds_read_b128 v[24:27], v8 offset:4096
  ds_read_b128 v[28:31], v8 offset:6144
  ds_read_b128 v[32:35], v8 offset:8192
  v_add_u32 v9, 27136, v3
  v_add_u32 v8, 0, v7
  ds_read_b128 v[128:131], v8
  ds_read_b64_tr_b16 v[120:121], v9
  ds_read_b64_tr_b16 v[122:123], v9 offset:512
  ds_read_b64_tr_b16 v[124:125], v9 offset:32
  ds_read_b64_tr_b16 v[126:127], v9 offset:544
  ds_read_b128 v[132:135], v8 offset:2048
  s_waitcnt lgkmcnt(14)
  ds_read_b128 v[136:139], v8 offset:4096
  s_waitcnt lgkmcnt(14)
  ds_read_b128 v[140:143], v8 offset:6144
  s_waitcnt lgkmcnt(14)
  ds_read_b128 v[144:147], v8 offset:8192
  v_mfma_f32_16x16x32_bf16 v[48:51], v[112:115], v[16:19], v[48:51]
  s_waitcnt lgkmcnt(13)
  v_mfma_f32_16x16x32_bf16 v[52:55], v[116:119], v[16:19], v[52:55]
  s_waitcnt lgkmcnt(12)
  v_mfma_f32_16x16x32_bf16 v[56:59], v[112:115], v[20:23], v[56:59]
  v_mfma_f32_16x16x32_bf16 v[60:63], v[116:119], v[20:23], v[60:63]
  s_waitcnt lgkmcnt(11)
  v_mfma_f32_16x16x32_bf16 v[64:67], v[112:115], v[24:27], v[64:67]
  v_mfma_f32_16x16x32_bf16 v[68:71], v[116:119], v[24:27], v[68:71]
  s_waitcnt lgkmcnt(10)
  v_mfma_f32_16x16x32_bf16 v[72:75], v[112:115], v[28:31], v[72:75]
  v_mfma_f32_16x16x32_bf16 v[76:79], v[116:119], v[28:31], v[76:79]
  s_waitcnt lgkmcnt(9)
  v_mfma_f32_16x16x32_bf16 v[80:83], v[112:115], v[32:35], v[80:83]
  v_mfma_f32_16x16x32_bf16 v[84:87], v[116:119], v[32:35], v[84:87]
  s_waitcnt lgkmcnt(6)
  v_mfma_f32_16x16x32_bf16 v[48:51], v[120:123], v[128:131], v[48:51]
  s_waitcnt lgkmcnt(4)
  v_mfma_f32_16x16x32_bf16 v[52:55], v[124:127], v[128:131], v[52:55]
  s_waitcnt lgkmcnt(3)
  v_mfma_f32_16x16x32_bf16 v[56:59], v[120:123], v[132:135], v[56:59]
  v_mfma_f32_16x16x32_bf16 v[60:63], v[124:127], v[132:135], v[60:63]
  s_waitcnt lgkmcnt(2)
  v_mfma_f32_16x16x32_bf16 v[64:67], v[120:123], v[136:139], v[64:67]
  v_mfma_f32_16x16x32_bf16 v[68:71], v[124:127], v[136:139], v[68:71]
  s_waitcnt lgkmcnt(1)
  v_mfma_f32_16x16x32_bf16 v[72:75], v[120:123], v[140:143], v[72:75]
  v_mfma_f32_16x16x32_bf16 v[76:79], v[124:127], v[140:143], v[76:79]
  s_waitcnt lgkmcnt(0)
  v_mfma_f32_16x16x32_bf16 v[80:83], v[120:123], v[144:147], v[80:83]
  v_mfma_f32_16x16x32_bf16 v[84:87], v[124:127], v[144:147], v[84:87]
  s_barrier
  v_add_u32 v9, 54272, v3
  v_add_u32 v8, 44032, v6
  ds_read_b128 v[16:19], v8
  ds_read_b64_tr_b16 v[112:113], v9
  ds_read_b64_tr_b16 v[114:115], v9 offset:512
  ds_read_b64_tr_b16 v[116:117], v9 offset:32
  ds_read_b64_tr_b16 v[118:119], v9 offset:544
  ds_read_b128 v[20:23], v8 offset:2048
  ds_read_b128 v[24:27], v8 offset:4096
  ds_read_b128 v[28:31], v8 offset:6144
  ds_read_b128 v[32:35], v8 offset:8192
  v_add_u32 v9, 71168, v3
  v_add_u32 v8, 44032, v7
  ds_read_b128 v[128:131], v8
  ds_read_b64_tr_b16 v[120:121], v9
  ds_read_b64_tr_b16 v[122:123], v9 offset:512
  ds_read_b64_tr_b16 v[124:125], v9 offset:32
  ds_read_b64_tr_b16 v[126:127], v9 offset:544
  ds_read_b128 v[132:135], v8 offset:2048
  s_waitcnt lgkmcnt(14)
  ds_read_b128 v[136:139], v8 offset:4096
  s_waitcnt lgkmcnt(14)
  ds_read_b128 v[140:143], v8 offset:6144
  s_waitcnt lgkmcnt(14)
  ds_read_b128 v[144:147], v8 offset:8192
  v_mfma_f32_16x16x32_bf16 v[48:51], v[112:115], v[16:19], v[48:51]
  s_waitcnt lgkmcnt(13)
  v_mfma_f32_16x16x32_bf16 v[52:55], v[116:119], v[16:19], v[52:55]
  s_waitcnt lgkmcnt(12)
  v_mfma_f32_16x16x32_bf16 v[56:59], v[112:115], v[20:23], v[56:59]
  v_mfma_f32_16x16x32_bf16 v[60:63], v[116:119], v[20:23], v[60:63]
  s_waitcnt lgkmcnt(11)
  v_mfma_f32_16x16x32_bf16 v[64:67], v[112:115], v[24:27], v[64:67]
  v_mfma_f32_16x16x32_bf16 v[68:71], v[116:119], v[24:27], v[68:71]
  s_waitcnt lgkmcnt(10)
  v_mfma_f32_16x16x32_bf16 v[72:75], v[112:115], v[28:31], v[72:75]
  v_mfma_f32_16x16x32_bf16 v[76:79], v[116:119], v[28:31], v[76:79]
  s_waitcnt lgkmcnt(9)
  v_mfma_f32_16x16x32_bf16 v[80:83], v[112:115], v[32:35], v[80:83]
  v_mfma_f32_16x16x32_bf16 v[84:87], v[116:119], v[32:35], v[84:87]
  s_waitcnt lgkmcnt(6)
  v_mfma_f32_16x16x32_bf16 v[48:51], v[120:123], v[128:131], v[48:51]
  s_waitcnt lgkmcnt(4)
  v_mfma_f32_16x16x32_bf16 v[52:55], v[124:127], v[128:131], v[52:55]
  s_waitcnt lgkmcnt(3)
  v_mfma_f32_16x16x32_bf16 v[56:59], v[120:123], v[132:135], v[56:59]
  v_mfma_f32_16x16x32_bf16 v[60:63], v[124:127], v[132:135], v[60:63]
  s_waitcnt lgkmcnt(2)
  v_mfma_f32_16x16x32_bf16 v[64:67], v[120:123], v[136:139], v[64:67]
  v_mfma_f32_16x16x32_bf16 v[68:71], v[124:127], v[136:139], v[68:71]
  s_waitcnt lgkmcnt(1)
  v_mfma_f32_16x16x32_bf16 v[72:75], v[120:123], v[140:143], v[72:75]
  v_mfma_f32_16x16x32_bf16 v[76:79], v[124:127], v[140:143], v[76:79]
  s_waitcnt lgkmcnt(0)
  v_mfma_f32_16x16x32_bf16 v[80:83], v[120:123], v[144:147], v[80:83]
  v_mfma_f32_16x16x32_bf16 v[84:87], v[124:127], v[144:147], v[84:87]
  s_barrier
  v_add_u32 v9, 98304, v3
  v_add_u32 v8, 88064, v6
  ds_read_b128 v[16:19], v8
  ds_read_b64_tr_b16 v[112:113], v9
  ds_read_b64_tr_b16 v[114:115], v9 offset:512
  ds_read_b64_tr_b16 v[116:117], v9 offset:32
  ds_read_b64_tr_b16 v[118:119], v9 offset:544
  ds_read_b128 v[20:23], v8 offset:2048
  ds_read_b128 v[24:27], v8 offset:4096
  ds_read_b128 v[28:31], v8 offset:6144
  ds_read_b128 v[32:35], v8 offset:8192
  v_add_u32 v9, 115200, v3
  v_add_u32 v8, 88064, v7
  ds_read_b128 v[128:131], v8
  ds_read_b64_tr_b16 v[120:121], v9
  ds_read_b64_tr_b16 v[122:123], v9 offset:512
  ds_read_b64_tr_b16 v[124:125], v9 offset:32
  ds_read_b64_tr_b16 v[126:127], v9 offset:544
  ds_read_b128 v[132:135], v8 offset:2048
  s_waitcnt lgkmcnt(14)
  ds_read_b128 v[136:139], v8 offset:4096
  s_waitcnt lgkmcnt(14)
  ds_read_b128 v[140:143], v8 offset:6144
  s_waitcnt lgkmcnt(14)
  ds_read_b128 v[144:147], v8 offset:8192
  v_mfma_f32_16x16x32_bf16 v[48:51], v[112:115], v[16:19], v[48:51]
  s_waitcnt lgkmcnt(13)
  v_mfma_f32_16x16x32_bf16 v[52:55], v[116:119], v[16:19], v[52:55]
  s_waitcnt lgkmcnt(12)
  v_mfma_f32_16x16x32_bf16 v[56:59], v[112:115], v[20:23], v[56:59]
  v_mfma_f32_16x16x32_bf16 v[60:63], v[116:119], v[20:23], v[60:63]
  s_waitcnt lgkmcnt(11)
  v_mfma_f32_16x16x32_bf16 v[64:67], v[112:115], v[24:27], v[64:67]
  v_mfma_f32_16x16x32_bf16 v[68:71], v[116:119], v[24:27], v[68:71]
  s_waitcnt lgkmcnt(10)
  v_mfma_f32_16x16x32_bf16 v[72:75], v[112:115], v[28:31], v[72:75]
  v_mfma_f32_16x16x32_bf16 v[76:79], v[116:119], v[28:31], v[76:79]
  s_waitcnt lgkmcnt(9)
  v_mfma_f32_16x16x32_bf16 v[80:83], v[112:115], v[32:35], v[80:83]
  v_mfma_f32_16x16x32_bf16 v[84:87], v[116:119], v[32:35], v[84:87]
  s_waitcnt lgkmcnt(6)
  v_mfma_f32_16x16x32_bf16 v[48:51], v[120:123], v[128:131], v[48:51]
  s_waitcnt lgkmcnt(4)
  v_mfma_f32_16x16x32_bf16 v[52:55], v[124:127], v[128:131], v[52:55]
  s_waitcnt lgkmcnt(3)
  v_mfma_f32_16x16x32_bf16 v[56:59], v[120:123], v[132:135], v[56:59]
  v_mfma_f32_16x16x32_bf16 v[60:63], v[124:127], v[132:135], v[60:63]
  s_waitcnt lgkmcnt(2)
  v_mfma_f32_16x16x32_bf16 v[64:67], v[120:123], v[136:139], v[64:67]
  v_mfma_f32_16x16x32_bf16 v[68:71], v[124:127], v[136:139], v[68:71]
  s_waitcnt lgkmcnt(1)
  v_mfma_f32_16x16x32_bf16 v[72:75], v[120:123], v[140:143], v[72:75]
  v_mfma_f32_16x16x32_bf16 v[76:79], v[124:127], v[140:143], v[76:79]
  s_waitcnt lgkmcnt(0)
  v_mfma_f32_16x16x32_bf16 v[80:83], v[120:123], v[144:147], v[80:83]
  v_mfma_f32_16x16x32_bf16 v[84:87], v[124:127], v[144:147], v[84:87]
  s_barrier
  v_add_u32 v9, 10240, v3
  v_add_u32 v8, 0, v6
  ds_read_b128 v[16:19], v8
  ds_read_b64_tr_b16 v[112:113], v9
  ds_read_b64_tr_b16 v[114:115], v9 offset:512
  ds_read_b64_tr_b16 v[116:117], v9 offset:32
  ds_read_b64_tr_b16 v[118:119], v9 offset:544
  ds_read_b128 v[20:23], v8 offset:2048
  ds_read_b128 v[24:27], v8 offset:4096
  ds_read_b128 v[28:31], v8 offset:6144
  ds_read_b128 v[32:35], v8 offset:8192
  v_add_u32 v9, 27136, v3
  v_add_u32 v8, 0, v7
  ds_read_b128 v[128:131], v8
  ds_read_b64_tr_b16 v[120:121], v9
  ds_read_b64_tr_b16 v[122:123], v9 offset:512
  ds_read_b64_tr_b16 v[124:125], v9 offset:32
  ds_read_b64_tr_b16 v[126:127], v9 offset:544
  ds_read_b128 v[132:135], v8 offset:2048
  s_waitcnt lgkmcnt(14)
  ds_read_b128 v[136:139], v8 offset:4096
  s_waitcnt lgkmcnt(14)
  ds_read_b128 v[140:143], v8 offset:6144
  s_waitcnt lgkmcnt(14)
  ds_read_b128 v[144:147], v8 offset:8192
  v_mfma_f32_16x16x32_bf16 v[48:51], v[112:115], v[16:19], v[48:51]
  s_waitcnt lgkmcnt(13)
  v_mfma_f32_16x16x32_bf16 v[52:55], v[116:119], v[16:19], v[52:55]
  s_waitcnt lgkmcnt(12)
  v_mfma_f32_16x16x32_bf16 v[56:59], v[112:115], v[20:23], v[56:59]
  v_mfma_f32_16x16x32_bf16 v[60:63], v[116:119], v[20:23], v[60:63]
  s_waitcnt lgkmcnt(11)
  v_mfma_f32_16x16x32_bf16 v[64:67], v[112:115], v[24:27], v[64:67]
  v_mfma_f32_16x16x32_bf16 v[68:71], v[116:119], v[24:27], v[68:71]
  s_waitcnt lgkmcnt(10)
  v_mfma_f32_16x16x32_bf16 v[72:75], v[112:115], v[28:31], v[72:75]
  v_mfma_f32_16x16x32_bf16 v[76:79], v[116:119], v[28:31], v[76:79]
  s_waitcnt lgkmcnt(9)
  v_mfma_f32_16x16x32_bf16 v[80:83], v[112:115], v[32:35], v[80:83]
  v_mfma_f32_16x16x32_bf16 v[84:87], v[116:119], v[32:35], v[84:87]
  s_waitcnt lgkmcnt(6)
  v_mfma_f32_16x16x32_bf16 v[48:51], v[120:123], v[128:131], v[48:51]
  s_waitcnt lgkmcnt(4)
  v_mfma_f32_16x16x32_bf16 v[52:55], v[124:127], v[128:131], v[52:55]
  s_waitcnt lgkmcnt(3)
  v_mfma_f32_16x16x32_bf16 v[56:59], v[120:123], v[132:135], v[56:59]
  v_mfma_f32_16x16x32_bf16 v[60:63], v[124:127], v[132:135], v[60:63]
  s_waitcnt lgkmcnt(2)
  v_mfma_f32_16x16x32_bf16 v[64:67], v[120:123], v[136:139], v[64:67]
  v_mfma_f32_16x16x32_bf16 v[68:71], v[124:127], v[136:139], v[68:71]
  s_waitcnt lgkmcnt(1)
  v_mfma_f32_16x16x32_bf16 v[72:75], v[120:123], v[140:143], v[72:75]
  v_mfma_f32_16x16x32_bf16 v[76:79], v[124:127], v[140:143], v[76:79]
  s_waitcnt lgkmcnt(0)
  v_mfma_f32_16x16x32_bf16 v[80:83], v[120:123], v[144:147], v[80:83]
  v_mfma_f32_16x16x32_bf16 v[84:87], v[124:127], v[144:147], v[84:87]
  v_lshlrev_b32 v8, 4, v10
  v_lshrrev_b32 v9, 1, v11
  v_lshl_add_u32 v8, v9, 8, v8
  v_and_b32 v9, 1, v11
  v_lshl_add_u32 v8, v9, 3, v8
  s_lshl_b32 s27, s24, 10
  s_add_u32 s27, s27, 0
  v_add_u32 v8, s27, v8
  v_cvt_pk_bf16_f32 v48, v48, v49
  v_cvt_pk_bf16_f32 v49, v50, v51
  v_cvt_pk_bf16_f32 v52, v52, v53
  v_cvt_pk_bf16_f32 v53, v54, v55
  v_cvt_pk_bf16_f32 v56, v56, v57
  v_cvt_pk_bf16_f32 v57, v58, v59
  v_cvt_pk_bf16_f32 v60, v60, v61
  v_cvt_pk_bf16_f32 v61, v62, v63
  v_cvt_pk_bf16_f32 v64, v64, v65
  v_cvt_pk_bf16_f32 v65, v66, v67
  v_cvt_pk_bf16_f32 v68, v68, v69
  v_cvt_pk_bf16_f32 v69, v70, v71
  v_cvt_pk_bf16_f32 v72, v72, v73
  v_cvt_pk_bf16_f32 v73, v74, v75
  v_cvt_pk_bf16_f32 v76, v76, v77
  v_cvt_pk_bf16_f32 v77, v78, v79
  v_cvt_pk_bf16_f32 v80, v80, v81
  v_cvt_pk_bf16_f32 v81, v82, v83
  v_cvt_pk_bf16_f32 v84, v84, v85
  v_cvt_pk_bf16_f32 v85, v86, v87
  s_barrier
  ds_write_b64 v8, v[48:49]
  ds_write_b64 v8, v[52:53] offset:512
  ds_write_b64 v8, v[56:57] offset:8192
  ds_write_b64 v8, v[60:61] offset:8704
  ds_write_b64 v8, v[64:65] offset:16384
  ds_write_b64 v8, v[68:69] offset:16896
  ds_write_b64 v8, v[72:73] offset:24576
  ds_write_b64 v8, v[76:77] offset:25088
  ds_write_b64 v8, v[80:81] offset:32768
  ds_write_b64 v8, v[84:85] offset:33280
  s_waitcnt lgkmcnt(0)
  s_branch L_qjoin_2
L_qskip_1:
  s_cmp_lg_u32 s24, 8
  s_cbranch_scc1 L_3
  v_mov_b32 v8, 0
  s_cmp_lg_u32 s2, 0
  s_cbranch_scc1 L_6
  s_memrealtime s[44:45]
  s_waitcnt lgkmcnt(0)
  s_or_b32 s44, s44, 1
  v_mov_b32 v16, s44
  v_mov_b32 v17, s45
  buffer_store_dwordx2 v[16:17], v8, s[32:35], 0 offen sc1
L_6:
L_3:
  s_barrier
  s_barrier
  s_barrier
  s_barrier
  s_barrier
  s_cmp_lg_u32 s24, 8
  s_cbranch_scc1 L_5_x
  s_mov_b32 s46, 0
L_4:
  buffer_load_dwordx2 v[18:19], v8, s[32:35], 0 offen sc1
  s_waitcnt vmcnt(0)
  v_cmp_ne_u32 vcc, 0, v18
  s_cbranch_vccnz L_5
  s_sleep 4
  s_add_u32 s46, s46, 1
  s_cmp_lt_u32 s46, 1048576
  s_cbranch_scc1 L_4
L_5:
  v_mov_b32 v8, 163328
  ds_write_b64 v8, v[18:19]
  s_waitcnt lgkmcnt(0)
L_5_x:
  s_barrier
  s_barrier
  s_barrier
L_qjoin_2:
  s_nop 7
  s_barrier
  s_lshl_b32 s28, s25, 13
  s_add_u32 s27, s28, 0
  v_add_u32 v9, s27, v5
  ds_read_b128 v[16:19], v9
  ds_read_b128 v[20:23], v9 offset:1024
  ds_read_b128 v[24:27], v9 offset:2048
  ds_read_b128 v[28:31], v9 offset:3072
  ds_read_b128 v[32:35], v9 offset:4096
  ds_read_b128 v[36:39], v9 offset:5120
  ds_read_b128 v[40:43], v9 offset:6144
  ds_read_b128 v[44:47], v9 offset:7168
  v_mov_b32 v8, 163328
  ds_read_b64 v[12:13], v8
  v_mov_b32 v7, 0xff800000
  s_waitcnt lgkmcnt(0)
  v_readfirstlane_b32 s42, v12
  v_readfirstlane_b32 s43, v13
  s_barrier
  s_mul_i32 s27, s26, 16896
  s_add_u32 s27, s27, 44032
  v_add_u32 v9, s27, v1
  ds_read_b128 v[144:147], v9
  ds_read_b128 v[148:151], v9 offset:8448
  ds_read_b128 v[152:155], v9 offset:64
  ds_read_b128 v[156:159], v9 offset:8512
  ds_read_b128 v[160:163], v9 offset:128
  s_waitcnt lgkmcnt(4)
  v_mfma_f32_16x16x32_bf16 v[80:83], v[144:147], v[16:19], 0
  ds_read_b128 v[164:167], v9 offset:8576
  s_waitcnt lgkmcnt(4)
  v_mfma_f32_16x16x32_bf16 v[84:87], v[148:151], v[16:19], 0
  ds_read_b128 v[144:147], v9 offset:192
  s_waitcnt lgkmcnt(4)
  v_mfma_f32_16x16x32_bf16 v[80:83], v[152:155], v[20:23], v[80:83]
  ds_read_b128 v[148:151], v9 offset:8640
  s_waitcnt lgkmcnt(4)
  v_mfma_f32_16x16x32_bf16 v[84:87], v[156:159], v[20:23], v[84:87]
  ds_read_b128 v[152:155], v9 offset:256
  s_waitcnt lgkmcnt(4)
  v_mfma_f32_16x16x32_bf16 v[80:83], v[160:163], v[24:27], v[80:83]
  ds_read_b128 v[156:159], v9 offset:8704
  s_waitcnt lgkmcnt(4)
  v_mfma_f32_16x16x32_bf16 v[84:87], v[164:167], v[24:27], v[84:87]
  ds_read_b128 v[160:163], v9 offset:320
  s_waitcnt lgkmcnt(4)
  v_mfma_f32_16x16x32_bf16 v[80:83], v[144:147], v[28:31], v[80:83]
  ds_read_b128 v[164:167], v9 offset:8768
  s_waitcnt lgkmcnt(4)
  v_mfma_f32_16x16x32_bf16 v[84:87], v[148:151], v[28:31], v[84:87]
  ds_read_b128 v[144:147], v9 offset:384
  s_waitcnt lgkmcnt(4)
  v_mfma_f32_16x16x32_bf16 v[80:83], v[152:155], v[32:35], v[80:83]
  ds_read_b128 v[148:151], v9 offset:8832
  s_waitcnt lgkmcnt(4)
  v_mfma_f32_16x16x32_bf16 v[84:87], v[156:159], v[32:35], v[84:87]
  ds_read_b128 v[152:155], v9 offset:448
  s_waitcnt lgkmcnt(4)
  v_mfma_f32_16x16x32_bf16 v[80:83], v[160:163], v[36:39], v[80:83]
  ds_read_b128 v[156:159], v9 offset:8896
  s_waitcnt lgkmcnt(4)
  v_mfma_f32_16x16x32_bf16 v[84:87], v[164:167], v[36:39], v[84:87]
  s_waitcnt lgkmcnt(3)
  v_mfma_f32_16x16x32_bf16 v[80:83], v[144:147], v[40:43], v[80:83]
  s_waitcnt lgkmcnt(2)
  v_mfma_f32_16x16x32_bf16 v[84:87], v[148:151], v[40:43], v[84:87]
  s_waitcnt lgkmcnt(1)
  v_mfma_f32_16x16x32_bf16 v[80:83], v[152:155], v[44:47], v[80:83]
  s_waitcnt lgkmcnt(0)
  v_mfma_f32_16x16x32_bf16 v[84:87], v[156:159], v[44:47], v[84:87]
  s_barrier
  s_mul_i32 s27, s26, 16896
  s_add_u32 s27, s27, 77824
  v_add_u32 v9, s27, v1
  ds_read_b128 v[160:163], v9
  ds_read_b128 v[164:167], v9 offset:8448
  ds_read_b128 v[144:147], v9 offset:64
  ds_read_b128 v[148:151], v9 offset:8512
  ds_read_b128 v[152:155], v9 offset:128
  s_waitcnt lgkmcnt(4)
  v_mfma_f32_16x16x32_bf16 v[88:91], v[160:163], v[16:19], 0
  ds_read_b128 v[156:159], v9 offset:8576
  v_max3_f32 v7, v7, v80, v81
  v_max3_f32 v7, v7, v82, v83
  s_waitcnt lgkmcnt(4)
  v_mfma_f32_16x16x32_bf16 v[92:95], v[164:167], v[16:19], 0
  ds_read_b128 v[160:163], v9 offset:192
  v_max3_f32 v7, v7, v84, v85
  v_max3_f32 v7, v7, v86, v87
  s_waitcnt lgkmcnt(4)
  v_mfma_f32_16x16x32_bf16 v[88:91], v[144:147], v[20:23], v[88:91]
  ds_read_b128 v[164:167], v9 offset:8640
  s_waitcnt lgkmcnt(4)
  v_mfma_f32_16x16x32_bf16 v[92:95], v[148:151], v[20:23], v[92:95]
  ds_read_b128 v[144:147], v9 offset:256
  s_waitcnt lgkmcnt(4)
  v_mfma_f32_16x16x32_bf16 v[88:91], v[152:155], v[24:27], v[88:91]
  ds_read_b128 v[148:151], v9 offset:8704
  s_waitcnt lgkmcnt(4)
  v_mfma_f32_16x16x32_bf16 v[92:95], v[156:159], v[24:27], v[92:95]
  ds_read_b128 v[152:155], v9 offset:320
  s_waitcnt lgkmcnt(4)
  v_mfma_f32_16x16x32_bf16 v[88:91], v[160:163], v[28:31], v[88:91]
  ds_read_b128 v[156:159], v9 offset:8768
  s_waitcnt lgkmcnt(4)
  v_mfma_f32_16x16x32_bf16 v[92:95], v[164:167], v[28:31], v[92:95]
  ds_read_b128 v[160:163], v9 offset:384
  s_waitcnt lgkmcnt(4)
  v_mfma_f32_16x16x32_bf16 v[88:91], v[144:147], v[32:35], v[88:91]
  ds_read_b128 v[164:167], v9 offset:8832
  s_waitcnt lgkmcnt(4)
  v_mfma_f32_16x16x32_bf16 v[92:95], v[148:151], v[32:35], v[92:95]
  ds_read_b128 v[144:147], v9 offset:448
  s_waitcnt lgkmcnt(4)
  v_mfma_f32_16x16x32_bf16 v[88:91], v[152:155], v[36:39], v[88:91]
  ds_read_b128 v[148:151], v9 offset:8896
  s_waitcnt lgkmcnt(4)
  v_mfma_f32_16x16x32_bf16 v[92:95], v[156:159], v[36:39], v[92:95]
  s_waitcnt lgkmcnt(3)
  v_mfma_f32_16x16x32_bf16 v[88:91], v[160:163], v[40:43], v[88:91]
  s_waitcnt lgkmcnt(2)
  v_mfma_f32_16x16x32_bf16 v[92:95], v[164:167], v[40:43], v[92:95]
  s_waitcnt lgkmcnt(1)
  v_mfma_f32_16x16x32_bf16 v[88:91], v[144:147], v[44:47], v[88:91]
  s_waitcnt lgkmcnt(0)
  v_mfma_f32_16x16x32_bf16 v[92:95], v[148:151], v[44:47], v[92:95]
  s_barrier
  s_mul_i32 s27, s26, -111616
  s_add_u32 s27, s27, 111616
  v_add_u32 v9, s27, v1
  ds_read_b128 v[152:155], v9
  ds_read_b128 v[156:159], v9 offset:8448
  ds_read_b128 v[160:163], v9 offset:64
  ds_read_b128 v[164:167], v9 offset:8512
  ds_read_b128 v[144:147], v9 offset:128
  s_waitcnt lgkmcnt(4)
  v_mfma_f32_16x16x32_bf16 v[96:99], v[152:155], v[16:19], 0
  ds_read_b128 v[148:151], v9 offset:8576
  v_max3_f32 v7, v7, v88, v89
  v_max3_f32 v7, v7, v90, v91
  s_waitcnt lgkmcnt(4)
  v_mfma_f32_16x16x32_bf16 v[100:103], v[156:159], v[16:19], 0
  ds_read_b128 v[152:155], v9 offset:192
  v_max3_f32 v7, v7, v92, v93
  v_max3_f32 v7, v7, v94, v95
  s_waitcnt lgkmcnt(4)
  v_mfma_f32_16x16x32_bf16 v[96:99], v[160:163], v[20:23], v[96:99]
  ds_read_b128 v[156:159], v9 offset:8640
  s_waitcnt lgkmcnt(4)
  v_mfma_f32_16x16x32_bf16 v[100:103], v[164:167], v[20:23], v[100:103]
  ds_read_b128 v[160:163], v9 offset:256
  s_waitcnt lgkmcnt(4)
  v_mfma_f32_16x16x32_bf16 v[96:99], v[144:147], v[24:27], v[96:99]
  ds_read_b128 v[164:167], v9 offset:8704
  s_waitcnt lgkmcnt(4)
  v_mfma_f32_16x16x32_bf16 v[100:103], v[148:151], v[24:27], v[100:103]
  ds_read_b128 v[144:147], v9 offset:320
  s_waitcnt lgkmcnt(4)
  v_mfma_f32_16x16x32_bf16 v[96:99], v[152:155], v[28:31], v[96:99]
  ds_read_b128 v[148:151], v9 offset:8768
  s_waitcnt lgkmcnt(4)
  v_mfma_f32_16x16x32_bf16 v[100:103], v[156:159], v[28:31], v[100:103]
  ds_read_b128 v[152:155], v9 offset:384
  s_waitcnt lgkmcnt(4)
  v_mfma_f32_16x16x32_bf16 v[96:99], v[160:163], v[32:35], v[96:99]
  ds_read_b128 v[156:159], v9 offset:8832
  s_waitcnt lgkmcnt(4)
  v_mfma_f32_16x16x32_bf16 v[100:103], v[164:167], v[32:35], v[100:103]
  ds_read_b128 v[160:163], v9 offset:448
  s_waitcnt lgkmcnt(4)
  v_mfma_f32_16x16x32_bf16 v[96:99], v[144:147], v[36:39], v[96:99]
  ds_read_b128 v[164:167], v9 offset:8896
  s_waitcnt lgkmcnt(4)
  v_mfma_f32_16x16x32_bf16 v[100:103], v[148:151], v[36:39], v[100:103]
  s_waitcnt lgkmcnt(3)
  v_mfma_f32_16x16x32_bf16 v[96:99], v[152:155], v[40:43], v[96:99]
  s_waitcnt lgkmcnt(2)
  v_mfma_f32_16x16x32_bf16 v[100:103], v[156:159], v[40:43], v[100:103]
  s_waitcnt lgkmcnt(1)
  v_mfma_f32_16x16x32_bf16 v[96:99], v[160:163], v[44:47], v[96:99]
  s_waitcnt lgkmcnt(0)
  v_mfma_f32_16x16x32_bf16 v[100:103], v[164:167], v[44:47], v[100:103]
  s_barrier
  s_mul_i32 s27, s26, 16896
  s_add_u32 s27, s27, 16896
  v_add_u32 v9, s27, v1
  ds_read_b128 v[144:147], v9
  ds_read_b128 v[148:151], v9 offset:8448
  ds_read_b128 v[152:155], v9 offset:64
  ds_read_b128 v[156:159], v9 offset:8512
  ds_read_b128 v[160:163], v9 offset:128
  s_waitcnt lgkmcnt(4)
  v_mfma_f32_16x16x32_bf16 v[104:107], v[144:147], v[16:19], 0
  ds_read_b128 v[164:167], v9 offset:8576
  v_max3_f32 v7, v7, v96, v97
  v_max3_f32 v7, v7, v98, v99
  s_waitcnt lgkmcnt(4)
  v_mfma_f32_16x16x32_bf16 v[108:111], v[148:151], v[16:19], 0
  ds_read_b128 v[144:147], v9 offset:192
  v_max3_f32 v7, v7, v100, v101
  v_max3_f32 v7, v7, v102, v103
  s_waitcnt lgkmcnt(4)
  v_mfma_f32_16x16x32_bf16 v[104:107], v[152:155], v[20:23], v[104:107]
  ds_read_b128 v[148:151], v9 offset:8640
  s_waitcnt lgkmcnt(4)
  v_mfma_f32_16x16x32_bf16 v[108:111], v[156:159], v[20:23], v[108:111]
  ds_read_b128 v[152:155], v9 offset:256
  s_waitcnt lgkmcnt(4)
  v_mfma_f32_16x16x32_bf16 v[104:107], v[160:163], v[24:27], v[104:107]
  ds_read_b128 v[156:159], v9 offset:8704
  s_waitcnt lgkmcnt(4)
  v_mfma_f32_16x16x32_bf16 v[108:111], v[164:167], v[24:27], v[108:111]
  ds_read_b128 v[160:163], v9 offset:320
  s_waitcnt lgkmcnt(4)
  v_mfma_f32_16x16x32_bf16 v[104:107], v[144:147], v[28:31], v[104:107]
  ds_read_b128 v[164:167], v9 offset:8768
  s_waitcnt lgkmcnt(4)
  v_mfma_f32_16x16x32_bf16 v[108:111], v[148:151], v[28:31], v[108:111]
  ds_read_b128 v[144:147], v9 offset:384
  s_waitcnt lgkmcnt(4)
  v_mfma_f32_16x16x32_bf16 v[104:107], v[152:155], v[32:35], v[104:107]
  ds_read_b128 v[148:151], v9 offset:8832
  s_waitcnt lgkmcnt(4)
  v_mfma_f32_16x16x32_bf16 v[108:111], v[156:159], v[32:35], v[108:111]
  ds_read_b128 v[152:155], v9 offset:448
  s_waitcnt lgkmcnt(4)
  v_mfma_f32_16x16x32_bf16 v[104:107], v[160:163], v[36:39], v[104:107]
  ds_read_b128 v[156:159], v9 offset:8896
  s_waitcnt lgkmcnt(4)
  v_mfma_f32_16x16x32_bf16 v[108:111], v[164:167], v[36:39], v[108:111]
  s_waitcnt lgkmcnt(3)
  v_mfma_f32_16x16x32_bf16 v[104:107], v[144:147], v[40:43], v[104:107]
  s_waitcnt lgkmcnt(2)
  v_mfma_f32_16x16x32_bf16 v[108:111], v[148:151], v[40:43], v[108:111]
  s_waitcnt lgkmcnt(1)
  v_mfma_f32_16x16x32_bf16 v[104:107], v[152:155], v[44:47], v[104:107]
  s_waitcnt lgkmcnt(0)
  v_mfma_f32_16x16x32_bf16 v[108:111], v[156:159], v[44:47], v[108:111]
  s_barrier
  s_mul_i32 s27, s26, 16896
  s_add_u32 s27, s27, 50688
  v_add_u32 v9, s27, v1
  ds_read_b128 v[160:163], v9
  ds_read_b128 v[164:167], v9 offset:8448
  ds_read_b128 v[144:147], v9 offset:64
  ds_read_b128 v[148:151], v9 offset:8512
  ds_read_b128 v[152:155], v9 offset:128
  s_waitcnt lgkmcnt(4)
  v_mfma_f32_16x16x32_bf16 v[112:115], v[160:163], v[16:19], 0
  ds_read_b128 v[156:159], v9 offset:8576
  v_max3_f32 v7, v7, v104, v105
  v_max3_f32 v7, v7, v106, v107
  s_waitcnt lgkmcnt(4)
  v_mfma_f32_16x16x32_bf16 v[116:119], v[164:167], v[16:19], 0
  ds_read_b128 v[160:163], v9 offset:192
  v_max3_f32 v7, v7, v108, v109
  v_max3_f32 v7, v7, v110, v111
  s_waitcnt lgkmcnt(4)
  v_mfma_f32_16x16x32_bf16 v[112:115], v[144:147], v[20:23], v[112:115]
  ds_read_b128 v[164:167], v9 offset:8640
  v_mov_b32 v8, v7
  s_nop 1
  v_permlane32_swap_b32 v7, v8
  s_waitcnt lgkmcnt(4)
  v_mfma_f32_16x16x32_bf16 v[116:119], v[148:151], v[20:23], v[116:119]
  ds_read_b128 v[144:147], v9 offset:256
  v_max_f32 v7, v7, v8
  v_mov_b32 v8, v7
  s_waitcnt lgkmcnt(4)
  v_mfma_f32_16x16x32_bf16 v[112:115], v[152:155], v[24:27], v[112:115]
  ds_read_b128 v[148:151], v9 offset:8704
  v_permlane16_swap_b32 v7, v8
  v_max_f32 v7, v7, v8
  s_waitcnt lgkmcnt(4)
  v_mfma_f32_16x16x32_bf16 v[116:119], v[156:159], v[24:27], v[116:119]
  ds_read_b128 v[152:155], v9 offset:320
  v_mul_f32 v8, s40, v7
  v_sub_f32 v6, 0, v8
  s_waitcnt lgkmcnt(4)
  v_mfma_f32_16x16x32_bf16 v[112:115], v[160:163], v[28:31], v[112:115]
  ds_read_b128 v[156:159], v9 offset:8768
  v_fma_f32 v80, v80, s40, v6
  v_fma_f32 v81, v81, s40, v6
  s_waitcnt lgkmcnt(4)
  v_mfma_f32_16x16x32_bf16 v[116:119], v[164:167], v[28:31], v[116:119]
  ds_read_b128 v[160:163], v9 offset:384
  v_fma_f32 v82, v82, s40, v6
  v_fma_f32 v83, v83, s40, v6
  s_waitcnt lgkmcnt(4)
  v_mfma_f32_16x16x32_bf16 v[112:115], v[144:147], v[32:35], v[112:115]
  ds_read_b128 v[164:167], v9 offset:8832
  v_fma_f32 v84, v84, s40, v6
  v_fma_f32 v85, v85, s40, v6
  s_waitcnt lgkmcnt(4)
  v_mfma_f32_16x16x32_bf16 v[116:119], v[148:151], v[32:35], v[116:119]
  ds_read_b128 v[144:147], v9 offset:448
  v_fma_f32 v86, v86, s40, v6
  v_fma_f32 v87, v87, s40, v6
  s_waitcnt lgkmcnt(4)
  v_mfma_f32_16x16x32_bf16 v[112:115], v[152:155], v[36:39], v[112:115]
  ds_read_b128 v[148:151], v9 offset:8896
  v_exp_f32 v80, v80
  v_exp_f32 v81, v81
  s_waitcnt lgkmcnt(4)
  v_mfma_f32_16x16x32_bf16 v[116:119], v[156:159], v[36:39], v[116:119]
  v_exp_f32 v82, v82
  v_exp_f32 v83, v83
  s_waitcnt lgkmcnt(3)
  v_mfma_f32_16x16x32_bf16 v[112:115], v[160:163], v[40:43], v[112:115]
  v_exp_f32 v84, v84
  v_exp_f32 v85, v85
  s_waitcnt lgkmcnt(2)
  v_mfma_f32_16x16x32_bf16 v[116:119], v[164:167], v[40:43], v[116:119]
  v_exp_f32 v86, v86
  v_exp_f32 v87, v87
  s_waitcnt lgkmcnt(1)
  v_mfma_f32_16x16x32_bf16 v[112:115], v[144:147], v[44:47], v[112:115]
  v_cvt_pk_bf16_f32 v48, v80, v81
  v_cvt_pk_bf16_f32 v49, v82, v83
  s_waitcnt lgkmcnt(0)
  v_mfma_f32_16x16x32_bf16 v[116:119], v[148:151], v[44:47], v[116:119]
  v_cvt_pk_bf16_f32 v50, v84, v85
  v_cvt_pk_bf16_f32 v51, v86, v87
  s_barrier
  s_mul_i32 s27, s26, 16896
  s_add_u32 s27, s27, 84480
  v_add_u32 v9, s27, v1
  ds_read_b128 v[152:155], v9
  ds_read_b128 v[156:159], v9 offset:8448
  ds_read_b128 v[160:163], v9 offset:64
  ds_read_b128 v[164:167], v9 offset:8512
  ds_read_b128 v[144:147], v9 offset:128
  s_waitcnt lgkmcnt(4)
  v_mfma_f32_16x16x32_bf16 v[120:123], v[152:155], v[16:19], 0
  ds_read_b128 v[148:151], v9 offset:8576
  v_max3_f32 v7, v7, v112, v113
  v_max3_f32 v7, v7, v114, v115
  s_waitcnt lgkmcnt(4)
  v_mfma_f32_16x16x32_bf16 v[124:127], v[156:159], v[16:19], 0
  ds_read_b128 v[152:155], v9 offset:192
  v_max3_f32 v7, v7, v116, v117
  v_max3_f32 v7, v7, v118, v119
  s_waitcnt lgkmcnt(4)
  v_mfma_f32_16x16x32_bf16 v[120:123], v[160:163], v[20:23], v[120:123]
  ds_read_b128 v[156:159], v9 offset:8640
  v_fma_f32 v88, v88, s40, v6
  v_fma_f32 v89, v89, s40, v6
  s_waitcnt lgkmcnt(4)
  v_mfma_f32_16x16x32_bf16 v[124:127], v[164:167], v[20:23], v[124:127]
  ds_read_b128 v[160:163], v9 offset:256
  v_fma_f32 v90, v90, s40, v6
  v_fma_f32 v91, v91, s40, v6
  s_waitcnt lgkmcnt(4)
  v_mfma_f32_16x16x32_bf16 v[120:123], v[144:147], v[24:27], v[120:123]
  ds_read_b128 v[164:167], v9 offset:8704
  v_fma_f32 v92, v92, s40, v6
  v_fma_f32 v93, v93, s40, v6
  s_waitcnt lgkmcnt(4)
  v_mfma_f32_16x16x32_bf16 v[124:127], v[148:151], v[24:27], v[124:127]
  ds_read_b128 v[144:147], v9 offset:320
  v_fma_f32 v94, v94, s40, v6
  v_fma_f32 v95, v95, s40, v6
  s_waitcnt lgkmcnt(4)
  v_mfma_f32_16x16x32_bf16 v[120:123], v[152:155], v[28:31], v[120:123]
  ds_read_b128 v[148:151], v9 offset:8768
  v_exp_f32 v88, v88
  v_exp_f32 v89, v89
  s_waitcnt lgkmcnt(4)
  v_mfma_f32_16x16x32_bf16 v[124:127], v[156:159], v[28:31], v[124:127]
  ds_read_b128 v[152:155], v9 offset:384
  v_exp_f32 v90, v90
  v_exp_f32 v91, v91
  s_waitcnt lgkmcnt(4)
  v_mfma_f32_16x16x32_bf16 v[120:123], v[160:163], v[32:35], v[120:123]
  ds_read_b128 v[156:159], v9 offset:8832
  v_exp_f32 v92, v92
  v_exp_f32 v93, v93
  s_waitcnt lgkmcnt(4)
  v_mfma_f32_16x16x32_bf16 v[124:127], v[164:167], v[32:35], v[124:127]
  ds_read_b128 v[160:163], v9 offset:448
  v_exp_f32 v94, v94
  v_exp_f32 v95, v95
  s_waitcnt lgkmcnt(4)
  v_mfma_f32_16x16x32_bf16 v[120:123], v[144:147], v[36:39], v[120:123]
  ds_read_b128 v[164:167], v9 offset:8896
  v_cvt_pk_bf16_f32 v52, v88, v89
  v_cvt_pk_bf16_f32 v53, v90, v91
  s_waitcnt lgkmcnt(4)
  v_mfma_f32_16x16x32_bf16 v[124:127], v[148:151], v[36:39], v[124:127]
  v_cvt_pk_bf16_f32 v54, v92, v93
  v_cvt_pk_bf16_f32 v55, v94, v95
  s_waitcnt lgkmcnt(3)
  v_mfma_f32_16x16x32_bf16 v[120:123], v[152:155], v[40:43], v[120:123]
  v_fma_f32 v96, v96, s40, v6
  v_fma_f32 v97, v97, s40, v6
  s_waitcnt lgkmcnt(2)
  v_mfma_f32_16x16x32_bf16 v[124:127], v[156:159], v[40:43], v[124:127]
  v_fma_f32 v98, v98, s40, v6
  v_fma_f32 v99, v99, s40, v6
  s_waitcnt lgkmcnt(1)
  v_mfma_f32_16x16x32_bf16 v[120:123], v[160:163], v[44:47], v[120:123]
  v_fma_f32 v100, v100, s40, v6
  v_fma_f32 v101, v101, s40, v6
  s_waitcnt lgkmcnt(0)
  v_mfma_f32_16x16x32_bf16 v[124:127], v[164:167], v[44:47], v[124:127]
  v_fma_f32 v102, v102, s40, v6
  v_fma_f32 v103, v103, s40, v6
  s_barrier
  s_mul_i32 s27, s26, -118272
  s_add_u32 s27, s27, 118272
  v_add_u32 v9, s27, v1
  ds_read_b128 v[144:147], v9
  ds_read_b128 v[148:151], v9 offset:8448
  ds_read_b128 v[152:155], v9 offset:64
  ds_read_b128 v[156:159], v9 offset:8512
  ds_read_b128 v[160:163], v9 offset:128
  s_waitcnt lgkmcnt(4)
  v_mfma_f32_16x16x32_bf16 v[128:131], v[144:147], v[16:19], 0
  ds_read_b128 v[164:167], v9 offset:8576
  v_max3_f32 v7, v7, v120, v121
  v_max3_f32 v7, v7, v122, v123
  s_waitcnt lgkmcnt(4)
  v_mfma_f32_16x16x32_bf16 v[132:135], v[148:151], v[16:19], 0
  ds_read_b128 v[144:147], v9 offset:192
  v_max3_f32 v7, v7, v124, v125
  v_max3_f32 v7, v7, v126, v127
  s_waitcnt lgkmcnt(4)
  v_mfma_f32_16x16x32_bf16 v[128:131], v[152:155], v[20:23], v[128:131]
  ds_read_b128 v[148:151], v9 offset:8640
  v_exp_f32 v96, v96
  v_exp_f32 v97, v97
  s_waitcnt lgkmcnt(4)
  v_mfma_f32_16x16x32_bf16 v[132:135], v[156:159], v[20:23], v[132:135]
  ds_read_b128 v[152:155], v9 offset:256
  v_exp_f32 v98, v98
  v_exp_f32 v99, v99
  s_waitcnt lgkmcnt(4)
  v_mfma_f32_16x16x32_bf16 v[128:131], v[160:163], v[24:27], v[128:131]
  ds_read_b128 v[156:159], v9 offset:8704
  v_exp_f32 v100, v100
  v_exp_f32 v101, v101
  s_waitcnt lgkmcnt(4)
  v_mfma_f32_16x16x32_bf16 v[132:135], v[164:167], v[24:27], v[132:135]
  ds_read_b128 v[160:163], v9 offset:320
  v_exp_f32 v102, v102
  v_exp_f32 v103, v103
  s_waitcnt lgkmcnt(4)
  v_mfma_f32_16x16x32_bf16 v[128:131], v[144:147], v[28:31], v[128:131]
  ds_read_b128 v[164:167], v9 offset:8768
  v_cvt_pk_bf16_f32 v56, v96, v97
  v_cvt_pk_bf16_f32 v57, v98, v99
  s_waitcnt lgkmcnt(4)
  v_mfma_f32_16x16x32_bf16 v[132:135], v[148:151], v[28:31], v[132:135]
  ds_read_b128 v[144:147], v9 offset:384
  v_cvt_pk_bf16_f32 v58, v100, v101
  v_cvt_pk_bf16_f32 v59, v102, v103
  s_waitcnt lgkmcnt(4)
  v_mfma_f32_16x16x32_bf16 v[128:131], v[152:155], v[32:35], v[128:131]
  ds_read_b128 v[148:151], v9 offset:8832
  v_fma_f32 v104, v104, s40, v6
  v_fma_f32 v105, v105, s40, v6
  s_waitcnt lgkmcnt(4)
  v_mfma_f32_16x16x32_bf16 v[132:135], v[156:159], v[32:35], v[132:135]
  ds_read_b128 v[152:155], v9 offset:448
  v_fma_f32 v106, v106, s40, v6
  v_fma_f32 v107, v107, s40, v6
  s_waitcnt lgkmcnt(4)
  v_mfma_f32_16x16x32_bf16 v[128:131], v[160:163], v[36:39], v[128:131]
  ds_read_b128 v[156:159], v9 offset:8896
  v_fma_f32 v108, v108, s40, v6
  v_fma_f32 v109, v109, s40, v6
  s_waitcnt lgkmcnt(4)
  v_mfma_f32_16x16x32_bf16 v[132:135], v[164:167], v[36:39], v[132:135]
  v_fma_f32 v110, v110, s40, v6
  v_fma_f32 v111, v111, s40, v6
  s_waitcnt lgkmcnt(3)
  v_mfma_f32_16x16x32_bf16 v[128:131], v[144:147], v[40:43], v[128:131]
  v_exp_f32 v104, v104
  v_exp_f32 v105, v105
  s_waitcnt lgkmcnt(2)
  v_mfma_f32_16x16x32_bf16 v[132:135], v[148:151], v[40:43], v[132:135]
  v_exp_f32 v106, v106
  v_exp_f32 v107, v107
  s_waitcnt lgkmcnt(1)
  v_mfma_f32_16x16x32_bf16 v[128:131], v[152:155], v[44:47], v[128:131]
  v_exp_f32 v108, v108
  v_exp_f32 v109, v109
  s_waitcnt lgkmcnt(0)
  v_mfma_f32_16x16x32_bf16 v[132:135], v[156:159], v[44:47], v[132:135]
  v_exp_f32 v110, v110
  v_exp_f32 v111, v111
  s_barrier
  s_mul_i32 s27, s26, 16896
  s_add_u32 s27, s27, 16896
  v_add_u32 v9, s27, v1
  ds_read_b128 v[160:163], v9
  ds_read_b128 v[164:167], v9 offset:8448
  ds_read_b128 v[144:147], v9 offset:64
  ds_read_b128 v[148:151], v9 offset:8512
  ds_read_b128 v[152:155], v9 offset:128
  s_waitcnt lgkmcnt(4)
  v_mfma_f32_16x16x32_bf16 v[136:139], v[160:163], v[16:19], 0
  ds_read_b128 v[156:159], v9 offset:8576
  v_max3_f32 v7, v7, v128, v129
  v_max3_f32 v7, v7, v130, v131
  s_waitcnt lgkmcnt(4)
  v_mfma_f32_16x16x32_bf16 v[140:143], v[164:167], v[16:19], 0
  ds_read_b128 v[160:163], v9 offset:192
  v_max3_f32 v7, v7, v132, v133
  v_max3_f32 v7, v7, v134, v135
  s_waitcnt lgkmcnt(4)
  v_mfma_f32_16x16x32_bf16 v[136:139], v[144:147], v[20:23], v[136:139]
  ds_read_b128 v[164:167], v9 offset:8640
  v_cvt_pk_bf16_f32 v60, v104, v105
  v_cvt_pk_bf16_f32 v61, v106, v107
  s_waitcnt lgkmcnt(4)
  v_mfma_f32_16x16x32_bf16 v[140:143], v[148:151], v[20:23], v[140:143]
  ds_read_b128 v[144:147], v9 offset:256
  v_cvt_pk_bf16_f32 v62, v108, v109
  v_cvt_pk_bf16_f32 v63, v110, v111
  s_waitcnt lgkmcnt(4)
  v_mfma_f32_16x16x32_bf16 v[136:139], v[152:155], v[24:27], v[136:139]
  ds_read_b128 v[148:151], v9 offset:8704
  s_waitcnt lgkmcnt(4)
  v_mfma_f32_16x16x32_bf16 v[140:143], v[156:159], v[24:27], v[140:143]
  ds_read_b128 v[152:155], v9 offset:320
  s_waitcnt lgkmcnt(4)
  v_mfma_f32_16x16x32_bf16 v[136:139], v[160:163], v[28:31], v[136:139]
  ds_read_b128 v[156:159], v9 offset:8768
  s_waitcnt lgkmcnt(4)
  v_mfma_f32_16x16x32_bf16 v[140:143], v[164:167], v[28:31], v[140:143]
  ds_read_b128 v[160:163], v9 offset:384
  s_waitcnt lgkmcnt(4)
  v_mfma_f32_16x16x32_bf16 v[136:139], v[144:147], v[32:35], v[136:139]
  ds_read_b128 v[164:167], v9 offset:8832
  s_waitcnt lgkmcnt(4)
  v_mfma_f32_16x16x32_bf16 v[140:143], v[148:151], v[32:35], v[140:143]
  ds_read_b128 v[144:147], v9 offset:448
  s_waitcnt lgkmcnt(4)
  v_mfma_f32_16x16x32_bf16 v[136:139], v[152:155], v[36:39], v[136:139]
  ds_read_b128 v[148:151], v9 offset:8896
  s_waitcnt lgkmcnt(4)
  v_mfma_f32_16x16x32_bf16 v[140:143], v[156:159], v[36:39], v[140:143]
  s_waitcnt lgkmcnt(3)
  v_mfma_f32_16x16x32_bf16 v[136:139], v[160:163], v[40:43], v[136:139]
  s_waitcnt lgkmcnt(2)
  v_mfma_f32_16x16x32_bf16 v[140:143], v[164:167], v[40:43], v[140:143]
  s_waitcnt lgkmcnt(1)
  v_mfma_f32_16x16x32_bf16 v[136:139], v[144:147], v[44:47], v[136:139]
  s_waitcnt lgkmcnt(0)
  v_mfma_f32_16x16x32_bf16 v[140:143], v[148:151], v[44:47], v[140:143]
  s_barrier
  s_mul_i32 s27, s26, 16896
  s_add_u32 s27, s27, 50688
  v_add_u32 v9, s27, v1
  ds_read_b128 v[152:155], v9
  ds_read_b128 v[156:159], v9 offset:8448
  ds_read_b128 v[160:163], v9 offset:64
  ds_read_b128 v[164:167], v9 offset:8512
  ds_read_b128 v[144:147], v9 offset:128
  s_waitcnt lgkmcnt(4)
  v_mfma_f32_16x16x32_bf16 v[80:83], v[152:155], v[16:19], 0
  ds_read_b128 v[148:151], v9 offset:8576
  v_max3_f32 v7, v7, v136, v137
  v_max3_f32 v7, v7, v138, v139
  s_waitcnt lgkmcnt(4)
  v_mfma_f32_16x16x32_bf16 v[84:87], v[156:159], v[16:19], 0
  ds_read_b128 v[152:155], v9 offset:192
  v_max3_f32 v7, v7, v140, v141
  v_max3_f32 v7, v7, v142, v143
  s_waitcnt lgkmcnt(4)
  v_mfma_f32_16x16x32_bf16 v[80:83], v[160:163], v[20:23], v[80:83]
  ds_read_b128 v[156:159], v9 offset:8640
  v_mov_b32 v8, v7
  s_nop 1
  v_permlane32_swap_b32 v7, v8
  s_waitcnt lgkmcnt(4)
  v_mfma_f32_16x16x32_bf16 v[84:87], v[164:167], v[20:23], v[84:87]
  ds_read_b128 v[160:163], v9 offset:256
  v_max_f32 v7, v7, v8
  v_mov_b32 v8, v7
  s_waitcnt lgkmcnt(4)
  v_mfma_f32_16x16x32_bf16 v[80:83], v[144:147], v[24:27], v[80:83]
  ds_read_b128 v[164:167], v9 offset:8704
  v_permlane16_swap_b32 v7, v8
  v_max_f32 v7, v7, v8
  s_waitcnt lgkmcnt(4)
  v_mfma_f32_16x16x32_bf16 v[84:87], v[148:151], v[24:27], v[84:87]
  ds_read_b128 v[144:147], v9 offset:320
  v_mul_f32 v8, s40, v7
  v_add_f32 v12, v6, v8
  s_waitcnt lgkmcnt(4)
  v_mfma_f32_16x16x32_bf16 v[80:83], v[152:155], v[28:31], v[80:83]
  ds_read_b128 v[148:151], v9 offset:8768
  v_sub_f32 v6, 0, v8
  v_exp_f32 v12, -v12
  s_waitcnt lgkmcnt(4)
  v_mfma_f32_16x16x32_bf16 v[84:87], v[156:159], v[28:31], v[84:87]
  ds_read_b128 v[152:155], v9 offset:384
  v_fma_f32 v112, v112, s40, v6
  v_fma_f32 v113, v113, s40, v6
  s_waitcnt lgkmcnt(4)
  v_mfma_f32_16x16x32_bf16 v[80:83], v[160:163], v[32:35], v[80:83]
  ds_read_b128 v[156:159], v9 offset:8832
  v_fma_f32 v114, v114, s40, v6
  v_fma_f32 v115, v115, s40, v6
  s_waitcnt lgkmcnt(4)
  v_mfma_f32_16x16x32_bf16 v[84:87], v[164:167], v[32:35], v[84:87]
  ds_read_b128 v[160:163], v9 offset:448
  v_fma_f32 v116, v116, s40, v6
  v_fma_f32 v117, v117, s40, v6
  s_waitcnt lgkmcnt(4)
  v_mfma_f32_16x16x32_bf16 v[80:83], v[144:147], v[36:39], v[80:83]
  ds_read_b128 v[164:167], v9 offset:8896
  v_fma_f32 v118, v118, s40, v6
  v_fma_f32 v119, v119, s40, v6
  s_waitcnt lgkmcnt(4)
  v_mfma_f32_16x16x32_bf16 v[84:87], v[148:151], v[36:39], v[84:87]
  v_exp_f32 v112, v112
  v_exp_f32 v113, v113
  s_waitcnt lgkmcnt(3)
  v_mfma_f32_16x16x32_bf16 v[80:83], v[152:155], v[40:43], v[80:83]
  v_exp_f32 v114, v114
  v_exp_f32 v115, v115
  s_waitcnt lgkmcnt(2)
  v_mfma_f32_16x16x32_bf16 v[84:87], v[156:159], v[40:43], v[84:87]
  v_exp_f32 v116, v116
  v_exp_f32 v117, v117
  s_waitcnt lgkmcnt(1)
  v_mfma_f32_16x16x32_bf16 v[80:83], v[160:163], v[44:47], v[80:83]
  v_exp_f32 v118, v118
  v_exp_f32 v119, v119
  s_waitcnt lgkmcnt(0)
  v_mfma_f32_16x16x32_bf16 v[84:87], v[164:167], v[44:47], v[84:87]
  v_cvt_pk_bf16_f32 v64, v112, v113
  v_cvt_pk_bf16_f32 v65, v114, v115
  s_barrier
  s_mul_i32 s27, s26, 16896
  s_add_u32 s27, s27, 84480
  v_add_u32 v9, s27, v1
  ds_read_b128 v[144:147], v9
  ds_read_b128 v[148:151], v9 offset:8448
  ds_read_b128 v[152:155], v9 offset:64
  ds_read_b128 v[156:159], v9 offset:8512
  ds_read_b128 v[160:163], v9 offset:128
  s_waitcnt lgkmcnt(4)
  v_mfma_f32_16x16x32_bf16 v[88:91], v[144:147], v[16:19], 0
  ds_read_b128 v[164:167], v9 offset:8576
  v_max3_f32 v7, v7, v80, v81
  v_max3_f32 v7, v7, v82, v83
  s_waitcnt lgkmcnt(4)
  v_mfma_f32_16x16x32_bf16 v[92:95], v[148:151], v[16:19], 0
  ds_read_b128 v[144:147], v9 offset:192
  v_max3_f32 v7, v7, v84, v85
  v_max3_f32 v7, v7, v86, v87
  s_waitcnt lgkmcnt(4)
  v_mfma_f32_16x16x32_bf16 v[88:91], v[152:155], v[20:23], v[88:91]
  ds_read_b128 v[148:151], v9 offset:8640
  v_cvt_pk_bf16_f32 v66, v116, v117
  v_cvt_pk_bf16_f32 v67, v118, v119
  s_waitcnt lgkmcnt(4)
  v_mfma_f32_16x16x32_bf16 v[92:95], v[156:159], v[20:23], v[92:95]
  ds_read_b128 v[152:155], v9 offset:256
  v_fma_f32 v120, v120, s40, v6
  v_fma_f32 v121, v121, s40, v6
  s_waitcnt lgkmcnt(4)
  v_mfma_f32_16x16x32_bf16 v[88:91], v[160:163], v[24:27], v[88:91]
  ds_read_b128 v[156:159], v9 offset:8704
  v_fma_f32 v122, v122, s40, v6
  v_fma_f32 v123, v123, s40, v6
  s_waitcnt lgkmcnt(4)
  v_mfma_f32_16x16x32_bf16 v[92:95], v[164:167], v[24:27], v[92:95]
  ds_read_b128 v[160:163], v9 offset:320
  v_fma_f32 v124, v124, s40, v6
  v_fma_f32 v125, v125, s40, v6
  s_waitcnt lgkmcnt(4)
  v_mfma_f32_16x16x32_bf16 v[88:91], v[144:147], v[28:31], v[88:91]
  ds_read_b128 v[164:167], v9 offset:8768
  v_fma_f32 v126, v126, s40, v6
  v_fma_f32 v127, v127, s40, v6
  s_waitcnt lgkmcnt(4)
  v_mfma_f32_16x16x32_bf16 v[92:95], v[148:151], v[28:31], v[92:95]
  ds_read_b128 v[144:147], v9 offset:384
  v_exp_f32 v120, v120
  v_exp_f32 v121, v121
  s_waitcnt lgkmcnt(4)
  v_mfma_f32_16x16x32_bf16 v[88:91], v[152:155], v[32:35], v[88:91]
  ds_read_b128 v[148:151], v9 offset:8832
  v_exp_f32 v122, v122
  v_exp_f32 v123, v123
  s_waitcnt lgkmcnt(4)
  v_mfma_f32_16x16x32_bf16 v[92:95], v[156:159], v[32:35], v[92:95]
  ds_read_b128 v[152:155], v9 offset:448
  v_exp_f32 v124, v124
  v_exp_f32 v125, v125
  s_waitcnt lgkmcnt(4)
  v_mfma_f32_16x16x32_bf16 v[88:91], v[160:163], v[36:39], v[88:91]
  ds_read_b128 v[156:159], v9 offset:8896
  v_exp_f32 v126, v126
  v_exp_f32 v127, v127
  s_waitcnt lgkmcnt(4)
  v_mfma_f32_16x16x32_bf16 v[92:95], v[164:167], v[36:39], v[92:95]
  v_cvt_pk_bf16_f32 v68, v120, v121
  v_cvt_pk_bf16_f32 v69, v122, v123
  s_waitcnt lgkmcnt(3)
  v_mfma_f32_16x16x32_bf16 v[88:91], v[144:147], v[40:43], v[88:91]
  v_cvt_pk_bf16_f32 v70, v124, v125
  v_cvt_pk_bf16_f32 v71, v126, v127
  s_waitcnt lgkmcnt(2)
  v_mfma_f32_16x16x32_bf16 v[92:95], v[148:151], v[40:43], v[92:95]
  v_fma_f32 v128, v128, s40, v6
  v_fma_f32 v129, v129, s40, v6
  s_waitcnt lgkmcnt(1)
  v_mfma_f32_16x16x32_bf16 v[88:91], v[152:155], v[44:47], v[88:91]
  v_fma_f32 v130, v130, s40, v6
  v_fma_f32 v131, v131, s40, v6
  s_waitcnt lgkmcnt(0)
  v_mfma_f32_16x16x32_bf16 v[92:95], v[156:159], v[44:47], v[92:95]
  v_fma_f32 v132, v132, s40, v6
  v_fma_f32 v133, v133, s40, v6
  s_barrier
  s_mul_i32 s27, s26, -118272
  s_add_u32 s27, s27, 118272
  v_add_u32 v9, s27, v1
  ds_read_b128 v[160:163], v9
  ds_read_b128 v[164:167], v9 offset:8448
  ds_read_b128 v[144:147], v9 offset:64
  ds_read_b128 v[148:151], v9 offset:8512
  ds_read_b128 v[152:155], v9 offset:128
  s_waitcnt lgkmcnt(4)
  v_mfma_f32_16x16x32_bf16 v[96:99], v[160:163], v[16:19], 0
  ds_read_b128 v[156:159], v9 offset:8576
  v_max3_f32 v7, v7, v88, v89
  v_max3_f32 v7, v7, v90, v91
  s_waitcnt lgkmcnt(4)
  v_mfma_f32_16x16x32_bf16 v[100:103], v[164:167], v[16:19], 0
  ds_read_b128 v[160:163], v9 offset:192
  v_max3_f32 v7, v7, v92, v93
  v_max3_f32 v7, v7, v94, v95
  s_waitcnt lgkmcnt(4)
  v_mfma_f32_16x16x32_bf16 v[96:99], v[144:147], v[20:23], v[96:99]
  ds_read_b128 v[164:167], v9 offset:8640
  v_fma_f32 v134, v134, s40, v6
  v_fma_f32 v135, v135, s40, v6
  s_waitcnt lgkmcnt(4)
  v_mfma_f32_16x16x32_bf16 v[100:103], v[148:151], v[20:23], v[100:103]
  ds_read_b128 v[144:147], v9 offset:256
  v_exp_f32 v128, v128
  v_exp_f32 v129, v129
  s_waitcnt lgkmcnt(4)
  v_mfma_f32_16x16x32_bf16 v[96:99], v[152:155], v[24:27], v[96:99]
  ds_read_b128 v[148:151], v9 offset:8704
  v_exp_f32 v130, v130
  v_exp_f32 v131, v131
  s_waitcnt lgkmcnt(4)
  v_mfma_f32_16x16x32_bf16 v[100:103], v[156:159], v[24:27], v[100:103]
  ds_read_b128 v[152:155], v9 offset:320
  v_exp_f32 v132, v132
  v_exp_f32 v133, v133
  s_waitcnt lgkmcnt(4)
  v_mfma_f32_16x16x32_bf16 v[96:99], v[160:163], v[28:31], v[96:99]
  ds_read_b128 v[156:159], v9 offset:8768
  v_exp_f32 v134, v134
  v_exp_f32 v135, v135
  s_waitcnt lgkmcnt(4)
  v_mfma_f32_16x16x32_bf16 v[100:103], v[164:167], v[28:31], v[100:103]
  ds_read_b128 v[160:163], v9 offset:384
  v_cvt_pk_bf16_f32 v72, v128, v129
  v_cvt_pk_bf16_f32 v73, v130, v131
  s_waitcnt lgkmcnt(4)
  v_mfma_f32_16x16x32_bf16 v[96:99], v[144:147], v[32:35], v[96:99]
  ds_read_b128 v[164:167], v9 offset:8832
  v_cvt_pk_bf16_f32 v74, v132, v133
  v_cvt_pk_bf16_f32 v75, v134, v135
  s_waitcnt lgkmcnt(4)
  v_mfma_f32_16x16x32_bf16 v[100:103], v[148:151], v[32:35], v[100:103]
  ds_read_b128 v[144:147], v9 offset:448
  v_fma_f32 v136, v136, s40, v6
  v_fma_f32 v137, v137, s40, v6
  s_waitcnt lgkmcnt(4)
  v_mfma_f32_16x16x32_bf16 v[96:99], v[152:155], v[36:39], v[96:99]
  ds_read_b128 v[148:151], v9 offset:8896
  v_fma_f32 v138, v138, s40, v6
  v_fma_f32 v139, v139, s40, v6
  s_waitcnt lgkmcnt(4)
  v_mfma_f32_16x16x32_bf16 v[100:103], v[156:159], v[36:39], v[100:103]
  v_fma_f32 v140, v140, s40, v6
  v_fma_f32 v141, v141, s40, v6
  s_waitcnt lgkmcnt(3)
  v_mfma_f32_16x16x32_bf16 v[96:99], v[160:163], v[40:43], v[96:99]
  v_fma_f32 v142, v142, s40, v6
  v_fma_f32 v143, v143, s40, v6
  s_waitcnt lgkmcnt(2)
  v_mfma_f32_16x16x32_bf16 v[100:103], v[164:167], v[40:43], v[100:103]
  v_exp_f32 v136, v136
  v_exp_f32 v137, v137
  s_waitcnt lgkmcnt(1)
  v_mfma_f32_16x16x32_bf16 v[96:99], v[144:147], v[44:47], v[96:99]
  v_exp_f32 v138, v138
  v_exp_f32 v139, v139
  s_waitcnt lgkmcnt(0)
  v_mfma_f32_16x16x32_bf16 v[100:103], v[148:151], v[44:47], v[100:103]
  v_exp_f32 v140, v140
  v_exp_f32 v141, v141
  s_barrier
  s_mul_i32 s27, s26, 16896
  s_add_u32 s27, s27, 16896
  v_add_u32 v9, s27, v1
  ds_read_b128 v[152:155], v9
  ds_read_b128 v[156:159], v9 offset:8448
  ds_read_b128 v[160:163], v9 offset:64
  ds_read_b128 v[164:167], v9 offset:8512
  ds_read_b128 v[144:147], v9 offset:128
  s_waitcnt lgkmcnt(4)
  v_mfma_f32_16x16x32_bf16 v[104:107], v[152:155], v[16:19], 0
  ds_read_b128 v[148:151], v9 offset:8576
  v_max3_f32 v7, v7, v96, v97
  v_max3_f32 v7, v7, v98, v99
  s_waitcnt lgkmcnt(4)
  v_mfma_f32_16x16x32_bf16 v[108:111], v[156:159], v[16:19], 0
  ds_read_b128 v[152:155], v9 offset:192
  v_max3_f32 v7, v7, v100, v101
  v_max3_f32 v7, v7, v102, v103
  s_waitcnt lgkmcnt(4)
  v_mfma_f32_16x16x32_bf16 v[104:107], v[160:163], v[20:23], v[104:107]
  ds_read_b128 v[156:159], v9 offset:8640
  v_exp_f32 v142, v142
  v_exp_f32 v143, v143
  s_waitcnt lgkmcnt(4)
  v_mfma_f32_16x16x32_bf16 v[108:111], v[164:167], v[20:23], v[108:111]
  ds_read_b128 v[160:163], v9 offset:256
  v_cvt_pk_bf16_f32 v76, v136, v137
  v_cvt_pk_bf16_f32 v77, v138, v139
  s_waitcnt lgkmcnt(4)
  v_mfma_f32_16x16x32_bf16 v[104:107], v[144:147], v[24:27], v[104:107]
  ds_read_b128 v[164:167], v9 offset:8704
  v_cvt_pk_bf16_f32 v78, v140, v141
  v_cvt_pk_bf16_f32 v79, v142, v143
  s_waitcnt lgkmcnt(4)
  v_mfma_f32_16x16x32_bf16 v[108:111], v[148:151], v[24:27], v[108:111]
  ds_read_b128 v[144:147], v9 offset:320
  s_waitcnt lgkmcnt(4)
  v_mfma_f32_16x16x32_bf16 v[104:107], v[152:155], v[28:31], v[104:107]
  ds_read_b128 v[148:151], v9 offset:8768
  s_waitcnt lgkmcnt(4)
  v_mfma_f32_16x16x32_bf16 v[108:111], v[156:159], v[28:31], v[108:111]
  ds_read_b128 v[152:155], v9 offset:384
  s_waitcnt lgkmcnt(4)
  v_mfma_f32_16x16x32_bf16 v[104:107], v[160:163], v[32:35], v[104:107]
  ds_read_b128 v[156:159], v9 offset:8832
  s_waitcnt lgkmcnt(4)
  v_mfma_f32_16x16x32_bf16 v[108:111], v[164:167], v[32:35], v[108:111]
  ds_read_b128 v[160:163], v9 offset:448
  s_waitcnt lgkmcnt(4)
  v_mfma_f32_16x16x32_bf16 v[104:107], v[144:147], v[36:39], v[104:107]
  ds_read_b128 v[164:167], v9 offset:8896
  s_waitcnt lgkmcnt(4)
  v_mfma_f32_16x16x32_bf16 v[108:111], v[148:151], v[36:39], v[108:111]
  s_waitcnt lgkmcnt(3)
  v_mfma_f32_16x16x32_bf16 v[104:107], v[152:155], v[40:43], v[104:107]
  s_waitcnt lgkmcnt(2)
  v_mfma_f32_16x16x32_bf16 v[108:111], v[156:159], v[40:43], v[108:111]
  s_waitcnt lgkmcnt(1)
  v_mfma_f32_16x16x32_bf16 v[104:107], v[160:163], v[44:47], v[104:107]
  s_waitcnt lgkmcnt(0)
  v_mfma_f32_16x16x32_bf16 v[108:111], v[164:167], v[44:47], v[108:111]
  s_barrier
  s_mul_i32 s27, s26, 16896
  s_add_u32 s27, s27, 50688
  v_add_u32 v9, s27, v1
  ds_read_b128 v[144:147], v9
  ds_read_b128 v[148:151], v9 offset:8448
  ds_read_b128 v[152:155], v9 offset:64
  ds_read_b128 v[156:159], v9 offset:8512
  ds_read_b128 v[160:163], v9 offset:128
  s_waitcnt lgkmcnt(4)
  v_mfma_f32_16x16x32_bf16 v[112:115], v[144:147], v[16:19], 0
  ds_read_b128 v[164:167], v9 offset:8576
  v_max3_f32 v7, v7, v104, v105
  v_max3_f32 v7, v7, v106, v107
  s_waitcnt lgkmcnt(4)
  v_mfma_f32_16x16x32_bf16 v[116:119], v[148:151], v[16:19], 0
  ds_read_b128 v[144:147], v9 offset:192
  v_max3_f32 v7, v7, v108, v109
  v_max3_f32 v7, v7, v110, v111
  s_waitcnt lgkmcnt(4)
  v_mfma_f32_16x16x32_bf16 v[112:115], v[152:155], v[20:23], v[112:115]
  ds_read_b128 v[148:151], v9 offset:8640
  v_mov_b32 v8, v7
  s_nop 1
  v_permlane32_swap_b32 v7, v8
  s_waitcnt lgkmcnt(4)
  v_mfma_f32_16x16x32_bf16 v[116:119], v[156:159], v[20:23], v[116:119]
  ds_read_b128 v[152:155], v9 offset:256
  v_max_f32 v7, v7, v8
  v_mov_b32 v8, v7
  s_waitcnt lgkmcnt(4)
  v_mfma_f32_16x16x32_bf16 v[112:115], v[160:163], v[24:27], v[112:115]
  ds_read_b128 v[156:159], v9 offset:8704
  v_permlane16_swap_b32 v7, v8
  v_max_f32 v7, v7, v8
  s_waitcnt lgkmcnt(4)
  v_mfma_f32_16x16x32_bf16 v[116:119], v[164:167], v[24:27], v[116:119]
  ds_read_b128 v[160:163], v9 offset:320
  v_mul_f32 v8, s40, v7
  v_add_f32 v13, v6, v8
  s_waitcnt lgkmcnt(4)
  v_mfma_f32_16x16x32_bf16 v[112:115], v[144:147], v[28:31], v[112:115]
  ds_read_b128 v[164:167], v9 offset:8768
  v_sub_f32 v6, 0, v8
  v_exp_f32 v13, -v13
  s_waitcnt lgkmcnt(4)
  v_mfma_f32_16x16x32_bf16 v[116:119], v[148:151], v[28:31], v[116:119]
  ds_read_b128 v[144:147], v9 offset:384
  v_fma_f32 v80, v80, s40, v6
  v_fma_f32 v81, v81, s40, v6
  s_waitcnt lgkmcnt(4)
  v_mfma_f32_16x16x32_bf16 v[112:115], v[152:155], v[32:35], v[112:115]
  ds_read_b128 v[148:151], v9 offset:8832
  v_fma_f32 v82, v82, s40, v6
  v_fma_f32 v83, v83, s40, v6
  s_waitcnt lgkmcnt(4)
  v_mfma_f32_16x16x32_bf16 v[116:119], v[156:159], v[32:35], v[116:119]
  ds_read_b128 v[152:155], v9 offset:448
  v_fma_f32 v84, v84, s40, v6
  v_fma_f32 v85, v85, s40, v6
  s_waitcnt lgkmcnt(4)
  v_mfma_f32_16x16x32_bf16 v[112:115], v[160:163], v[36:39], v[112:115]
  ds_read_b128 v[156:159], v9 offset:8896
  v_fma_f32 v86, v86, s40, v6
  v_fma_f32 v87, v87, s40, v6
  s_waitcnt lgkmcnt(4)
  v_mfma_f32_16x16x32_bf16 v[116:119], v[164:167], v[36:39], v[116:119]
  v_exp_f32 v80, v80
  v_exp_f32 v81, v81
  s_waitcnt lgkmcnt(3)
  v_mfma_f32_16x16x32_bf16 v[112:115], v[144:147], v[40:43], v[112:115]
  v_exp_f32 v82, v82
  v_exp_f32 v83, v83
  s_waitcnt lgkmcnt(2)
  v_mfma_f32_16x16x32_bf16 v[116:119], v[148:151], v[40:43], v[116:119]
  v_exp_f32 v84, v84
  v_exp_f32 v85, v85
  s_waitcnt lgkmcnt(1)
  v_mfma_f32_16x16x32_bf16 v[112:115], v[152:155], v[44:47], v[112:115]
  v_exp_f32 v86, v86
  v_exp_f32 v87, v87
  s_waitcnt lgkmcnt(0)
  v_mfma_f32_16x16x32_bf16 v[116:119], v[156:159], v[44:47], v[116:119]
  v_cvt_pk_bf16_f32 v80, v80, v81
  v_cvt_pk_bf16_f32 v81, v82, v83
  s_barrier
  s_mul_i32 s27, s26, 16896
  s_add_u32 s27, s27, 84480
  v_add_u32 v9, s27, v1
  ds_read_b128 v[160:163], v9
  ds_read_b128 v[164:167], v9 offset:8448
  ds_read_b128 v[144:147], v9 offset:64
  ds_read_b128 v[148:151], v9 offset:8512
  ds_read_b128 v[152:155], v9 offset:128
  s_waitcnt lgkmcnt(4)
  v_mfma_f32_16x16x32_bf16 v[120:123], v[160:163], v[16:19], 0
  ds_read_b128 v[156:159], v9 offset:8576
  v_max3_f32 v7, v7, v112, v113
  v_max3_f32 v7, v7, v114, v115
  s_waitcnt lgkmcnt(4)
  v_mfma_f32_16x16x32_bf16 v[124:127], v[164:167], v[16:19], 0
  ds_read_b128 v[160:163], v9 offset:192
  v_max3_f32 v7, v7, v116, v117
  v_max3_f32 v7, v7, v118, v119
  s_waitcnt lgkmcnt(4)
  v_mfma_f32_16x16x32_bf16 v[120:123], v[144:147], v[20:23], v[120:123]
  ds_read_b128 v[164:167], v9 offset:8640
  v_cvt_pk_bf16_f32 v82, v84, v85
  v_cvt_pk_bf16_f32 v83, v86, v87
  s_waitcnt lgkmcnt(4)
  v_mfma_f32_16x16x32_bf16 v[124:127], v[148:151], v[20:23], v[124:127]
  ds_read_b128 v[144:147], v9 offset:256
  v_fma_f32 v88, v88, s40, v6
  v_fma_f32 v89, v89, s40, v6
  s_waitcnt lgkmcnt(4)
  v_mfma_f32_16x16x32_bf16 v[120:123], v[152:155], v[24:27], v[120:123]
  ds_read_b128 v[148:151], v9 offset:8704
  v_fma_f32 v90, v90, s40, v6
  v_fma_f32 v91, v91, s40, v6
  s_waitcnt lgkmcnt(4)
  v_mfma_f32_16x16x32_bf16 v[124:127], v[156:159], v[24:27], v[124:127]
  ds_read_b128 v[152:155], v9 offset:320
  v_fma_f32 v92, v92, s40, v6
  v_fma_f32 v93, v93, s40, v6
  s_waitcnt lgkmcnt(4)
  v_mfma_f32_16x16x32_bf16 v[120:123], v[160:163], v[28:31], v[120:123]
  ds_read_b128 v[156:159], v9 offset:8768
  v_fma_f32 v94, v94, s40, v6
  v_fma_f32 v95, v95, s40, v6
  s_waitcnt lgkmcnt(4)
  v_mfma_f32_16x16x32_bf16 v[124:127], v[164:167], v[28:31], v[124:127]
  ds_read_b128 v[160:163], v9 offset:384
  v_exp_f32 v88, v88
  v_exp_f32 v89, v89
  s_waitcnt lgkmcnt(4)
  v_mfma_f32_16x16x32_bf16 v[120:123], v[144:147], v[32:35], v[120:123]
  ds_read_b128 v[164:167], v9 offset:8832
  v_exp_f32 v90, v90
  v_exp_f32 v91, v91
  s_waitcnt lgkmcnt(4)
  v_mfma_f32_16x16x32_bf16 v[124:127], v[148:151], v[32:35], v[124:127]
  ds_read_b128 v[144:147], v9 offset:448
  v_exp_f32 v92, v92
  v_exp_f32 v93, v93
  s_waitcnt lgkmcnt(4)
  v_mfma_f32_16x16x32_bf16 v[120:123], v[152:155], v[36:39], v[120:123]
  ds_read_b128 v[148:151], v9 offset:8896
  v_exp_f32 v94, v94
  v_exp_f32 v95, v95
  s_waitcnt lgkmcnt(4)
  v_mfma_f32_16x16x32_bf16 v[124:127], v[156:159], v[36:39], v[124:127]
  v_cvt_pk_bf16_f32 v84, v88, v89
  v_cvt_pk_bf16_f32 v85, v90, v91
  s_waitcnt lgkmcnt(3)
  v_mfma_f32_16x16x32_bf16 v[120:123], v[160:163], v[40:43], v[120:123]
  v_cvt_pk_bf16_f32 v86, v92, v93
  v_cvt_pk_bf16_f32 v87, v94, v95
  s_waitcnt lgkmcnt(2)
  v_mfma_f32_16x16x32_bf16 v[124:127], v[164:167], v[40:43], v[124:127]
  v_fma_f32 v96, v96, s40, v6
  v_fma_f32 v97, v97, s40, v6
  s_waitcnt lgkmcnt(1)
  v_mfma_f32_16x16x32_bf16 v[120:123], v[144:147], v[44:47], v[120:123]
  v_fma_f32 v98, v98, s40, v6
  v_fma_f32 v99, v99, s40, v6
  s_waitcnt lgkmcnt(0)
  v_mfma_f32_16x16x32_bf16 v[124:127], v[148:151], v[44:47], v[124:127]
  v_fma_f32 v100, v100, s40, v6
  v_fma_f32 v101, v101, s40, v6
  s_barrier
  s_mul_i32 s27, s26, -118272
  s_add_u32 s27, s27, 118272
  v_add_u32 v9, s27, v1
  ds_read_b128 v[152:155], v9
  ds_read_b128 v[156:159], v9 offset:8448
  ds_read_b128 v[160:163], v9 offset:64
  ds_read_b128 v[164:167], v9 offset:8512
  ds_read_b128 v[144:147], v9 offset:128
  s_waitcnt lgkmcnt(4)
  v_mfma_f32_16x16x32_bf16 v[128:131], v[152:155], v[16:19], 0
  ds_read_b128 v[148:151], v9 offset:8576
  v_max3_f32 v7, v7, v120, v121
  v_max3_f32 v7, v7, v122, v123
  s_waitcnt lgkmcnt(4)
  v_mfma_f32_16x16x32_bf16 v[132:135], v[156:159], v[16:19], 0
  ds_read_b128 v[152:155], v9 offset:192
  v_max3_f32 v7, v7, v124, v125
  v_max3_f32 v7, v7, v126, v127
  s_waitcnt lgkmcnt(4)
  v_mfma_f32_16x16x32_bf16 v[128:131], v[160:163], v[20:23], v[128:131]
  ds_read_b128 v[156:159], v9 offset:8640
  v_fma_f32 v102, v102, s40, v6
  v_fma_f32 v103, v103, s40, v6
  s_waitcnt lgkmcnt(4)
  v_mfma_f32_16x16x32_bf16 v[132:135], v[164:167], v[20:23], v[132:135]
  ds_read_b128 v[160:163], v9 offset:256
  v_exp_f32 v96, v96
  v_exp_f32 v97, v97
  s_waitcnt lgkmcnt(4)
  v_mfma_f32_16x16x32_bf16 v[128:131], v[144:147], v[24:27], v[128:131]
  ds_read_b128 v[164:167], v9 offset:8704
  v_exp_f32 v98, v98
  v_exp_f32 v99, v99
  s_waitcnt lgkmcnt(4)
  v_mfma_f32_16x16x32_bf16 v[132:135], v[148:151], v[24:27], v[132:135]
  ds_read_b128 v[144:147], v9 offset:320
  v_exp_f32 v100, v100
  v_exp_f32 v101, v101
  s_waitcnt lgkmcnt(4)
  v_mfma_f32_16x16x32_bf16 v[128:131], v[152:155], v[28:31], v[128:131]
  ds_read_b128 v[148:151], v9 offset:8768
  v_exp_f32 v102, v102
  v_exp_f32 v103, v103
  s_waitcnt lgkmcnt(4)
  v_mfma_f32_16x16x32_bf16 v[132:135], v[156:159], v[28:31], v[132:135]
  ds_read_b128 v[152:155], v9 offset:384
  v_cvt_pk_bf16_f32 v88, v96, v97
  v_cvt_pk_bf16_f32 v89, v98, v99
  s_waitcnt lgkmcnt(4)
  v_mfma_f32_16x16x32_bf16 v[128:131], v[160:163], v[32:35], v[128:131]
  ds_read_b128 v[156:159], v9 offset:8832
  v_cvt_pk_bf16_f32 v90, v100, v101
  v_cvt_pk_bf16_f32 v91, v102, v103
  s_waitcnt lgkmcnt(4)
  v_mfma_f32_16x16x32_bf16 v[132:135], v[164:167], v[32:35], v[132:135]
  ds_read_b128 v[160:163], v9 offset:448
  v_fma_f32 v104, v104, s40, v6
  v_fma_f32 v105, v105, s40, v6
  s_waitcnt lgkmcnt(4)
  v_mfma_f32_16x16x32_bf16 v[128:131], v[144:147], v[36:39], v[128:131]
  ds_read_b128 v[164:167], v9 offset:8896
  v_fma_f32 v106, v106, s40, v6
  v_fma_f32 v107, v107, s40, v6
  s_waitcnt lgkmcnt(4)
  v_mfma_f32_16x16x32_bf16 v[132:135], v[148:151], v[36:39], v[132:135]
  v_fma_f32 v108, v108, s40, v6
  v_fma_f32 v109, v109, s40, v6
  s_waitcnt lgkmcnt(3)
  v_mfma_f32_16x16x32_bf16 v[128:131], v[152:155], v[40:43], v[128:131]
  v_fma_f32 v110, v110, s40, v6
  v_fma_f32 v111, v111, s40, v6
  s_waitcnt lgkmcnt(2)
  v_mfma_f32_16x16x32_bf16 v[132:135], v[156:159], v[40:43], v[132:135]
  v_exp_f32 v104, v104
  v_exp_f32 v105, v105
  s_waitcnt lgkmcnt(1)
  v_mfma_f32_16x16x32_bf16 v[128:131], v[160:163], v[44:47], v[128:131]
  v_exp_f32 v106, v106
  v_exp_f32 v107, v107
  s_waitcnt lgkmcnt(0)
  v_mfma_f32_16x16x32_bf16 v[132:135], v[164:167], v[44:47], v[132:135]
  v_exp_f32 v108, v108
  v_exp_f32 v109, v109
  s_barrier
  s_mul_i32 s27, s26, 16896
  s_add_u32 s27, s27, 16896
  v_add_u32 v9, s27, v1
  ds_read_b128 v[144:147], v9
  ds_read_b128 v[148:151], v9 offset:8448
  ds_read_b128 v[152:155], v9 offset:64
  ds_read_b128 v[156:159], v9 offset:8512
  ds_read_b128 v[160:163], v9 offset:128
  s_waitcnt lgkmcnt(4)
  v_mfma_f32_16x16x32_bf16 v[136:139], v[144:147], v[16:19], 0
  ds_read_b128 v[164:167], v9 offset:8576
  v_max3_f32 v7, v7, v128, v129
  v_max3_f32 v7, v7, v130, v131
  s_waitcnt lgkmcnt(4)
  v_mfma_f32_16x16x32_bf16 v[140:143], v[148:151], v[16:19], 0
  ds_read_b128 v[144:147], v9 offset:192
  v_max3_f32 v7, v7, v132, v133
  v_max3_f32 v7, v7, v134, v135
  s_waitcnt lgkmcnt(4)
  v_mfma_f32_16x16x32_bf16 v[136:139], v[152:155], v[20:23], v[136:139]
  ds_read_b128 v[148:151], v9 offset:8640
  v_exp_f32 v110, v110
  v_exp_f32 v111, v111
  s_waitcnt lgkmcnt(4)
  v_mfma_f32_16x16x32_bf16 v[140:143], v[156:159], v[20:23], v[140:143]
  ds_read_b128 v[152:155], v9 offset:256
  v_cvt_pk_bf16_f32 v92, v104, v105
  v_cvt_pk_bf16_f32 v93, v106, v107
  s_waitcnt lgkmcnt(4)
  v_mfma_f32_16x16x32_bf16 v[136:139], v[160:163], v[24:27], v[136:139]
  ds_read_b128 v[156:159], v9 offset:8704
  v_cvt_pk_bf16_f32 v94, v108, v109
  v_cvt_pk_bf16_f32 v95, v110, v111
  s_waitcnt lgkmcnt(4)
  v_mfma_f32_16x16x32_bf16 v[140:143], v[164:167], v[24:27], v[140:143]
  ds_read_b128 v[160:163], v9 offset:320
  s_waitcnt lgkmcnt(4)
  v_mfma_f32_16x16x32_bf16 v[136:139], v[144:147], v[28:31], v[136:139]
  ds_read_b128 v[164:167], v9 offset:8768
  s_waitcnt lgkmcnt(4)
  v_mfma_f32_16x16x32_bf16 v[140:143], v[148:151], v[28:31], v[140:143]
  ds_read_b128 v[144:147], v9 offset:384
  s_waitcnt lgkmcnt(4)
  v_mfma_f32_16x16x32_bf16 v[136:139], v[152:155], v[32:35], v[136:139]
  ds_read_b128 v[148:151], v9 offset:8832
  s_waitcnt lgkmcnt(4)
  v_mfma_f32_16x16x32_bf16 v[140:143], v[156:159], v[32:35], v[140:143]
  ds_read_b128 v[152:155], v9 offset:448
  s_waitcnt lgkmcnt(4)
  v_mfma_f32_16x16x32_bf16 v[136:139], v[160:163], v[36:39], v[136:139]
  ds_read_b128 v[156:159], v9 offset:8896
  s_waitcnt lgkmcnt(4)
  v_mfma_f32_16x16x32_bf16 v[140:143], v[164:167], v[36:39], v[140:143]
  s_waitcnt lgkmcnt(3)
  v_mfma_f32_16x16x32_bf16 v[136:139], v[144:147], v[40:43], v[136:139]
  s_waitcnt lgkmcnt(2)
  v_mfma_f32_16x16x32_bf16 v[140:143], v[148:151], v[40:43], v[140:143]
  s_waitcnt lgkmcnt(1)
  v_mfma_f32_16x16x32_bf16 v[136:139], v[152:155], v[44:47], v[136:139]
  s_waitcnt lgkmcnt(0)
  v_mfma_f32_16x16x32_bf16 v[140:143], v[156:159], v[44:47], v[140:143]
  v_mov_b32 v28, 0x3f803f80
  v_mov_b32 v29, 0x3f803f80
  v_mov_b32 v30, 0x3f803f80
  v_mov_b32 v31, 0x3f803f80
  s_nop 1
  v_max3_f32 v7, v7, v136, v137
  v_max3_f32 v7, v7, v138, v139
  v_max3_f32 v7, v7, v140, v141
  v_max3_f32 v7, v7, v142, v143
  v_mov_b32 v8, v7
  s_nop 0
  s_nop 0
  v_permlane32_swap_b32 v7, v8
  v_max_f32 v7, v7, v8
  v_mov_b32 v8, v7
  s_nop 0
  s_nop 0
  v_permlane16_swap_b32 v7, v8
  v_max_f32 v7, v7, v8
  v_mul_f32 v8, s40, v7
  v_add_f32 v3, v6, v8
  v_sub_f32 v6, 0, v8
  v_exp_f32 v3, -v3
  v_fma_f32 v112, v112, s40, v6
  v_fma_f32 v113, v113, s40, v6
  v_fma_f32 v114, v114, s40, v6
  v_fma_f32 v115, v115, s40, v6
  v_fma_f32 v116, v116, s40, v6
  v_fma_f32 v117, v117, s40, v6
  v_fma_f32 v118, v118, s40, v6
  v_fma_f32 v119, v119, s40, v6
  v_exp_f32 v112, v112
  v_exp_f32 v113, v113
  v_exp_f32 v114, v114
  v_exp_f32 v115, v115
  v_exp_f32 v116, v116
  v_exp_f32 v117, v117
  v_exp_f32 v118, v118
  v_exp_f32 v119, v119
  v_cvt_pk_bf16_f32 v96, v112, v113
  v_cvt_pk_bf16_f32 v97, v114, v115
  v_cvt_pk_bf16_f32 v98, v116, v117
  v_cvt_pk_bf16_f32 v99, v118, v119
  v_fma_f32 v120, v120, s40, v6
  v_fma_f32 v121, v121, s40, v6
  v_fma_f32 v122, v122, s40, v6
  v_fma_f32 v123, v123, s40, v6
  v_fma_f32 v124, v124, s40, v6
  v_fma_f32 v125, v125, s40, v6
  s_lshl_b32 s27, s25, 12
  s_add_u32 s27, s27, 140288
  v_add_u32 v14, s27, v5
  s_lshl_b32 s27, s25, 9
  s_add_u32 s27, s27, 160768
  v_lshlrev_b32 v15, 3, v0
  v_add_u32 v15, s27, v15
  s_barrier
  v_add_u32 v9, 50688, v2
  v_add_u32 v8, 67584, v2
  ds_read_b64_tr_b16 v[160:161], v9
  ds_read_b64_tr_b16 v[162:163], v9 offset:256
  ds_read_b64_tr_b16 v[164:165], v9 offset:32
  ds_read_b64_tr_b16 v[166:167], v9 offset:288
  ds_read_b64_tr_b16 v[144:145], v9 offset:64
  ds_read_b64_tr_b16 v[146:147], v9 offset:320
  ds_read_b64_tr_b16 v[148:149], v9 offset:96
  ds_read_b64_tr_b16 v[150:151], v9 offset:352
  ds_read_b64_tr_b16 v[152:153], v9 offset:8448
  ds_read_b64_tr_b16 v[154:155], v9 offset:8704
  s_waitcnt lgkmcnt(8)
  v_mfma_f32_16x16x32_bf16 v[32:35], v[160:163], v[48:51], 0
  v_fma_f32 v126, v126, s40, v6
  v_fma_f32 v127, v127, s40, v6
  ds_read_b64_tr_b16 v[156:157], v9 offset:8480
  ds_read_b64_tr_b16 v[158:159], v9 offset:8736
  s_waitcnt lgkmcnt(8)
  v_mfma_f32_16x16x32_bf16 v[36:39], v[164:167], v[48:51], 0
  v_exp_f32 v120, v120
  v_exp_f32 v121, v121
  ds_read_b64_tr_b16 v[160:161], v9 offset:8512
  ds_read_b64_tr_b16 v[162:163], v9 offset:8768
  s_waitcnt lgkmcnt(8)
  v_mfma_f32_16x16x32_bf16 v[40:43], v[144:147], v[48:51], 0
  v_exp_f32 v122, v122
  v_exp_f32 v123, v123
  ds_read_b64_tr_b16 v[164:165], v9 offset:8544
  ds_read_b64_tr_b16 v[166:167], v9 offset:8800
  s_waitcnt lgkmcnt(8)
  v_mfma_f32_16x16x32_bf16 v[44:47], v[148:151], v[48:51], 0
  v_mfma_f32_16x16x32_bf16 v[24:27], v[28:31], v[48:51], 0
  v_exp_f32 v124, v124
  v_exp_f32 v125, v125
  ds_read_b64_tr_b16 v[144:145], v8
  ds_read_b64_tr_b16 v[146:147], v8 offset:256
  s_waitcnt lgkmcnt(8)
  v_mfma_f32_16x16x32_bf16 v[32:35], v[152:155], v[52:55], v[32:35]
  v_exp_f32 v126, v126
  v_exp_f32 v127, v127
  ds_read_b64_tr_b16 v[148:149], v8 offset:32
  ds_read_b64_tr_b16 v[150:151], v8 offset:288
  s_waitcnt lgkmcnt(8)
  v_mfma_f32_16x16x32_bf16 v[36:39], v[156:159], v[52:55], v[36:39]
  v_cvt_pk_bf16_f32 v100, v120, v121
  v_cvt_pk_bf16_f32 v101, v122, v123
  ds_read_b64_tr_b16 v[152:153], v8 offset:64
  ds_read_b64_tr_b16 v[154:155], v8 offset:320
  s_waitcnt lgkmcnt(8)
  v_mfma_f32_16x16x32_bf16 v[40:43], v[160:163], v[52:55], v[40:43]
  v_cvt_pk_bf16_f32 v102, v124, v125
  v_cvt_pk_bf16_f32 v103, v126, v127
  ds_read_b64_tr_b16 v[156:157], v8 offset:96
  ds_read_b64_tr_b16 v[158:159], v8 offset:352
  s_waitcnt lgkmcnt(8)
  v_mfma_f32_16x16x32_bf16 v[44:47], v[164:167], v[52:55], v[44:47]
  v_mfma_f32_16x16x32_bf16 v[24:27], v[28:31], v[52:55], v[24:27]
  v_fma_f32 v128, v128, s40, v6
  v_fma_f32 v129, v129, s40, v6
  ds_read_b64_tr_b16 v[160:161], v8 offset:8448
  ds_read_b64_tr_b16 v[162:163], v8 offset:8704
  s_waitcnt lgkmcnt(8)
  v_mfma_f32_16x16x32_bf16 v[32:35], v[144:147], v[56:59], v[32:35]
  v_fma_f32 v130, v130, s40, v6
  v_fma_f32 v131, v131, s40, v6
  ds_read_b64_tr_b16 v[164:165], v8 offset:8480
  ds_read_b64_tr_b16 v[166:167], v8 offset:8736
  s_waitcnt lgkmcnt(8)
  v_mfma_f32_16x16x32_bf16 v[36:39], v[148:151], v[56:59], v[36:39]
  v_fma_f32 v132, v132, s40, v6
  v_fma_f32 v133, v133, s40, v6
  ds_read_b64_tr_b16 v[144:145], v8 offset:8512
  ds_read_b64_tr_b16 v[146:147], v8 offset:8768
  s_waitcnt lgkmcnt(8)
  v_mfma_f32_16x16x32_bf16 v[40:43], v[152:155], v[56:59], v[40:43]
  v_fma_f32 v134, v134, s40, v6
  v_fma_f32 v135, v135, s40, v6
  ds_read_b64_tr_b16 v[148:149], v8 offset:8544
  ds_read_b64_tr_b16 v[150:151], v8 offset:8800
  s_waitcnt lgkmcnt(8)
  v_mfma_f32_16x16x32_bf16 v[44:47], v[156:159], v[56:59], v[44:47]
  v_mfma_f32_16x16x32_bf16 v[24:27], v[28:31], v[56:59], v[24:27]
  v_exp_f32 v128, v128
  v_exp_f32 v129, v129
  s_waitcnt lgkmcnt(6)
  v_mfma_f32_16x16x32_bf16 v[32:35], v[160:163], v[60:63], v[32:35]
  v_exp_f32 v130, v130
  v_exp_f32 v131, v131
  s_waitcnt lgkmcnt(4)
  v_mfma_f32_16x16x32_bf16 v[36:39], v[164:167], v[60:63], v[36:39]
  v_exp_f32 v132, v132
  v_exp_f32 v133, v133
  s_waitcnt lgkmcnt(2)
  v_mfma_f32_16x16x32_bf16 v[40:43], v[144:147], v[60:63], v[40:43]
  v_exp_f32 v134, v134
  v_exp_f32 v135, v135
  s_waitcnt lgkmcnt(0)
  v_mfma_f32_16x16x32_bf16 v[44:47], v[148:151], v[60:63], v[44:47]
  v_mfma_f32_16x16x32_bf16 v[24:27], v[28:31], v[60:63], v[24:27]
  v_cvt_pk_bf16_f32 v104, v128, v129
  v_cvt_pk_bf16_f32 v105, v130, v131
  s_barrier
  v_add_u32 v9, 84480, v2
  v_add_u32 v8, 101376, v2
  ds_read_b64_tr_b16 v[152:153], v9
  ds_read_b64_tr_b16 v[154:155], v9 offset:256
  ds_read_b64_tr_b16 v[156:157], v9 offset:32
  ds_read_b64_tr_b16 v[158:159], v9 offset:288
  ds_read_b64_tr_b16 v[160:161], v9 offset:64
  ds_read_b64_tr_b16 v[162:163], v9 offset:320
  ds_read_b64_tr_b16 v[164:165], v9 offset:96
  ds_read_b64_tr_b16 v[166:167], v9 offset:352
  v_mul_f32 v32, v32, v12
  v_mul_f32 v33, v33, v12
  v_mul_f32 v34, v34, v12
  v_mul_f32 v35, v35, v12
  v_mul_f32 v36, v36, v12
  v_mul_f32 v37, v37, v12
  v_mul_f32 v38, v38, v12
  v_mul_f32 v39, v39, v12
  v_mul_f32 v40, v40, v12
  v_mul_f32 v41, v41, v12
  v_mul_f32 v42, v42, v12
  v_mul_f32 v43, v43, v12
  v_mul_f32 v44, v44, v12
  v_mul_f32 v45, v45, v12
  v_mul_f32 v46, v46, v12
  v_mul_f32 v47, v47, v12
  v_mul_f32 v24, v24, v12
  ds_read_b64_tr_b16 v[144:145], v9 offset:8448
  ds_read_b64_tr_b16 v[146:147], v9 offset:8704
  s_waitcnt lgkmcnt(8)
  v_mfma_f32_16x16x32_bf16 v[32:35], v[152:155], v[64:67], v[32:35]
  v_cvt_pk_bf16_f32 v106, v132, v133
  v_cvt_pk_bf16_f32 v107, v134, v135
  ds_read_b64_tr_b16 v[148:149], v9 offset:8480
  ds_read_b64_tr_b16 v[150:151], v9 offset:8736
  s_waitcnt lgkmcnt(8)
  v_mfma_f32_16x16x32_bf16 v[36:39], v[156:159], v[64:67], v[36:39]
  v_fma_f32 v136, v136, s40, v6
  v_fma_f32 v137, v137, s40, v6
  ds_read_b64_tr_b16 v[152:153], v9 offset:8512
  ds_read_b64_tr_b16 v[154:155], v9 offset:8768
  s_waitcnt lgkmcnt(8)
  v_mfma_f32_16x16x32_bf16 v[40:43], v[160:163], v[64:67], v[40:43]
  v_fma_f32 v138, v138, s40, v6
  v_fma_f32 v139, v139, s40, v6
  ds_read_b64_tr_b16 v[156:157], v9 offset:8544
  ds_read_b64_tr_b16 v[158:159], v9 offset:8800
  s_waitcnt lgkmcnt(8)
  v_mfma_f32_16x16x32_bf16 v[44:47], v[164:167], v[64:67], v[44:47]
  v_mfma_f32_16x16x32_bf16 v[24:27], v[28:31], v[64:67], v[24:27]
  v_fma_f32 v140, v140, s40, v6
  v_fma_f32 v141, v141, s40, v6
  ds_read_b64_tr_b16 v[160:161], v8
  ds_read_b64_tr_b16 v[162:163], v8 offset:256
  s_waitcnt lgkmcnt(8)
  v_mfma_f32_16x16x32_bf16 v[32:35], v[144:147], v[68:71], v[32:35]
  v_fma_f32 v142, v142, s40, v6
  v_fma_f32 v143, v143, s40, v6
  ds_read_b64_tr_b16 v[164:165], v8 offset:32
  ds_read_b64_tr_b16 v[166:167], v8 offset:288
  s_waitcnt lgkmcnt(8)
  v_mfma_f32_16x16x32_bf16 v[36:39], v[148:151], v[68:71], v[36:39]
  v_exp_f32 v136, v136
  v_exp_f32 v137, v137
  ds_read_b64_tr_b16 v[144:145], v8 offset:64
  ds_read_b64_tr_b16 v[146:147], v8 offset:320
  s_waitcnt lgkmcnt(8)
  v_mfma_f32_16x16x32_bf16 v[40:43], v[152:155], v[68:71], v[40:43]
  v_exp_f32 v138, v138
  v_exp_f32 v139, v139
  ds_read_b64_tr_b16 v[148:149], v8 offset:96
  ds_read_b64_tr_b16 v[150:151], v8 offset:352
  s_waitcnt lgkmcnt(8)
  v_mfma_f32_16x16x32_bf16 v[44:47], v[156:159], v[68:71], v[44:47]
  v_mfma_f32_16x16x32_bf16 v[24:27], v[28:31], v[68:71], v[24:27]
  v_exp_f32 v140, v140
  v_exp_f32 v141, v141
  ds_read_b64_tr_b16 v[152:153], v8 offset:8448
  ds_read_b64_tr_b16 v[154:155], v8 offset:8704
  s_waitcnt lgkmcnt(8)
  v_mfma_f32_16x16x32_bf16 v[32:35], v[160:163], v[72:75], v[32:35]
  v_exp_f32 v142, v142
  v_exp_f32 v143, v143
  ds_read_b64_tr_b16 v[156:157], v8 offset:8480
  ds_read_b64_tr_b16 v[158:159], v8 offset:8736
  s_waitcnt lgkmcnt(8)
  v_mfma_f32_16x16x32_bf16 v[36:39], v[164:167], v[72:75], v[36:39]
  v_cvt_pk_bf16_f32 v108, v136, v137
  v_cvt_pk_bf16_f32 v109, v138, v139
  ds_read_b64_tr_b16 v[160:161], v8 offset:8512
  ds_read_b64_tr_b16 v[162:163], v8 offset:8768
  s_waitcnt lgkmcnt(8)
  v_mfma_f32_16x16x32_bf16 v[40:43], v[144:147], v[72:75], v[40:43]
  v_cvt_pk_bf16_f32 v110, v140, v141
  v_cvt_pk_bf16_f32 v111, v142, v143
  ds_read_b64_tr_b16 v[164:165], v8 offset:8544
  ds_read_b64_tr_b16 v[166:167], v8 offset:8800
  s_waitcnt lgkmcnt(8)
  v_mfma_f32_16x16x32_bf16 v[44:47], v[148:151], v[72:75], v[44:47]
  v_mfma_f32_16x16x32_bf16 v[24:27], v[28:31], v[72:75], v[24:27]
  s_waitcnt lgkmcnt(6)
  v_mfma_f32_16x16x32_bf16 v[32:35], v[152:155], v[76:79], v[32:35]
  s_waitcnt lgkmcnt(4)
  v_mfma_f32_16x16x32_bf16 v[36:39], v[156:159], v[76:79], v[36:39]
  s_waitcnt lgkmcnt(2)
  v_mfma_f32_16x16x32_bf16 v[40:43], v[160:163], v[76:79], v[40:43]
  s_waitcnt lgkmcnt(0)
  v_mfma_f32_16x16x32_bf16 v[44:47], v[164:167], v[76:79], v[44:47]
  v_mfma_f32_16x16x32_bf16 v[24:27], v[28:31], v[76:79], v[24:27]
  s_barrier
  v_add_u32 v9, 118272, v2
  v_add_u32 v8, 0, v2
  ds_read_b64_tr_b16 v[144:145], v9
  ds_read_b64_tr_b16 v[146:147], v9 offset:256
  ds_read_b64_tr_b16 v[148:149], v9 offset:32
  ds_read_b64_tr_b16 v[150:151], v9 offset:288
  ds_read_b64_tr_b16 v[152:153], v9 offset:64
  ds_read_b64_tr_b16 v[154:155], v9 offset:320
  ds_read_b64_tr_b16 v[156:157], v9 offset:96
  ds_read_b64_tr_b16 v[158:159], v9 offset:352
  v_mul_f32 v32, v32, v13
  v_mul_f32 v33, v33, v13
  v_mul_f32 v34, v34, v13
  v_mul_f32 v35, v35, v13
  v_mul_f32 v36, v36, v13
  v_mul_f32 v37, v37, v13
  v_mul_f32 v38, v38, v13
  v_mul_f32 v39, v39, v13
  v_mul_f32 v40, v40, v13
  v_mul_f32 v41, v41, v13
  v_mul_f32 v42, v42, v13
  v_mul_f32 v43, v43, v13
  v_mul_f32 v44, v44, v13
  v_mul_f32 v45, v45, v13
  v_mul_f32 v46, v46, v13
  v_mul_f32 v47, v47, v13
  v_mul_f32 v24, v24, v13
  ds_read_b64_tr_b16 v[160:161], v9 offset:8448
  ds_read_b64_tr_b16 v[162:163], v9 offset:8704
  s_waitcnt lgkmcnt(8)
  v_mfma_f32_16x16x32_bf16 v[32:35], v[144:147], v[80:83], v[32:35]
  ds_read_b64_tr_b16 v[164:165], v9 offset:8480
  ds_read_b64_tr_b16 v[166:167], v9 offset:8736
  s_waitcnt lgkmcnt(8)
  v_mfma_f32_16x16x32_bf16 v[36:39], v[148:151], v[80:83], v[36:39]
  ds_read_b64_tr_b16 v[144:145], v9 offset:8512
  ds_read_b64_tr_b16 v[146:147], v9 offset:8768
  s_waitcnt lgkmcnt(8)
  v_mfma_f32_16x16x32_bf16 v[40:43], v[152:155], v[80:83], v[40:43]
  ds_read_b64_tr_b16 v[148:149], v9 offset:8544
  ds_read_b64_tr_b16 v[150:151], v9 offset:8800
  s_waitcnt lgkmcnt(8)
  v_mfma_f32_16x16x32_bf16 v[44:47], v[156:159], v[80:83], v[44:47]
  v_mfma_f32_16x16x32_bf16 v[24:27], v[28:31], v[80:83], v[24:27]
  ds_read_b64_tr_b16 v[152:153], v8
  ds_read_b64_tr_b16 v[154:155], v8 offset:256
  s_waitcnt lgkmcnt(8)
  v_mfma_f32_16x16x32_bf16 v[32:35], v[160:163], v[84:87], v[32:35]
  ds_read_b64_tr_b16 v[156:157], v8 offset:32
  ds_read_b64_tr_b16 v[158:159], v8 offset:288
  s_waitcnt lgkmcnt(8)
  v_mfma_f32_16x16x32_bf16 v[36:39], v[164:167], v[84:87], v[36:39]
  ds_read_b64_tr_b16 v[160:161], v8 offset:64
  ds_read_b64_tr_b16 v[162:163], v8 offset:320
  s_waitcnt lgkmcnt(8)
  v_mfma_f32_16x16x32_bf16 v[40:43], v[144:147], v[84:87], v[40:43]
  ds_read_b64_tr_b16 v[164:165], v8 offset:96
  ds_read_b64_tr_b16 v[166:167], v8 offset:352
  s_waitcnt lgkmcnt(8)
  v_mfma_f32_16x16x32_bf16 v[44:47], v[148:151], v[84:87], v[44:47]
  v_mfma_f32_16x16x32_bf16 v[24:27], v[28:31], v[84:87], v[24:27]
  ds_read_b64_tr_b16 v[144:145], v8 offset:8448
  ds_read_b64_tr_b16 v[146:147], v8 offset:8704
  s_waitcnt lgkmcnt(8)
  v_mfma_f32_16x16x32_bf16 v[32:35], v[152:155], v[88:91], v[32:35]
  ds_read_b64_tr_b16 v[148:149], v8 offset:8480
  ds_read_b64_tr_b16 v[150:151], v8 offset:8736
  s_waitcnt lgkmcnt(8)
  v_mfma_f32_16x16x32_bf16 v[36:39], v[156:159], v[88:91], v[36:39]
  ds_read_b64_tr_b16 v[152:153], v8 offset:8512
  ds_read_b64_tr_b16 v[154:155], v8 offset:8768
  s_waitcnt lgkmcnt(8)
  v_mfma_f32_16x16x32_bf16 v[40:43], v[160:163], v[88:91], v[40:43]
  ds_read_b64_tr_b16 v[156:157], v8 offset:8544
  ds_read_b64_tr_b16 v[158:159], v8 offset:8800
  s_waitcnt lgkmcnt(8)
  v_mfma_f32_16x16x32_bf16 v[44:47], v[164:167], v[88:91], v[44:47]
  v_mfma_f32_16x16x32_bf16 v[24:27], v[28:31], v[88:91], v[24:27]
  s_waitcnt lgkmcnt(6)
  v_mfma_f32_16x16x32_bf16 v[32:35], v[144:147], v[92:95], v[32:35]
  s_waitcnt lgkmcnt(4)
  v_mfma_f32_16x16x32_bf16 v[36:39], v[148:151], v[92:95], v[36:39]
  s_waitcnt lgkmcnt(2)
  v_mfma_f32_16x16x32_bf16 v[40:43], v[152:155], v[92:95], v[40:43]
  s_waitcnt lgkmcnt(0)
  v_mfma_f32_16x16x32_bf16 v[44:47], v[156:159], v[92:95], v[44:47]
  v_mfma_f32_16x16x32_bf16 v[24:27], v[28:31], v[92:95], v[24:27]
  s_barrier
  v_add_u32 v9, 16896, v2
  v_add_u32 v8, 33792, v2
  ds_read_b64_tr_b16 v[160:161], v9
  ds_read_b64_tr_b16 v[162:163], v9 offset:256
  ds_read_b64_tr_b16 v[164:165], v9 offset:32
  ds_read_b64_tr_b16 v[166:167], v9 offset:288
  ds_read_b64_tr_b16 v[144:145], v9 offset:64
  ds_read_b64_tr_b16 v[146:147], v9 offset:320
  ds_read_b64_tr_b16 v[148:149], v9 offset:96
  ds_read_b64_tr_b16 v[150:151], v9 offset:352
  v_mul_f32 v32, v32, v3
  v_mul_f32 v33, v33, v3
  v_mul_f32 v34, v34, v3
  v_mul_f32 v35, v35, v3
  v_mul_f32 v36, v36, v3
  v_mul_f32 v37, v37, v3
  v_mul_f32 v38, v38, v3
  v_mul_f32 v39, v39, v3
  v_mul_f32 v40, v40, v3
  v_mul_f32 v41, v41, v3
  v_mul_f32 v42, v42, v3
  v_mul_f32 v43, v43, v3
  v_mul_f32 v44, v44, v3
  v_mul_f32 v45, v45, v3
  v_mul_f32 v46, v46, v3
  v_mul_f32 v47, v47, v3
  v_mul_f32 v24, v24, v3
  ds_read_b64_tr_b16 v[152:153], v9 offset:8448
  ds_read_b64_tr_b16 v[154:155], v9 offset:8704
  s_waitcnt lgkmcnt(8)
  v_mfma_f32_16x16x32_bf16 v[32:35], v[160:163], v[96:99], v[32:35]
  ds_read_b64_tr_b16 v[156:157], v9 offset:8480
  ds_read_b64_tr_b16 v[158:159], v9 offset:8736
  s_waitcnt lgkmcnt(8)
  v_mfma_f32_16x16x32_bf16 v[36:39], v[164:167], v[96:99], v[36:39]
  ds_read_b64_tr_b16 v[160:161], v9 offset:8512
  ds_read_b64_tr_b16 v[162:163], v9 offset:8768
  s_waitcnt lgkmcnt(8)
  v_mfma_f32_16x16x32_bf16 v[40:43], v[144:147], v[96:99], v[40:43]
  ds_read_b64_tr_b16 v[164:165], v9 offset:8544
  ds_read_b64_tr_b16 v[166:167], v9 offset:8800
  s_waitcnt lgkmcnt(8)
  v_mfma_f32_16x16x32_bf16 v[44:47], v[148:151], v[96:99], v[44:47]
  v_mfma_f32_16x16x32_bf16 v[24:27], v[28:31], v[96:99], v[24:27]
  ds_read_b64_tr_b16 v[144:145], v8
  ds_read_b64_tr_b16 v[146:147], v8 offset:256
  s_waitcnt lgkmcnt(8)
  v_mfma_f32_16x16x32_bf16 v[32:35], v[152:155], v[100:103], v[32:35]
  ds_read_b64_tr_b16 v[148:149], v8 offset:32
  ds_read_b64_tr_b16 v[150:151], v8 offset:288
  s_waitcnt lgkmcnt(8)
  v_mfma_f32_16x16x32_bf16 v[36:39], v[156:159], v[100:103], v[36:39]
  ds_read_b64_tr_b16 v[152:153], v8 offset:64
  ds_read_b64_tr_b16 v[154:155], v8 offset:320
  s_waitcnt lgkmcnt(8)
  v_mfma_f32_16x16x32_bf16 v[40:43], v[160:163], v[100:103], v[40:43]
  ds_read_b64_tr_b16 v[156:157], v8 offset:96
  ds_read_b64_tr_b16 v[158:159], v8 offset:352
  s_waitcnt lgkmcnt(8)
  v_mfma_f32_16x16x32_bf16 v[44:47], v[164:167], v[100:103], v[44:47]
  v_mfma_f32_16x16x32_bf16 v[24:27], v[28:31], v[100:103], v[24:27]
  ds_read_b64_tr_b16 v[160:161], v8 offset:8448
  ds_read_b64_tr_b16 v[162:163], v8 offset:8704
  s_waitcnt lgkmcnt(8)
  v_mfma_f32_16x16x32_bf16 v[32:35], v[144:147], v[104:107], v[32:35]
  ds_read_b64_tr_b16 v[164:165], v8 offset:8480
  ds_read_b64_tr_b16 v[166:167], v8 offset:8736
  s_waitcnt lgkmcnt(8)
  v_mfma_f32_16x16x32_bf16 v[36:39], v[148:151], v[104:107], v[36:39]
  ds_read_b64_tr_b16 v[144:145], v8 offset:8512
  ds_read_b64_tr_b16 v[146:147], v8 offset:8768
  s_waitcnt lgkmcnt(8)
  v_mfma_f32_16x16x32_bf16 v[40:43], v[152:155], v[104:107], v[40:43]
  ds_read_b64_tr_b16 v[148:149], v8 offset:8544
  ds_read_b64_tr_b16 v[150:151], v8 offset:8800
  s_waitcnt lgkmcnt(8)
  v_mfma_f32_16x16x32_bf16 v[44:47], v[156:159], v[104:107], v[44:47]
  v_mfma_f32_16x16x32_bf16 v[24:27], v[28:31], v[104:107], v[24:27]
  s_waitcnt lgkmcnt(6)
  v_mfma_f32_16x16x32_bf16 v[32:35], v[160:163], v[108:111], v[32:35]
  s_waitcnt lgkmcnt(4)
  v_mfma_f32_16x16x32_bf16 v[36:39], v[164:167], v[108:111], v[36:39]
  s_waitcnt lgkmcnt(2)
  v_mfma_f32_16x16x32_bf16 v[40:43], v[144:147], v[108:111], v[40:43]
  s_waitcnt lgkmcnt(0)
  v_mfma_f32_16x16x32_bf16 v[44:47], v[148:151], v[108:111], v[44:47]
  v_mfma_f32_16x16x32_bf16 v[24:27], v[28:31], v[108:111], v[24:27]
  s_nop 7
  v_mov_b32 v7, v24
  s_nop 7
  s_cmp_eq_u32 s26, 1
  s_cbranch_scc0 L_c_7
  ds_write_b128 v14, v[32:35]
  ds_write_b128 v14, v[36:39] offset:1024
  ds_write_b128 v14, v[40:43] offset:2048
  ds_write_b128 v14, v[44:47] offset:3072
  ds_write_b64 v15, v[6:7]
  s_waitcnt lgkmcnt(0)
  s_nop 7
L_c_7:
  s_barrier
  s_nop 7
  s_cmp_eq_u32 s26, 0
  s_cbranch_scc0 L_c_8
  ds_read_b64 v[8:9], v15
  ds_read_b128 v[144:147], v14
  ds_read_b128 v[148:151], v14 offset:1024
  ds_read_b128 v[152:155], v14 offset:2048
  ds_read_b128 v[156:159], v14 offset:3072
  s_waitcnt lgkmcnt(4)
  v_min_f32 v160, v6, v8
  v_sub_f32 v10, v160, v6
  v_sub_f32 v11, v160, v8
  v_exp_f32 v10, v10
  v_exp_f32 v11, v11
  v_mul_f32 v160, v10, v7
  v_fma_f32 v160, v11, v9, v160
  v_rcp_f32 v160, v160
  s_nop 0
  v_mul_f32 v10, v10, v160
  v_mul_f32 v11, v11, v160
  v_mul_f32 v32, v32, v10
  s_waitcnt lgkmcnt(3)
  v_fma_f32 v32, v144, v11, v32
  v_mul_f32 v33, v33, v10
  v_fma_f32 v33, v145, v11, v33
  v_mul_f32 v34, v34, v10
  v_fma_f32 v34, v146, v11, v34
  v_mul_f32 v35, v35, v10
  v_fma_f32 v35, v147, v11, v35
  v_mul_f32 v36, v36, v10
  s_waitcnt lgkmcnt(2)
  v_fma_f32 v36, v148, v11, v36
  v_mul_f32 v37, v37, v10
  v_fma_f32 v37, v149, v11, v37
  v_mul_f32 v38, v38, v10
  v_fma_f32 v38, v150, v11, v38
  v_mul_f32 v39, v39, v10
  v_fma_f32 v39, v151, v11, v39
  v_mul_f32 v40, v40, v10
  s_waitcnt lgkmcnt(1)
  v_fma_f32 v40, v152, v11, v40
  v_mul_f32 v41, v41, v10
  v_fma_f32 v41, v153, v11, v41
  v_mul_f32 v42, v42, v10
  v_fma_f32 v42, v154, v11, v42
  v_mul_f32 v43, v43, v10
  v_fma_f32 v43, v155, v11, v43
  v_mul_f32 v44, v44, v10
  s_waitcnt lgkmcnt(0)
  v_fma_f32 v44, v156, v11, v44
  v_mul_f32 v45, v45, v10
  v_fma_f32 v45, v157, v11, v45
  v_mul_f32 v46, v46, v10
  v_fma_f32 v46, v158, v11, v46
  v_mul_f32 v47, v47, v10
  v_fma_f32 v47, v159, v11, v47
  v_cvt_pk_bf16_f32 v16, v32, v33
  v_cvt_pk_bf16_f32 v17, v34, v35
  v_cvt_pk_bf16_f32 v18, v36, v37
  v_cvt_pk_bf16_f32 v19, v38, v39
  v_cvt_pk_bf16_f32 v20, v40, v41
  v_cvt_pk_bf16_f32 v21, v42, v43
  v_cvt_pk_bf16_f32 v22, v44, v45
  v_cvt_pk_bf16_f32 v23, v46, v47
  s_nop 7
L_c_8:
  v_add_u32 v9, 50688, v2
  v_add_u32 v8, 67584, v2
  ds_read_b64_tr_b16 v[152:153], v9
  ds_read_b64_tr_b16 v[154:155], v9 offset:256
  ds_read_b64_tr_b16 v[156:157], v9 offset:32
  ds_read_b64_tr_b16 v[158:159], v9 offset:288
  ds_read_b64_tr_b16 v[160:161], v9 offset:64
  ds_read_b64_tr_b16 v[162:163], v9 offset:320
  ds_read_b64_tr_b16 v[164:165], v9 offset:96
  ds_read_b64_tr_b16 v[166:167], v9 offset:352
  ds_read_b64_tr_b16 v[144:145], v9 offset:8448
  ds_read_b64_tr_b16 v[146:147], v9 offset:8704
  s_waitcnt lgkmcnt(8)
  v_mfma_f32_16x16x32_bf16 v[32:35], v[152:155], v[48:51], 0
  ds_read_b64_tr_b16 v[148:149], v9 offset:8480
  ds_read_b64_tr_b16 v[150:151], v9 offset:8736
  s_waitcnt lgkmcnt(8)
  v_mfma_f32_16x16x32_bf16 v[36:39], v[156:159], v[48:51], 0
  ds_read_b64_tr_b16 v[152:153], v9 offset:8512
  ds_read_b64_tr_b16 v[154:155], v9 offset:8768
  s_waitcnt lgkmcnt(8)
  v_mfma_f32_16x16x32_bf16 v[40:43], v[160:163], v[48:51], 0
  ds_read_b64_tr_b16 v[156:157], v9 offset:8544
  ds_read_b64_tr_b16 v[158:159], v9 offset:8800
  s_waitcnt lgkmcnt(8)
  v_mfma_f32_16x16x32_bf16 v[44:47], v[164:167], v[48:51], 0
  ds_read_b64_tr_b16 v[160:161], v8
  ds_read_b64_tr_b16 v[162:163], v8 offset:256
  s_waitcnt lgkmcnt(8)
  v_mfma_f32_16x16x32_bf16 v[32:35], v[144:147], v[52:55], v[32:35]
  ds_read_b64_tr_b16 v[164:165], v8 offset:32
  ds_read_b64_tr_b16 v[166:167], v8 offset:288
  s_waitcnt lgkmcnt(8)
  v_mfma_f32_16x16x32_bf16 v[36:39], v[148:151], v[52:55], v[36:39]
  ds_read_b64_tr_b16 v[144:145], v8 offset:64
  ds_read_b64_tr_b16 v[146:147], v8 offset:320
  s_waitcnt lgkmcnt(8)
  v_mfma_f32_16x16x32_bf16 v[40:43], v[152:155], v[52:55], v[40:43]
  ds_read_b64_tr_b16 v[148:149], v8 offset:96
  ds_read_b64_tr_b16 v[150:151], v8 offset:352
  s_waitcnt lgkmcnt(8)
  v_mfma_f32_16x16x32_bf16 v[44:47], v[156:159], v[52:55], v[44:47]
  ds_read_b64_tr_b16 v[152:153], v8 offset:8448
  ds_read_b64_tr_b16 v[154:155], v8 offset:8704
  s_waitcnt lgkmcnt(8)
  v_mfma_f32_16x16x32_bf16 v[32:35], v[160:163], v[56:59], v[32:35]
  ds_read_b64_tr_b16 v[156:157], v8 offset:8480
  ds_read_b64_tr_b16 v[158:159], v8 offset:8736
  s_waitcnt lgkmcnt(8)
  v_mfma_f32_16x16x32_bf16 v[36:39], v[164:167], v[56:59], v[36:39]
  ds_read_b64_tr_b16 v[160:161], v8 offset:8512
  ds_read_b64_tr_b16 v[162:163], v8 offset:8768
  s_waitcnt lgkmcnt(8)
  v_mfma_f32_16x16x32_bf16 v[40:43], v[144:147], v[56:59], v[40:43]
  ds_read_b64_tr_b16 v[164:165], v8 offset:8544
  ds_read_b64_tr_b16 v[166:167], v8 offset:8800
  s_waitcnt lgkmcnt(8)
  v_mfma_f32_16x16x32_bf16 v[44:47], v[148:151], v[56:59], v[44:47]
  s_waitcnt lgkmcnt(6)
  v_mfma_f32_16x16x32_bf16 v[32:35], v[152:155], v[60:63], v[32:35]
  s_waitcnt lgkmcnt(4)
  v_mfma_f32_16x16x32_bf16 v[36:39], v[156:159], v[60:63], v[36:39]
  s_waitcnt lgkmcnt(2)
  v_mfma_f32_16x16x32_bf16 v[40:43], v[160:163], v[60:63], v[40:43]
  s_waitcnt lgkmcnt(0)
  v_mfma_f32_16x16x32_bf16 v[44:47], v[164:167], v[60:63], v[44:47]
  s_barrier
  v_add_u32 v9, 84480, v2
  v_add_u32 v8, 101376, v2
  ds_read_b64_tr_b16 v[144:145], v9
  ds_read_b64_tr_b16 v[146:147], v9 offset:256
  ds_read_b64_tr_b16 v[148:149], v9 offset:32
  ds_read_b64_tr_b16 v[150:151], v9 offset:288
  ds_read_b64_tr_b16 v[152:153], v9 offset:64
  ds_read_b64_tr_b16 v[154:155], v9 offset:320
  ds_read_b64_tr_b16 v[156:157], v9 offset:96
  ds_read_b64_tr_b16 v[158:159], v9 offset:352
  v_mul_f32 v32, v32, v12
  v_mul_f32 v33, v33, v12
  v_mul_f32 v34, v34, v12
  v_mul_f32 v35, v35, v12
  v_mul_f32 v36, v36, v12
  v_mul_f32 v37, v37, v12
  v_mul_f32 v38, v38, v12
  v_mul_f32 v39, v39, v12
  v_mul_f32 v40, v40, v12
  v_mul_f32 v41, v41, v12
  v_mul_f32 v42, v42, v12
  v_mul_f32 v43, v43, v12
  v_mul_f32 v44, v44, v12
  v_mul_f32 v45, v45, v12
  v_mul_f32 v46, v46, v12
  v_mul_f32 v47, v47, v12
  ds_read_b64_tr_b16 v[160:161], v9 offset:8448
  ds_read_b64_tr_b16 v[162:163], v9 offset:8704
  s_waitcnt lgkmcnt(8)
  v_mfma_f32_16x16x32_bf16 v[32:35], v[144:147], v[64:67], v[32:35]
  ds_read_b64_tr_b16 v[164:165], v9 offset:8480
  ds_read_b64_tr_b16 v[166:167], v9 offset:8736
  s_waitcnt lgkmcnt(8)
  v_mfma_f32_16x16x32_bf16 v[36:39], v[148:151], v[64:67], v[36:39]
  ds_read_b64_tr_b16 v[144:145], v9 offset:8512
  ds_read_b64_tr_b16 v[146:147], v9 offset:8768
  s_waitcnt lgkmcnt(8)
  v_mfma_f32_16x16x32_bf16 v[40:43], v[152:155], v[64:67], v[40:43]
  ds_read_b64_tr_b16 v[148:149], v9 offset:8544
  ds_read_b64_tr_b16 v[150:151], v9 offset:8800
  s_waitcnt lgkmcnt(8)
  v_mfma_f32_16x16x32_bf16 v[44:47], v[156:159], v[64:67], v[44:47]
  ds_read_b64_tr_b16 v[152:153], v8
  ds_read_b64_tr_b16 v[154:155], v8 offset:256
  s_waitcnt lgkmcnt(8)
  v_mfma_f32_16x16x32_bf16 v[32:35], v[160:163], v[68:71], v[32:35]
  ds_read_b64_tr_b16 v[156:157], v8 offset:32
  ds_read_b64_tr_b16 v[158:159], v8 offset:288
  s_waitcnt lgkmcnt(8)
  v_mfma_f32_16x16x32_bf16 v[36:39], v[164:167], v[68:71], v[36:39]
  ds_read_b64_tr_b16 v[160:161], v8 offset:64
  ds_read_b64_tr_b16 v[162:163], v8 offset:320
  s_waitcnt lgkmcnt(8)
  v_mfma_f32_16x16x32_bf16 v[40:43], v[144:147], v[68:71], v[40:43]
  ds_read_b64_tr_b16 v[164:165], v8 offset:96
  ds_read_b64_tr_b16 v[166:167], v8 offset:352
  s_waitcnt lgkmcnt(8)
  v_mfma_f32_16x16x32_bf16 v[44:47], v[148:151], v[68:71], v[44:47]
  ds_read_b64_tr_b16 v[144:145], v8 offset:8448
  ds_read_b64_tr_b16 v[146:147], v8 offset:8704
  s_waitcnt lgkmcnt(8)
  v_mfma_f32_16x16x32_bf16 v[32:35], v[152:155], v[72:75], v[32:35]
  ds_read_b64_tr_b16 v[148:149], v8 offset:8480
  ds_read_b64_tr_b16 v[150:151], v8 offset:8736
  s_waitcnt lgkmcnt(8)
  v_mfma_f32_16x16x32_bf16 v[36:39], v[156:159], v[72:75], v[36:39]
  ds_read_b64_tr_b16 v[152:153], v8 offset:8512
  ds_read_b64_tr_b16 v[154:155], v8 offset:8768
  s_waitcnt lgkmcnt(8)
  v_mfma_f32_16x16x32_bf16 v[40:43], v[160:163], v[72:75], v[40:43]
  ds_read_b64_tr_b16 v[156:157], v8 offset:8544
  ds_read_b64_tr_b16 v[158:159], v8 offset:8800
  s_waitcnt lgkmcnt(8)
  v_mfma_f32_16x16x32_bf16 v[44:47], v[164:167], v[72:75], v[44:47]
  s_waitcnt lgkmcnt(6)
  v_mfma_f32_16x16x32_bf16 v[32:35], v[144:147], v[76:79], v[32:35]
  s_waitcnt lgkmcnt(4)
  v_mfma_f32_16x16x32_bf16 v[36:39], v[148:151], v[76:79], v[36:39]
  s_waitcnt lgkmcnt(2)
  v_mfma_f32_16x16x32_bf16 v[40:43], v[152:155], v[76:79], v[40:43]
  s_waitcnt lgkmcnt(0)
  v_mfma_f32_16x16x32_bf16 v[44:47], v[156:159], v[76:79], v[44:47]
  s_barrier
  v_add_u32 v9, 118272, v2
  v_add_u32 v8, 0, v2
  ds_read_b64_tr_b16 v[160:161], v9
  ds_read_b64_tr_b16 v[162:163], v9 offset:256
  ds_read_b64_tr_b16 v[164:165], v9 offset:32
  ds_read_b64_tr_b16 v[166:167], v9 offset:288
  ds_read_b64_tr_b16 v[144:145], v9 offset:64
  ds_read_b64_tr_b16 v[146:147], v9 offset:320
  ds_read_b64_tr_b16 v[148:149], v9 offset:96
  ds_read_b64_tr_b16 v[150:151], v9 offset:352
  v_mul_f32 v32, v32, v13
  v_mul_f32 v33, v33, v13
  v_mul_f32 v34, v34, v13
  v_mul_f32 v35, v35, v13
  v_mul_f32 v36, v36, v13
  v_mul_f32 v37, v37, v13
  v_mul_f32 v38, v38, v13
  v_mul_f32 v39, v39, v13
  v_mul_f32 v40, v40, v13
  v_mul_f32 v41, v41, v13
  v_mul_f32 v42, v42, v13
  v_mul_f32 v43, v43, v13
  v_mul_f32 v44, v44, v13
  v_mul_f32 v45, v45, v13
  v_mul_f32 v46, v46, v13
  v_mul_f32 v47, v47, v13
  ds_read_b64_tr_b16 v[152:153], v9 offset:8448
  ds_read_b64_tr_b16 v[154:155], v9 offset:8704
  s_waitcnt lgkmcnt(8)
  v_mfma_f32_16x16x32_bf16 v[32:35], v[160:163], v[80:83], v[32:35]
  ds_read_b64_tr_b16 v[156:157], v9 offset:8480
  ds_read_b64_tr_b16 v[158:159], v9 offset:8736
  s_waitcnt lgkmcnt(8)
  v_mfma_f32_16x16x32_bf16 v[36:39], v[164:167], v[80:83], v[36:39]
  ds_read_b64_tr_b16 v[160:161], v9 offset:8512
  ds_read_b64_tr_b16 v[162:163], v9 offset:8768
  s_waitcnt lgkmcnt(8)
  v_mfma_f32_16x16x32_bf16 v[40:43], v[144:147], v[80:83], v[40:43]
  ds_read_b64_tr_b16 v[164:165], v9 offset:8544
  ds_read_b64_tr_b16 v[166:167], v9 offset:8800
  s_waitcnt lgkmcnt(8)
  v_mfma_f32_16x16x32_bf16 v[44:47], v[148:151], v[80:83], v[44:47]
  ds_read_b64_tr_b16 v[144:145], v8
  ds_read_b64_tr_b16 v[146:147], v8 offset:256
  s_waitcnt lgkmcnt(8)
  v_mfma_f32_16x16x32_bf16 v[32:35], v[152:155], v[84:87], v[32:35]
  ds_read_b64_tr_b16 v[148:149], v8 offset:32
  ds_read_b64_tr_b16 v[150:151], v8 offset:288
  s_waitcnt lgkmcnt(8)
  v_mfma_f32_16x16x32_bf16 v[36:39], v[156:159], v[84:87], v[36:39]
  ds_read_b64_tr_b16 v[152:153], v8 offset:64
  ds_read_b64_tr_b16 v[154:155], v8 offset:320
  s_waitcnt lgkmcnt(8)
  v_mfma_f32_16x16x32_bf16 v[40:43], v[160:163], v[84:87], v[40:43]
  ds_read_b64_tr_b16 v[156:157], v8 offset:96
  ds_read_b64_tr_b16 v[158:159], v8 offset:352
  s_waitcnt lgkmcnt(8)
  v_mfma_f32_16x16x32_bf16 v[44:47], v[164:167], v[84:87], v[44:47]
  ds_read_b64_tr_b16 v[160:161], v8 offset:8448
  ds_read_b64_tr_b16 v[162:163], v8 offset:8704
  s_waitcnt lgkmcnt(8)
  v_mfma_f32_16x16x32_bf16 v[32:35], v[144:147], v[88:91], v[32:35]
  ds_read_b64_tr_b16 v[164:165], v8 offset:8480
  ds_read_b64_tr_b16 v[166:167], v8 offset:8736
  s_waitcnt lgkmcnt(8)
  v_mfma_f32_16x16x32_bf16 v[36:39], v[148:151], v[88:91], v[36:39]
  ds_read_b64_tr_b16 v[144:145], v8 offset:8512
  ds_read_b64_tr_b16 v[146:147], v8 offset:8768
  s_waitcnt lgkmcnt(8)
  v_mfma_f32_16x16x32_bf16 v[40:43], v[152:155], v[88:91], v[40:43]
  ds_read_b64_tr_b16 v[148:149], v8 offset:8544
  ds_read_b64_tr_b16 v[150:151], v8 offset:8800
  s_waitcnt lgkmcnt(8)
  v_mfma_f32_16x16x32_bf16 v[44:47], v[156:159], v[88:91], v[44:47]
  s_waitcnt lgkmcnt(6)
  v_mfma_f32_16x16x32_bf16 v[32:35], v[160:163], v[92:95], v[32:35]
  s_waitcnt lgkmcnt(4)
  v_mfma_f32_16x16x32_bf16 v[36:39], v[164:167], v[92:95], v[36:39]
  s_waitcnt lgkmcnt(2)
  v_mfma_f32_16x16x32_bf16 v[40:43], v[144:147], v[92:95], v[40:43]
  s_waitcnt lgkmcnt(0)
  v_mfma_f32_16x16x32_bf16 v[44:47], v[148:151], v[92:95], v[44:47]
  s_barrier
  v_add_u32 v9, 16896, v2
  v_add_u32 v8, 33792, v2
  ds_read_b64_tr_b16 v[152:153], v9
  ds_read_b64_tr_b16 v[154:155], v9 offset:256
  ds_read_b64_tr_b16 v[156:157], v9 offset:32
  ds_read_b64_tr_b16 v[158:159], v9 offset:288
  ds_read_b64_tr_b16 v[160:161], v9 offset:64
  ds_read_b64_tr_b16 v[162:163], v9 offset:320
  ds_read_b64_tr_b16 v[164:165], v9 offset:96
  ds_read_b64_tr_b16 v[166:167], v9 offset:352
  v_mul_f32 v32, v32, v3
  v_mul_f32 v33, v33, v3
  v_mul_f32 v34, v34, v3
  v_mul_f32 v35, v35, v3
  v_mul_f32 v36, v36, v3
  v_mul_f32 v37, v37, v3
  v_mul_f32 v38, v38, v3
  v_mul_f32 v39, v39, v3
  v_mul_f32 v40, v40, v3
  v_mul_f32 v41, v41, v3
  v_mul_f32 v42, v42, v3
  v_mul_f32 v43, v43, v3
  v_mul_f32 v44, v44, v3
  v_mul_f32 v45, v45, v3
  v_mul_f32 v46, v46, v3
  v_mul_f32 v47, v47, v3
  ds_read_b64_tr_b16 v[144:145], v9 offset:8448
  ds_read_b64_tr_b16 v[146:147], v9 offset:8704
  s_waitcnt lgkmcnt(8)
  v_mfma_f32_16x16x32_bf16 v[32:35], v[152:155], v[96:99], v[32:35]
  ds_read_b64_tr_b16 v[148:149], v9 offset:8480
  ds_read_b64_tr_b16 v[150:151], v9 offset:8736
  s_waitcnt lgkmcnt(8)
  v_mfma_f32_16x16x32_bf16 v[36:39], v[156:159], v[96:99], v[36:39]
  ds_read_b64_tr_b16 v[152:153], v9 offset:8512
  ds_read_b64_tr_b16 v[154:155], v9 offset:8768
  s_waitcnt lgkmcnt(8)
  v_mfma_f32_16x16x32_bf16 v[40:43], v[160:163], v[96:99], v[40:43]
  ds_read_b64_tr_b16 v[156:157], v9 offset:8544
  ds_read_b64_tr_b16 v[158:159], v9 offset:8800
  s_waitcnt lgkmcnt(8)
  v_mfma_f32_16x16x32_bf16 v[44:47], v[164:167], v[96:99], v[44:47]
  ds_read_b64_tr_b16 v[160:161], v8
  ds_read_b64_tr_b16 v[162:163], v8 offset:256
  s_waitcnt lgkmcnt(8)
  v_mfma_f32_16x16x32_bf16 v[32:35], v[144:147], v[100:103], v[32:35]
  ds_read_b64_tr_b16 v[164:165], v8 offset:32
  ds_read_b64_tr_b16 v[166:167], v8 offset:288
  s_waitcnt lgkmcnt(8)
  v_mfma_f32_16x16x32_bf16 v[36:39], v[148:151], v[100:103], v[36:39]
  ds_read_b64_tr_b16 v[144:145], v8 offset:64
  ds_read_b64_tr_b16 v[146:147], v8 offset:320
  s_waitcnt lgkmcnt(8)
  v_mfma_f32_16x16x32_bf16 v[40:43], v[152:155], v[100:103], v[40:43]
  ds_read_b64_tr_b16 v[148:149], v8 offset:96
  ds_read_b64_tr_b16 v[150:151], v8 offset:352
  s_waitcnt lgkmcnt(8)
  v_mfma_f32_16x16x32_bf16 v[44:47], v[156:159], v[100:103], v[44:47]
  ds_read_b64_tr_b16 v[152:153], v8 offset:8448
  ds_read_b64_tr_b16 v[154:155], v8 offset:8704
  s_waitcnt lgkmcnt(8)
  v_mfma_f32_16x16x32_bf16 v[32:35], v[160:163], v[104:107], v[32:35]
  ds_read_b64_tr_b16 v[156:157], v8 offset:8480
  ds_read_b64_tr_b16 v[158:159], v8 offset:8736
  s_waitcnt lgkmcnt(8)
  v_mfma_f32_16x16x32_bf16 v[36:39], v[164:167], v[104:107], v[36:39]
  ds_read_b64_tr_b16 v[160:161], v8 offset:8512
  ds_read_b64_tr_b16 v[162:163], v8 offset:8768
  s_waitcnt lgkmcnt(8)
  v_mfma_f32_16x16x32_bf16 v[40:43], v[144:147], v[104:107], v[40:43]
  ds_read_b64_tr_b16 v[164:165], v8 offset:8544
  ds_read_b64_tr_b16 v[166:167], v8 offset:8800
  s_waitcnt lgkmcnt(8)
  v_mfma_f32_16x16x32_bf16 v[44:47], v[148:151], v[104:107], v[44:47]
  s_waitcnt lgkmcnt(6)
  v_mfma_f32_16x16x32_bf16 v[32:35], v[152:155], v[108:111], v[32:35]
  s_waitcnt lgkmcnt(4)
  v_mfma_f32_16x16x32_bf16 v[36:39], v[156:159], v[108:111], v[36:39]
  s_waitcnt lgkmcnt(2)
  v_mfma_f32_16x16x32_bf16 v[40:43], v[160:163], v[108:111], v[40:43]
  s_waitcnt lgkmcnt(0)
  v_mfma_f32_16x16x32_bf16 v[44:47], v[164:167], v[108:111], v[44:47]
  s_nop 7
  s_cmp_eq_u32 s26, 1
  s_cbranch_scc0 L_c_9
  ds_write_b128 v14, v[32:35]
  ds_write_b128 v14, v[36:39] offset:1024
  ds_write_b128 v14, v[40:43] offset:2048
  ds_write_b128 v14, v[44:47] offset:3072
  s_waitcnt lgkmcnt(0)
  s_nop 7
L_c_9:
  s_barrier
  s_nop 7
  s_cmp_eq_u32 s26, 0
  s_cbranch_scc0 L_c_10
  ds_read_b128 v[144:147], v14
  ds_read_b128 v[148:151], v14 offset:1024
  ds_read_b128 v[152:155], v14 offset:2048
  ds_read_b128 v[156:159], v14 offset:3072
  v_mul_f32 v32, v32, v10
  s_waitcnt lgkmcnt(3)
  v_fma_f32 v32, v144, v11, v32
  v_mul_f32 v33, v33, v10
  v_fma_f32 v33, v145, v11, v33
  v_mul_f32 v34, v34, v10
  v_fma_f32 v34, v146, v11, v34
  v_mul_f32 v35, v35, v10
  v_fma_f32 v35, v147, v11, v35
  v_mul_f32 v36, v36, v10
  s_waitcnt lgkmcnt(2)
  v_fma_f32 v36, v148, v11, v36
  v_mul_f32 v37, v37, v10
  v_fma_f32 v37, v149, v11, v37
  v_mul_f32 v38, v38, v10
  v_fma_f32 v38, v150, v11, v38
  v_mul_f32 v39, v39, v10
  v_fma_f32 v39, v151, v11, v39
  v_mul_f32 v40, v40, v10
  s_waitcnt lgkmcnt(1)
  v_fma_f32 v40, v152, v11, v40
  v_mul_f32 v41, v41, v10
  v_fma_f32 v41, v153, v11, v41
  v_mul_f32 v42, v42, v10
  v_fma_f32 v42, v154, v11, v42
  v_mul_f32 v43, v43, v10
  v_fma_f32 v43, v155, v11, v43
  v_mul_f32 v44, v44, v10
  s_waitcnt lgkmcnt(0)
  v_fma_f32 v44, v156, v11, v44
  v_mul_f32 v45, v45, v10
  v_fma_f32 v45, v157, v11, v45
  v_mul_f32 v46, v46, v10
  v_fma_f32 v46, v158, v11, v46
  v_mul_f32 v47, v47, v10
  v_fma_f32 v47, v159, v11, v47
  v_cvt_pk_bf16_f32 v24, v32, v33
  v_cvt_pk_bf16_f32 v25, v34, v35
  v_cvt_pk_bf16_f32 v26, v36, v37
  v_cvt_pk_bf16_f32 v27, v38, v39
  v_cvt_pk_bf16_f32 v28, v40, v41
  v_cvt_pk_bf16_f32 v29, v42, v43
  v_cvt_pk_bf16_f32 v30, v44, v45
  v_cvt_pk_bf16_f32 v31, v46, v47
  s_nop 7
L_c_10:
  v_add_u32 v9, 50688, v2
  v_add_u32 v8, 67584, v2
  ds_read_b64_tr_b16 v[144:145], v9
  ds_read_b64_tr_b16 v[146:147], v9 offset:256
  ds_read_b64_tr_b16 v[148:149], v9 offset:32
  ds_read_b64_tr_b16 v[150:151], v9 offset:288
  ds_read_b64_tr_b16 v[152:153], v9 offset:64
  ds_read_b64_tr_b16 v[154:155], v9 offset:320
  ds_read_b64_tr_b16 v[156:157], v9 offset:96
  ds_read_b64_tr_b16 v[158:159], v9 offset:352
  ds_read_b64_tr_b16 v[160:161], v9 offset:8448
  ds_read_b64_tr_b16 v[162:163], v9 offset:8704
  s_waitcnt lgkmcnt(8)
  v_mfma_f32_16x16x32_bf16 v[32:35], v[144:147], v[48:51], 0
  ds_read_b64_tr_b16 v[164:165], v9 offset:8480
  ds_read_b64_tr_b16 v[166:167], v9 offset:8736
  s_waitcnt lgkmcnt(8)
  v_mfma_f32_16x16x32_bf16 v[36:39], v[148:151], v[48:51], 0
  ds_read_b64_tr_b16 v[144:145], v9 offset:8512
  ds_read_b64_tr_b16 v[146:147], v9 offset:8768
  s_waitcnt lgkmcnt(8)
  v_mfma_f32_16x16x32_bf16 v[40:43], v[152:155], v[48:51], 0
  ds_read_b64_tr_b16 v[148:149], v9 offset:8544
  ds_read_b64_tr_b16 v[150:151], v9 offset:8800
  s_waitcnt lgkmcnt(8)
  v_mfma_f32_16x16x32_bf16 v[44:47], v[156:159], v[48:51], 0
  ds_read_b64_tr_b16 v[152:153], v8
  ds_read_b64_tr_b16 v[154:155], v8 offset:256
  s_waitcnt lgkmcnt(8)
  v_mfma_f32_16x16x32_bf16 v[32:35], v[160:163], v[52:55], v[32:35]
  ds_read_b64_tr_b16 v[156:157], v8 offset:32
  ds_read_b64_tr_b16 v[158:159], v8 offset:288
  s_waitcnt lgkmcnt(8)
  v_mfma_f32_16x16x32_bf16 v[36:39], v[164:167], v[52:55], v[36:39]
  ds_read_b64_tr_b16 v[160:161], v8 offset:64
  ds_read_b64_tr_b16 v[162:163], v8 offset:320
  s_waitcnt lgkmcnt(8)
  v_mfma_f32_16x16x32_bf16 v[40:43], v[144:147], v[52:55], v[40:43]
  ds_read_b64_tr_b16 v[164:165], v8 offset:96
  ds_read_b64_tr_b16 v[166:167], v8 offset:352
  s_waitcnt lgkmcnt(8)
  v_mfma_f32_16x16x32_bf16 v[44:47], v[148:151], v[52:55], v[44:47]
  ds_read_b64_tr_b16 v[144:145], v8 offset:8448
  ds_read_b64_tr_b16 v[146:147], v8 offset:8704
  s_waitcnt lgkmcnt(8)
  v_mfma_f32_16x16x32_bf16 v[32:35], v[152:155], v[56:59], v[32:35]
  ds_read_b64_tr_b16 v[148:149], v8 offset:8480
  ds_read_b64_tr_b16 v[150:151], v8 offset:8736
  s_waitcnt lgkmcnt(8)
  v_mfma_f32_16x16x32_bf16 v[36:39], v[156:159], v[56:59], v[36:39]
  ds_read_b64_tr_b16 v[152:153], v8 offset:8512
  ds_read_b64_tr_b16 v[154:155], v8 offset:8768
  s_waitcnt lgkmcnt(8)
  v_mfma_f32_16x16x32_bf16 v[40:43], v[160:163], v[56:59], v[40:43]
  ds_read_b64_tr_b16 v[156:157], v8 offset:8544
  ds_read_b64_tr_b16 v[158:159], v8 offset:8800
  s_waitcnt lgkmcnt(8)
  v_mfma_f32_16x16x32_bf16 v[44:47], v[164:167], v[56:59], v[44:47]
  s_waitcnt lgkmcnt(6)
  v_mfma_f32_16x16x32_bf16 v[32:35], v[144:147], v[60:63], v[32:35]
  s_waitcnt lgkmcnt(4)
  v_mfma_f32_16x16x32_bf16 v[36:39], v[148:151], v[60:63], v[36:39]
  s_waitcnt lgkmcnt(2)
  v_mfma_f32_16x16x32_bf16 v[40:43], v[152:155], v[60:63], v[40:43]
  s_waitcnt lgkmcnt(0)
  v_mfma_f32_16x16x32_bf16 v[44:47], v[156:159], v[60:63], v[44:47]
  s_barrier
  v_add_u32 v9, 84480, v2
  v_add_u32 v8, 101376, v2
  ds_read_b64_tr_b16 v[160:161], v9
  ds_read_b64_tr_b16 v[162:163], v9 offset:256
  ds_read_b64_tr_b16 v[164:165], v9 offset:32
  ds_read_b64_tr_b16 v[166:167], v9 offset:288
  ds_read_b64_tr_b16 v[144:145], v9 offset:64
  ds_read_b64_tr_b16 v[146:147], v9 offset:320
  ds_read_b64_tr_b16 v[148:149], v9 offset:96
  ds_read_b64_tr_b16 v[150:151], v9 offset:352
  v_mul_f32 v32, v32, v12
  v_mul_f32 v33, v33, v12
  v_mul_f32 v34, v34, v12
  v_mul_f32 v35, v35, v12
  v_mul_f32 v36, v36, v12
  v_mul_f32 v37, v37, v12
  v_mul_f32 v38, v38, v12
  v_mul_f32 v39, v39, v12
  v_mul_f32 v40, v40, v12
  v_mul_f32 v41, v41, v12
  v_mul_f32 v42, v42, v12
  v_mul_f32 v43, v43, v12
  v_mul_f32 v44, v44, v12
  v_mul_f32 v45, v45, v12
  v_mul_f32 v46, v46, v12
  v_mul_f32 v47, v47, v12
  ds_read_b64_tr_b16 v[152:153], v9 offset:8448
  ds_read_b64_tr_b16 v[154:155], v9 offset:8704
  s_waitcnt lgkmcnt(8)
  v_mfma_f32_16x16x32_bf16 v[32:35], v[160:163], v[64:67], v[32:35]
  ds_read_b64_tr_b16 v[156:157], v9 offset:8480
  ds_read_b64_tr_b16 v[158:159], v9 offset:8736
  s_waitcnt lgkmcnt(8)
  v_mfma_f32_16x16x32_bf16 v[36:39], v[164:167], v[64:67], v[36:39]
  ds_read_b64_tr_b16 v[160:161], v9 offset:8512
  ds_read_b64_tr_b16 v[162:163], v9 offset:8768
  s_waitcnt lgkmcnt(8)
  v_mfma_f32_16x16x32_bf16 v[40:43], v[144:147], v[64:67], v[40:43]
  ds_read_b64_tr_b16 v[164:165], v9 offset:8544
  ds_read_b64_tr_b16 v[166:167], v9 offset:8800
  s_waitcnt lgkmcnt(8)
  v_mfma_f32_16x16x32_bf16 v[44:47], v[148:151], v[64:67], v[44:47]
  ds_read_b64_tr_b16 v[144:145], v8
  ds_read_b64_tr_b16 v[146:147], v8 offset:256
  s_waitcnt lgkmcnt(8)
  v_mfma_f32_16x16x32_bf16 v[32:35], v[152:155], v[68:71], v[32:35]
  ds_read_b64_tr_b16 v[148:149], v8 offset:32
  ds_read_b64_tr_b16 v[150:151], v8 offset:288
  s_waitcnt lgkmcnt(8)
  v_mfma_f32_16x16x32_bf16 v[36:39], v[156:159], v[68:71], v[36:39]
  ds_read_b64_tr_b16 v[152:153], v8 offset:64
  ds_read_b64_tr_b16 v[154:155], v8 offset:320
  s_waitcnt lgkmcnt(8)
  v_mfma_f32_16x16x32_bf16 v[40:43], v[160:163], v[68:71], v[40:43]
  ds_read_b64_tr_b16 v[156:157], v8 offset:96
  ds_read_b64_tr_b16 v[158:159], v8 offset:352
  s_waitcnt lgkmcnt(8)
  v_mfma_f32_16x16x32_bf16 v[44:47], v[164:167], v[68:71], v[44:47]
  ds_read_b64_tr_b16 v[160:161], v8 offset:8448
  ds_read_b64_tr_b16 v[162:163], v8 offset:8704
  s_waitcnt lgkmcnt(8)
  v_mfma_f32_16x16x32_bf16 v[32:35], v[144:147], v[72:75], v[32:35]
  ds_read_b64_tr_b16 v[164:165], v8 offset:8480
  ds_read_b64_tr_b16 v[166:167], v8 offset:8736
  s_waitcnt lgkmcnt(8)
  v_mfma_f32_16x16x32_bf16 v[36:39], v[148:151], v[72:75], v[36:39]
  ds_read_b64_tr_b16 v[144:145], v8 offset:8512
  ds_read_b64_tr_b16 v[146:147], v8 offset:8768
  s_waitcnt lgkmcnt(8)
  v_mfma_f32_16x16x32_bf16 v[40:43], v[152:155], v[72:75], v[40:43]
  ds_read_b64_tr_b16 v[148:149], v8 offset:8544
  ds_read_b64_tr_b16 v[150:151], v8 offset:8800
  s_waitcnt lgkmcnt(8)
  v_mfma_f32_16x16x32_bf16 v[44:47], v[156:159], v[72:75], v[44:47]
  s_waitcnt lgkmcnt(6)
  v_mfma_f32_16x16x32_bf16 v[32:35], v[160:163], v[76:79], v[32:35]
  s_waitcnt lgkmcnt(4)
  v_mfma_f32_16x16x32_bf16 v[36:39], v[164:167], v[76:79], v[36:39]
  s_waitcnt lgkmcnt(2)
  v_mfma_f32_16x16x32_bf16 v[40:43], v[144:147], v[76:79], v[40:43]
  s_waitcnt lgkmcnt(0)
  v_mfma_f32_16x16x32_bf16 v[44:47], v[148:151], v[76:79], v[44:47]
  s_barrier
  v_add_u32 v9, 118272, v2
  v_add_u32 v8, 0, v2
  ds_read_b64_tr_b16 v[152:153], v9
  ds_read_b64_tr_b16 v[154:155], v9 offset:256
  ds_read_b64_tr_b16 v[156:157], v9 offset:32
  ds_read_b64_tr_b16 v[158:159], v9 offset:288
  ds_read_b64_tr_b16 v[160:161], v9 offset:64
  ds_read_b64_tr_b16 v[162:163], v9 offset:320
  ds_read_b64_tr_b16 v[164:165], v9 offset:96
  ds_read_b64_tr_b16 v[166:167], v9 offset:352
  v_mul_f32 v32, v32, v13
  v_mul_f32 v33, v33, v13
  v_mul_f32 v34, v34, v13
  v_mul_f32 v35, v35, v13
  v_mul_f32 v36, v36, v13
  v_mul_f32 v37, v37, v13
  v_mul_f32 v38, v38, v13
  v_mul_f32 v39, v39, v13
  v_mul_f32 v40, v40, v13
  v_mul_f32 v41, v41, v13
  v_mul_f32 v42, v42, v13
  v_mul_f32 v43, v43, v13
  v_mul_f32 v44, v44, v13
  v_mul_f32 v45, v45, v13
  v_mul_f32 v46, v46, v13
  v_mul_f32 v47, v47, v13
  ds_read_b64_tr_b16 v[144:145], v9 offset:8448
  ds_read_b64_tr_b16 v[146:147], v9 offset:8704
  s_waitcnt lgkmcnt(8)
  v_mfma_f32_16x16x32_bf16 v[32:35], v[152:155], v[80:83], v[32:35]
  ds_read_b64_tr_b16 v[148:149], v9 offset:8480
  ds_read_b64_tr_b16 v[150:151], v9 offset:8736
  s_waitcnt lgkmcnt(8)
  v_mfma_f32_16x16x32_bf16 v[36:39], v[156:159], v[80:83], v[36:39]
  ds_read_b64_tr_b16 v[152:153], v9 offset:8512
  ds_read_b64_tr_b16 v[154:155], v9 offset:8768
  s_waitcnt lgkmcnt(8)
  v_mfma_f32_16x16x32_bf16 v[40:43], v[160:163], v[80:83], v[40:43]
  ds_read_b64_tr_b16 v[156:157], v9 offset:8544
  ds_read_b64_tr_b16 v[158:159], v9 offset:8800
  s_waitcnt lgkmcnt(8)
  v_mfma_f32_16x16x32_bf16 v[44:47], v[164:167], v[80:83], v[44:47]
  ds_read_b64_tr_b16 v[160:161], v8
  ds_read_b64_tr_b16 v[162:163], v8 offset:256
  s_waitcnt lgkmcnt(8)
  v_mfma_f32_16x16x32_bf16 v[32:35], v[144:147], v[84:87], v[32:35]
  ds_read_b64_tr_b16 v[164:165], v8 offset:32
  ds_read_b64_tr_b16 v[166:167], v8 offset:288
  s_waitcnt lgkmcnt(8)
  v_mfma_f32_16x16x32_bf16 v[36:39], v[148:151], v[84:87], v[36:39]
  ds_read_b64_tr_b16 v[144:145], v8 offset:64
  ds_read_b64_tr_b16 v[146:147], v8 offset:320
  s_waitcnt lgkmcnt(8)
  v_mfma_f32_16x16x32_bf16 v[40:43], v[152:155], v[84:87], v[40:43]
  ds_read_b64_tr_b16 v[148:149], v8 offset:96
  ds_read_b64_tr_b16 v[150:151], v8 offset:352
  s_waitcnt lgkmcnt(8)
  v_mfma_f32_16x16x32_bf16 v[44:47], v[156:159], v[84:87], v[44:47]
  ds_read_b64_tr_b16 v[152:153], v8 offset:8448
  ds_read_b64_tr_b16 v[154:155], v8 offset:8704
  s_waitcnt lgkmcnt(8)
  v_mfma_f32_16x16x32_bf16 v[32:35], v[160:163], v[88:91], v[32:35]
  ds_read_b64_tr_b16 v[156:157], v8 offset:8480
  ds_read_b64_tr_b16 v[158:159], v8 offset:8736
  s_waitcnt lgkmcnt(8)
  v_mfma_f32_16x16x32_bf16 v[36:39], v[164:167], v[88:91], v[36:39]
  ds_read_b64_tr_b16 v[160:161], v8 offset:8512
  ds_read_b64_tr_b16 v[162:163], v8 offset:8768
  s_waitcnt lgkmcnt(8)
  v_mfma_f32_16x16x32_bf16 v[40:43], v[144:147], v[88:91], v[40:43]
  ds_read_b64_tr_b16 v[164:165], v8 offset:8544
  ds_read_b64_tr_b16 v[166:167], v8 offset:8800
  s_waitcnt lgkmcnt(8)
  v_mfma_f32_16x16x32_bf16 v[44:47], v[148:151], v[88:91], v[44:47]
  s_waitcnt lgkmcnt(6)
  v_mfma_f32_16x16x32_bf16 v[32:35], v[152:155], v[92:95], v[32:35]
  s_waitcnt lgkmcnt(4)
  v_mfma_f32_16x16x32_bf16 v[36:39], v[156:159], v[92:95], v[36:39]
  s_waitcnt lgkmcnt(2)
  v_mfma_f32_16x16x32_bf16 v[40:43], v[160:163], v[92:95], v[40:43]
  s_waitcnt lgkmcnt(0)
  v_mfma_f32_16x16x32_bf16 v[44:47], v[164:167], v[92:95], v[44:47]
  s_barrier
  v_add_u32 v9, 16896, v2
  v_add_u32 v8, 33792, v2
  ds_read_b64_tr_b16 v[144:145], v9
  ds_read_b64_tr_b16 v[146:147], v9 offset:256
  ds_read_b64_tr_b16 v[148:149], v9 offset:32
  ds_read_b64_tr_b16 v[150:151], v9 offset:288
  ds_read_b64_tr_b16 v[152:153], v9 offset:64
  ds_read_b64_tr_b16 v[154:155], v9 offset:320
  ds_read_b64_tr_b16 v[156:157], v9 offset:96
  ds_read_b64_tr_b16 v[158:159], v9 offset:352
  v_mul_f32 v32, v32, v3
  v_mul_f32 v33, v33, v3
  v_mul_f32 v34, v34, v3
  v_mul_f32 v35, v35, v3
  v_mul_f32 v36, v36, v3
  v_mul_f32 v37, v37, v3
  v_mul_f32 v38, v38, v3
  v_mul_f32 v39, v39, v3
  v_mul_f32 v40, v40, v3
  v_mul_f32 v41, v41, v3
  v_mul_f32 v42, v42, v3
  v_mul_f32 v43, v43, v3
  v_mul_f32 v44, v44, v3
  v_mul_f32 v45, v45, v3
  v_mul_f32 v46, v46, v3
  v_mul_f32 v47, v47, v3
  ds_read_b64_tr_b16 v[160:161], v9 offset:8448
  ds_read_b64_tr_b16 v[162:163], v9 offset:8704
  s_waitcnt lgkmcnt(8)
  v_mfma_f32_16x16x32_bf16 v[32:35], v[144:147], v[96:99], v[32:35]
  ds_read_b64_tr_b16 v[164:165], v9 offset:8480
  ds_read_b64_tr_b16 v[166:167], v9 offset:8736
  s_waitcnt lgkmcnt(8)
  v_mfma_f32_16x16x32_bf16 v[36:39], v[148:151], v[96:99], v[36:39]
  ds_read_b64_tr_b16 v[144:145], v9 offset:8512
  ds_read_b64_tr_b16 v[146:147], v9 offset:8768
  s_waitcnt lgkmcnt(8)
  v_mfma_f32_16x16x32_bf16 v[40:43], v[152:155], v[96:99], v[40:43]
  ds_read_b64_tr_b16 v[148:149], v9 offset:8544
  ds_read_b64_tr_b16 v[150:151], v9 offset:8800
  s_waitcnt lgkmcnt(8)
  v_mfma_f32_16x16x32_bf16 v[44:47], v[156:159], v[96:99], v[44:47]
  ds_read_b64_tr_b16 v[152:153], v8
  ds_read_b64_tr_b16 v[154:155], v8 offset:256
  s_waitcnt lgkmcnt(8)
  v_mfma_f32_16x16x32_bf16 v[32:35], v[160:163], v[100:103], v[32:35]
  ds_read_b64_tr_b16 v[156:157], v8 offset:32
  ds_read_b64_tr_b16 v[158:159], v8 offset:288
  s_waitcnt lgkmcnt(8)
  v_mfma_f32_16x16x32_bf16 v[36:39], v[164:167], v[100:103], v[36:39]
  ds_read_b64_tr_b16 v[160:161], v8 offset:64
  ds_read_b64_tr_b16 v[162:163], v8 offset:320
  s_waitcnt lgkmcnt(8)
  v_mfma_f32_16x16x32_bf16 v[40:43], v[144:147], v[100:103], v[40:43]
  ds_read_b64_tr_b16 v[164:165], v8 offset:96
  ds_read_b64_tr_b16 v[166:167], v8 offset:352
  s_waitcnt lgkmcnt(8)
  v_mfma_f32_16x16x32_bf16 v[44:47], v[148:151], v[100:103], v[44:47]
  ds_read_b64_tr_b16 v[144:145], v8 offset:8448
  ds_read_b64_tr_b16 v[146:147], v8 offset:8704
  s_waitcnt lgkmcnt(8)
  v_mfma_f32_16x16x32_bf16 v[32:35], v[152:155], v[104:107], v[32:35]
  ds_read_b64_tr_b16 v[148:149], v8 offset:8480
  ds_read_b64_tr_b16 v[150:151], v8 offset:8736
  s_waitcnt lgkmcnt(8)
  v_mfma_f32_16x16x32_bf16 v[36:39], v[156:159], v[104:107], v[36:39]
  ds_read_b64_tr_b16 v[152:153], v8 offset:8512
  ds_read_b64_tr_b16 v[154:155], v8 offset:8768
  s_waitcnt lgkmcnt(8)
  v_mfma_f32_16x16x32_bf16 v[40:43], v[160:163], v[104:107], v[40:43]
  ds_read_b64_tr_b16 v[156:157], v8 offset:8544
  ds_read_b64_tr_b16 v[158:159], v8 offset:8800
  s_waitcnt lgkmcnt(8)
  v_mfma_f32_16x16x32_bf16 v[44:47], v[164:167], v[104:107], v[44:47]
  s_waitcnt lgkmcnt(6)
  v_mfma_f32_16x16x32_bf16 v[32:35], v[144:147], v[108:111], v[32:35]
  s_waitcnt lgkmcnt(4)
  v_mfma_f32_16x16x32_bf16 v[36:39], v[148:151], v[108:111], v[36:39]
  s_waitcnt lgkmcnt(2)
  v_mfma_f32_16x16x32_bf16 v[40:43], v[152:155], v[108:111], v[40:43]
  s_waitcnt lgkmcnt(0)
  v_mfma_f32_16x16x32_bf16 v[44:47], v[156:159], v[108:111], v[44:47]
  s_nop 7
  s_cmp_eq_u32 s26, 1
  s_cbranch_scc0 L_c_11
  ds_write_b128 v14, v[32:35]
  ds_write_b128 v14, v[36:39] offset:1024
  ds_write_b128 v14, v[40:43] offset:2048
  ds_write_b128 v14, v[44:47] offset:3072
  s_waitcnt lgkmcnt(0)
  s_nop 7
L_c_11:
  s_barrier
  s_nop 7
  s_cmp_eq_u32 s26, 0
  s_cbranch_scc0 L_c_12
  ds_read_b128 v[144:147], v14
  ds_read_b128 v[148:151], v14 offset:1024
  ds_read_b128 v[152:155], v14 offset:2048
  ds_read_b128 v[156:159], v14 offset:3072
  v_mul_f32 v32, v32, v10
  s_waitcnt lgkmcnt(3)
  v_fma_f32 v32, v144, v11, v32
  v_mul_f32 v33, v33, v10
  v_fma_f32 v33, v145, v11, v33
  v_mul_f32 v34, v34, v10
  v_fma_f32 v34, v146, v11, v34
  v_mul_f32 v35, v35, v10
  v_fma_f32 v35, v147, v11, v35
  v_mul_f32 v36, v36, v10
  s_waitcnt lgkmcnt(2)
  v_fma_f32 v36, v148, v11, v36
  v_mul_f32 v37, v37, v10
  v_fma_f32 v37, v149, v11, v37
  v_mul_f32 v38, v38, v10
  v_fma_f32 v38, v150, v11, v38
  v_mul_f32 v39, v39, v10
  v_fma_f32 v39, v151, v11, v39
  v_mul_f32 v40, v40, v10
  s_waitcnt lgkmcnt(1)
  v_fma_f32 v40, v152, v11, v40
  v_mul_f32 v41, v41, v10
  v_fma_f32 v41, v153, v11, v41
  v_mul_f32 v42, v42, v10
  v_fma_f32 v42, v154, v11, v42
  v_mul_f32 v43, v43, v10
  v_fma_f32 v43, v155, v11, v43
  v_mul_f32 v44, v44, v10
  s_waitcnt lgkmcnt(0)
  v_fma_f32 v44, v156, v11, v44
  v_mul_f32 v45, v45, v10
  v_fma_f32 v45, v157, v11, v45
  v_mul_f32 v46, v46, v10
  v_fma_f32 v46, v158, v11, v46
  v_mul_f32 v47, v47, v10
  v_fma_f32 v47, v159, v11, v47
  v_cvt_pk_bf16_f32 v128, v32, v33
  v_cvt_pk_bf16_f32 v129, v34, v35
  v_cvt_pk_bf16_f32 v130, v36, v37
  v_cvt_pk_bf16_f32 v131, v38, v39
  v_cvt_pk_bf16_f32 v132, v40, v41
  v_cvt_pk_bf16_f32 v133, v42, v43
  v_cvt_pk_bf16_f32 v134, v44, v45
  v_cvt_pk_bf16_f32 v135, v46, v47
  s_nop 7
L_c_12:
  v_add_u32 v9, 50688, v2
  v_add_u32 v8, 67584, v2
  ds_read_b64_tr_b16 v[160:161], v9
  ds_read_b64_tr_b16 v[162:163], v9 offset:256
  ds_read_b64_tr_b16 v[164:165], v9 offset:32
  ds_read_b64_tr_b16 v[166:167], v9 offset:288
  ds_read_b64_tr_b16 v[144:145], v9 offset:64
  ds_read_b64_tr_b16 v[146:147], v9 offset:320
  ds_read_b64_tr_b16 v[148:149], v9 offset:96
  ds_read_b64_tr_b16 v[150:151], v9 offset:352
  ds_read_b64_tr_b16 v[152:153], v9 offset:8448
  ds_read_b64_tr_b16 v[154:155], v9 offset:8704
  s_waitcnt lgkmcnt(8)
  v_mfma_f32_16x16x32_bf16 v[32:35], v[160:163], v[48:51], 0
  ds_read_b64_tr_b16 v[156:157], v9 offset:8480
  ds_read_b64_tr_b16 v[158:159], v9 offset:8736
  s_waitcnt lgkmcnt(8)
  v_mfma_f32_16x16x32_bf16 v[36:39], v[164:167], v[48:51], 0
  ds_read_b64_tr_b16 v[160:161], v9 offset:8512
  ds_read_b64_tr_b16 v[162:163], v9 offset:8768
  s_waitcnt lgkmcnt(8)
  v_mfma_f32_16x16x32_bf16 v[40:43], v[144:147], v[48:51], 0
  ds_read_b64_tr_b16 v[164:165], v9 offset:8544
  ds_read_b64_tr_b16 v[166:167], v9 offset:8800
  s_waitcnt lgkmcnt(8)
  v_mfma_f32_16x16x32_bf16 v[44:47], v[148:151], v[48:51], 0
  ds_read_b64_tr_b16 v[144:145], v8
  ds_read_b64_tr_b16 v[146:147], v8 offset:256
  s_waitcnt lgkmcnt(8)
  v_mfma_f32_16x16x32_bf16 v[32:35], v[152:155], v[52:55], v[32:35]
  ds_read_b64_tr_b16 v[148:149], v8 offset:32
  ds_read_b64_tr_b16 v[150:151], v8 offset:288
  s_waitcnt lgkmcnt(8)
  v_mfma_f32_16x16x32_bf16 v[36:39], v[156:159], v[52:55], v[36:39]
  ds_read_b64_tr_b16 v[152:153], v8 offset:64
  ds_read_b64_tr_b16 v[154:155], v8 offset:320
  s_waitcnt lgkmcnt(8)
  v_mfma_f32_16x16x32_bf16 v[40:43], v[160:163], v[52:55], v[40:43]
  ds_read_b64_tr_b16 v[156:157], v8 offset:96
  ds_read_b64_tr_b16 v[158:159], v8 offset:352
  s_waitcnt lgkmcnt(8)
  v_mfma_f32_16x16x32_bf16 v[44:47], v[164:167], v[52:55], v[44:47]
  ds_read_b64_tr_b16 v[160:161], v8 offset:8448
  ds_read_b64_tr_b16 v[162:163], v8 offset:8704
  s_waitcnt lgkmcnt(8)
  v_mfma_f32_16x16x32_bf16 v[32:35], v[144:147], v[56:59], v[32:35]
  ds_read_b64_tr_b16 v[164:165], v8 offset:8480
  ds_read_b64_tr_b16 v[166:167], v8 offset:8736
  s_waitcnt lgkmcnt(8)
  v_mfma_f32_16x16x32_bf16 v[36:39], v[148:151], v[56:59], v[36:39]
  ds_read_b64_tr_b16 v[144:145], v8 offset:8512
  ds_read_b64_tr_b16 v[146:147], v8 offset:8768
  s_waitcnt lgkmcnt(8)
  v_mfma_f32_16x16x32_bf16 v[40:43], v[152:155], v[56:59], v[40:43]
  ds_read_b64_tr_b16 v[148:149], v8 offset:8544
  ds_read_b64_tr_b16 v[150:151], v8 offset:8800
  s_waitcnt lgkmcnt(8)
  v_mfma_f32_16x16x32_bf16 v[44:47], v[156:159], v[56:59], v[44:47]
  s_waitcnt lgkmcnt(6)
  v_mfma_f32_16x16x32_bf16 v[32:35], v[160:163], v[60:63], v[32:35]
  s_waitcnt lgkmcnt(4)
  v_mfma_f32_16x16x32_bf16 v[36:39], v[164:167], v[60:63], v[36:39]
  s_waitcnt lgkmcnt(2)
  v_mfma_f32_16x16x32_bf16 v[40:43], v[144:147], v[60:63], v[40:43]
  s_waitcnt lgkmcnt(0)
  v_mfma_f32_16x16x32_bf16 v[44:47], v[148:151], v[60:63], v[44:47]
  s_barrier
  v_add_u32 v9, 84480, v2
  v_add_u32 v8, 101376, v2
  ds_read_b64_tr_b16 v[152:153], v9
  ds_read_b64_tr_b16 v[154:155], v9 offset:256
  ds_read_b64_tr_b16 v[156:157], v9 offset:32
  ds_read_b64_tr_b16 v[158:159], v9 offset:288
  ds_read_b64_tr_b16 v[160:161], v9 offset:64
  ds_read_b64_tr_b16 v[162:163], v9 offset:320
  ds_read_b64_tr_b16 v[164:165], v9 offset:96
  ds_read_b64_tr_b16 v[166:167], v9 offset:352
  v_mul_f32 v32, v32, v12
  v_mul_f32 v33, v33, v12
  v_mul_f32 v34, v34, v12
  v_mul_f32 v35, v35, v12
  v_mul_f32 v36, v36, v12
  v_mul_f32 v37, v37, v12
  v_mul_f32 v38, v38, v12
  v_mul_f32 v39, v39, v12
  v_mul_f32 v40, v40, v12
  v_mul_f32 v41, v41, v12
  v_mul_f32 v42, v42, v12
  v_mul_f32 v43, v43, v12
  v_mul_f32 v44, v44, v12
  v_mul_f32 v45, v45, v12
  v_mul_f32 v46, v46, v12
  v_mul_f32 v47, v47, v12
  ds_read_b64_tr_b16 v[144:145], v9 offset:8448
  ds_read_b64_tr_b16 v[146:147], v9 offset:8704
  s_waitcnt lgkmcnt(8)
  v_mfma_f32_16x16x32_bf16 v[32:35], v[152:155], v[64:67], v[32:35]
  ds_read_b64_tr_b16 v[148:149], v9 offset:8480
  ds_read_b64_tr_b16 v[150:151], v9 offset:8736
  s_waitcnt lgkmcnt(8)
  v_mfma_f32_16x16x32_bf16 v[36:39], v[156:159], v[64:67], v[36:39]
  ds_read_b64_tr_b16 v[152:153], v9 offset:8512
  ds_read_b64_tr_b16 v[154:155], v9 offset:8768
  s_waitcnt lgkmcnt(8)
  v_mfma_f32_16x16x32_bf16 v[40:43], v[160:163], v[64:67], v[40:43]
  ds_read_b64_tr_b16 v[156:157], v9 offset:8544
  ds_read_b64_tr_b16 v[158:159], v9 offset:8800
  s_waitcnt lgkmcnt(8)
  v_mfma_f32_16x16x32_bf16 v[44:47], v[164:167], v[64:67], v[44:47]
  ds_read_b64_tr_b16 v[160:161], v8
  ds_read_b64_tr_b16 v[162:163], v8 offset:256
  s_waitcnt lgkmcnt(8)
  v_mfma_f32_16x16x32_bf16 v[32:35], v[144:147], v[68:71], v[32:35]
  ds_read_b64_tr_b16 v[164:165], v8 offset:32
  ds_read_b64_tr_b16 v[166:167], v8 offset:288
  s_waitcnt lgkmcnt(8)
  v_mfma_f32_16x16x32_bf16 v[36:39], v[148:151], v[68:71], v[36:39]
  ds_read_b64_tr_b16 v[144:145], v8 offset:64
  ds_read_b64_tr_b16 v[146:147], v8 offset:320
  s_waitcnt lgkmcnt(8)
  v_mfma_f32_16x16x32_bf16 v[40:43], v[152:155], v[68:71], v[40:43]
  ds_read_b64_tr_b16 v[148:149], v8 offset:96
  ds_read_b64_tr_b16 v[150:151], v8 offset:352
  s_waitcnt lgkmcnt(8)
  v_mfma_f32_16x16x32_bf16 v[44:47], v[156:159], v[68:71], v[44:47]
  ds_read_b64_tr_b16 v[152:153], v8 offset:8448
  ds_read_b64_tr_b16 v[154:155], v8 offset:8704
  s_waitcnt lgkmcnt(8)
  v_mfma_f32_16x16x32_bf16 v[32:35], v[160:163], v[72:75], v[32:35]
  ds_read_b64_tr_b16 v[156:157], v8 offset:8480
  ds_read_b64_tr_b16 v[158:159], v8 offset:8736
  s_waitcnt lgkmcnt(8)
  v_mfma_f32_16x16x32_bf16 v[36:39], v[164:167], v[72:75], v[36:39]
  ds_read_b64_tr_b16 v[160:161], v8 offset:8512
  ds_read_b64_tr_b16 v[162:163], v8 offset:8768
  s_waitcnt lgkmcnt(8)
  v_mfma_f32_16x16x32_bf16 v[40:43], v[144:147], v[72:75], v[40:43]
  ds_read_b64_tr_b16 v[164:165], v8 offset:8544
  ds_read_b64_tr_b16 v[166:167], v8 offset:8800
  s_waitcnt lgkmcnt(8)
  v_mfma_f32_16x16x32_bf16 v[44:47], v[148:151], v[72:75], v[44:47]
  s_waitcnt lgkmcnt(6)
  v_mfma_f32_16x16x32_bf16 v[32:35], v[152:155], v[76:79], v[32:35]
  s_waitcnt lgkmcnt(4)
  v_mfma_f32_16x16x32_bf16 v[36:39], v[156:159], v[76:79], v[36:39]
  s_waitcnt lgkmcnt(2)
  v_mfma_f32_16x16x32_bf16 v[40:43], v[160:163], v[76:79], v[40:43]
  s_waitcnt lgkmcnt(0)
  v_mfma_f32_16x16x32_bf16 v[44:47], v[164:167], v[76:79], v[44:47]
  s_barrier
  v_add_u32 v9, 118272, v2
  v_add_u32 v8, 0, v2
  ds_read_b64_tr_b16 v[144:145], v9
  ds_read_b64_tr_b16 v[146:147], v9 offset:256
  ds_read_b64_tr_b16 v[148:149], v9 offset:32
  ds_read_b64_tr_b16 v[150:151], v9 offset:288
  ds_read_b64_tr_b16 v[152:153], v9 offset:64
  ds_read_b64_tr_b16 v[154:155], v9 offset:320
  ds_read_b64_tr_b16 v[156:157], v9 offset:96
  ds_read_b64_tr_b16 v[158:159], v9 offset:352
  v_mul_f32 v32, v32, v13
  v_mul_f32 v33, v33, v13
  v_mul_f32 v34, v34, v13
  v_mul_f32 v35, v35, v13
  v_mul_f32 v36, v36, v13
  v_mul_f32 v37, v37, v13
  v_mul_f32 v38, v38, v13
  v_mul_f32 v39, v39, v13
  v_mul_f32 v40, v40, v13
  v_mul_f32 v41, v41, v13
  v_mul_f32 v42, v42, v13
  v_mul_f32 v43, v43, v13
  v_mul_f32 v44, v44, v13
  v_mul_f32 v45, v45, v13
  v_mul_f32 v46, v46, v13
  v_mul_f32 v47, v47, v13
  ds_read_b64_tr_b16 v[160:161], v9 offset:8448
  ds_read_b64_tr_b16 v[162:163], v9 offset:8704
  s_waitcnt lgkmcnt(8)
  v_mfma_f32_16x16x32_bf16 v[32:35], v[144:147], v[80:83], v[32:35]
  ds_read_b64_tr_b16 v[164:165], v9 offset:8480
  ds_read_b64_tr_b16 v[166:167], v9 offset:8736
  s_waitcnt lgkmcnt(8)
  v_mfma_f32_16x16x32_bf16 v[36:39], v[148:151], v[80:83], v[36:39]
  ds_read_b64_tr_b16 v[144:145], v9 offset:8512
  ds_read_b64_tr_b16 v[146:147], v9 offset:8768
  s_waitcnt lgkmcnt(8)
  v_mfma_f32_16x16x32_bf16 v[40:43], v[152:155], v[80:83], v[40:43]
  ds_read_b64_tr_b16 v[148:149], v9 offset:8544
  ds_read_b64_tr_b16 v[150:151], v9 offset:8800
  s_waitcnt lgkmcnt(8)
  v_mfma_f32_16x16x32_bf16 v[44:47], v[156:159], v[80:83], v[44:47]
  ds_read_b64_tr_b16 v[152:153], v8
  ds_read_b64_tr_b16 v[154:155], v8 offset:256
  s_waitcnt lgkmcnt(8)
  v_mfma_f32_16x16x32_bf16 v[32:35], v[160:163], v[84:87], v[32:35]
  ds_read_b64_tr_b16 v[156:157], v8 offset:32
  ds_read_b64_tr_b16 v[158:159], v8 offset:288
  s_waitcnt lgkmcnt(8)
  v_mfma_f32_16x16x32_bf16 v[36:39], v[164:167], v[84:87], v[36:39]
  ds_read_b64_tr_b16 v[160:161], v8 offset:64
  ds_read_b64_tr_b16 v[162:163], v8 offset:320
  s_waitcnt lgkmcnt(8)
  v_mfma_f32_16x16x32_bf16 v[40:43], v[144:147], v[84:87], v[40:43]
  ds_read_b64_tr_b16 v[164:165], v8 offset:96
  ds_read_b64_tr_b16 v[166:167], v8 offset:352
  s_waitcnt lgkmcnt(8)
  v_mfma_f32_16x16x32_bf16 v[44:47], v[148:151], v[84:87], v[44:47]
  ds_read_b64_tr_b16 v[144:145], v8 offset:8448
  ds_read_b64_tr_b16 v[146:147], v8 offset:8704
  s_waitcnt lgkmcnt(8)
  v_mfma_f32_16x16x32_bf16 v[32:35], v[152:155], v[88:91], v[32:35]
  ds_read_b64_tr_b16 v[148:149], v8 offset:8480
  ds_read_b64_tr_b16 v[150:151], v8 offset:8736
  s_waitcnt lgkmcnt(8)
  v_mfma_f32_16x16x32_bf16 v[36:39], v[156:159], v[88:91], v[36:39]
  ds_read_b64_tr_b16 v[152:153], v8 offset:8512
  ds_read_b64_tr_b16 v[154:155], v8 offset:8768
  s_waitcnt lgkmcnt(8)
  v_mfma_f32_16x16x32_bf16 v[40:43], v[160:163], v[88:91], v[40:43]
  ds_read_b64_tr_b16 v[156:157], v8 offset:8544
  ds_read_b64_tr_b16 v[158:159], v8 offset:8800
  s_waitcnt lgkmcnt(8)
  v_mfma_f32_16x16x32_bf16 v[44:47], v[164:167], v[88:91], v[44:47]
  s_waitcnt lgkmcnt(6)
  v_mfma_f32_16x16x32_bf16 v[32:35], v[144:147], v[92:95], v[32:35]
  s_waitcnt lgkmcnt(4)
  v_mfma_f32_16x16x32_bf16 v[36:39], v[148:151], v[92:95], v[36:39]
  s_waitcnt lgkmcnt(2)
  v_mfma_f32_16x16x32_bf16 v[40:43], v[152:155], v[92:95], v[40:43]
  s_waitcnt lgkmcnt(0)
  v_mfma_f32_16x16x32_bf16 v[44:47], v[156:159], v[92:95], v[44:47]
  s_barrier
  v_add_u32 v9, 16896, v2
  v_add_u32 v8, 33792, v2
  ds_read_b64_tr_b16 v[160:161], v9
  ds_read_b64_tr_b16 v[162:163], v9 offset:256
  ds_read_b64_tr_b16 v[164:165], v9 offset:32
  ds_read_b64_tr_b16 v[166:167], v9 offset:288
  ds_read_b64_tr_b16 v[144:145], v9 offset:64
  ds_read_b64_tr_b16 v[146:147], v9 offset:320
  ds_read_b64_tr_b16 v[148:149], v9 offset:96
  ds_read_b64_tr_b16 v[150:151], v9 offset:352
  v_mul_f32 v32, v32, v3
  v_mul_f32 v33, v33, v3
  v_mul_f32 v34, v34, v3
  v_mul_f32 v35, v35, v3
  v_mul_f32 v36, v36, v3
  v_mul_f32 v37, v37, v3
  v_mul_f32 v38, v38, v3
  v_mul_f32 v39, v39, v3
  v_mul_f32 v40, v40, v3
  v_mul_f32 v41, v41, v3
  v_mul_f32 v42, v42, v3
  v_mul_f32 v43, v43, v3
  v_mul_f32 v44, v44, v3
  v_mul_f32 v45, v45, v3
  v_mul_f32 v46, v46, v3
  v_mul_f32 v47, v47, v3
  ds_read_b64_tr_b16 v[152:153], v9 offset:8448
  ds_read_b64_tr_b16 v[154:155], v9 offset:8704
  s_waitcnt lgkmcnt(8)
  v_mfma_f32_16x16x32_bf16 v[32:35], v[160:163], v[96:99], v[32:35]
  ds_read_b64_tr_b16 v[156:157], v9 offset:8480
  ds_read_b64_tr_b16 v[158:159], v9 offset:8736
  s_waitcnt lgkmcnt(8)
  v_mfma_f32_16x16x32_bf16 v[36:39], v[164:167], v[96:99], v[36:39]
  ds_read_b64_tr_b16 v[160:161], v9 offset:8512
  ds_read_b64_tr_b16 v[162:163], v9 offset:8768
  s_waitcnt lgkmcnt(8)
  v_mfma_f32_16x16x32_bf16 v[40:43], v[144:147], v[96:99], v[40:43]
  ds_read_b64_tr_b16 v[164:165], v9 offset:8544
  ds_read_b64_tr_b16 v[166:167], v9 offset:8800
  s_waitcnt lgkmcnt(8)
  v_mfma_f32_16x16x32_bf16 v[44:47], v[148:151], v[96:99], v[44:47]
  ds_read_b64_tr_b16 v[144:145], v8
  ds_read_b64_tr_b16 v[146:147], v8 offset:256
  s_waitcnt lgkmcnt(8)
  v_mfma_f32_16x16x32_bf16 v[32:35], v[152:155], v[100:103], v[32:35]
  ds_read_b64_tr_b16 v[148:149], v8 offset:32
  ds_read_b64_tr_b16 v[150:151], v8 offset:288
  s_waitcnt lgkmcnt(8)
  v_mfma_f32_16x16x32_bf16 v[36:39], v[156:159], v[100:103], v[36:39]
  ds_read_b64_tr_b16 v[152:153], v8 offset:64
  ds_read_b64_tr_b16 v[154:155], v8 offset:320
  s_waitcnt lgkmcnt(8)
  v_mfma_f32_16x16x32_bf16 v[40:43], v[160:163], v[100:103], v[40:43]
  ds_read_b64_tr_b16 v[156:157], v8 offset:96
  ds_read_b64_tr_b16 v[158:159], v8 offset:352
  s_waitcnt lgkmcnt(8)
  v_mfma_f32_16x16x32_bf16 v[44:47], v[164:167], v[100:103], v[44:47]
  ds_read_b64_tr_b16 v[160:161], v8 offset:8448
  ds_read_b64_tr_b16 v[162:163], v8 offset:8704
  s_waitcnt lgkmcnt(8)
  v_mfma_f32_16x16x32_bf16 v[32:35], v[144:147], v[104:107], v[32:35]
  ds_read_b64_tr_b16 v[164:165], v8 offset:8480
  ds_read_b64_tr_b16 v[166:167], v8 offset:8736
  s_waitcnt lgkmcnt(8)
  v_mfma_f32_16x16x32_bf16 v[36:39], v[148:151], v[104:107], v[36:39]
  ds_read_b64_tr_b16 v[144:145], v8 offset:8512
  ds_read_b64_tr_b16 v[146:147], v8 offset:8768
  s_waitcnt lgkmcnt(8)
  v_mfma_f32_16x16x32_bf16 v[40:43], v[152:155], v[104:107], v[40:43]
  ds_read_b64_tr_b16 v[148:149], v8 offset:8544
  ds_read_b64_tr_b16 v[150:151], v8 offset:8800
  s_waitcnt lgkmcnt(8)
  v_mfma_f32_16x16x32_bf16 v[44:47], v[156:159], v[104:107], v[44:47]
  s_waitcnt lgkmcnt(6)
  v_mfma_f32_16x16x32_bf16 v[32:35], v[160:163], v[108:111], v[32:35]
  s_waitcnt lgkmcnt(4)
  v_mfma_f32_16x16x32_bf16 v[36:39], v[164:167], v[108:111], v[36:39]
  s_waitcnt lgkmcnt(2)
  v_mfma_f32_16x16x32_bf16 v[40:43], v[144:147], v[108:111], v[40:43]
  s_waitcnt lgkmcnt(0)
  v_mfma_f32_16x16x32_bf16 v[44:47], v[148:151], v[108:111], v[44:47]
  s_nop 7
  s_cmp_eq_u32 s26, 1
  s_cbranch_scc0 L_c_13
  ds_write_b128 v14, v[32:35]
  ds_write_b128 v14, v[36:39] offset:1024
  ds_write_b128 v14, v[40:43] offset:2048
  ds_write_b128 v14, v[44:47] offset:3072
  s_waitcnt lgkmcnt(0)
  s_nop 7
L_c_13:
  s_barrier
  s_nop 7
  s_cmp_eq_u32 s26, 0
  s_cbranch_scc0 L_c_14
  ds_read_b128 v[144:147], v14
  ds_read_b128 v[148:151], v14 offset:1024
  ds_read_b128 v[152:155], v14 offset:2048
  ds_read_b128 v[156:159], v14 offset:3072
  v_mul_f32 v32, v32, v10
  s_waitcnt lgkmcnt(3)
  v_fma_f32 v32, v144, v11, v32
  v_mul_f32 v33, v33, v10
  v_fma_f32 v33, v145, v11, v33
  v_mul_f32 v34, v34, v10
  v_fma_f32 v34, v146, v11, v34
  v_mul_f32 v35, v35, v10
  v_fma_f32 v35, v147, v11, v35
  v_mul_f32 v36, v36, v10
  s_waitcnt lgkmcnt(2)
  v_fma_f32 v36, v148, v11, v36
  v_mul_f32 v37, v37, v10
  v_fma_f32 v37, v149, v11, v37
  v_mul_f32 v38, v38, v10
  v_fma_f32 v38, v150, v11, v38
  v_mul_f32 v39, v39, v10
  v_fma_f32 v39, v151, v11, v39
  v_mul_f32 v40, v40, v10
  s_waitcnt lgkmcnt(1)
  v_fma_f32 v40, v152, v11, v40
  v_mul_f32 v41, v41, v10
  v_fma_f32 v41, v153, v11, v41
  v_mul_f32 v42, v42, v10
  v_fma_f32 v42, v154, v11, v42
  v_mul_f32 v43, v43, v10
  v_fma_f32 v43, v155, v11, v43
  v_mul_f32 v44, v44, v10
  s_waitcnt lgkmcnt(0)
  v_fma_f32 v44, v156, v11, v44
  v_mul_f32 v45, v45, v10
  v_fma_f32 v45, v157, v11, v45
  v_mul_f32 v46, v46, v10
  v_fma_f32 v46, v158, v11, v46
  v_mul_f32 v47, v47, v10
  v_fma_f32 v47, v159, v11, v47
  v_cvt_pk_bf16_f32 v136, v32, v33
  v_cvt_pk_bf16_f32 v137, v34, v35
  v_cvt_pk_bf16_f32 v138, v36, v37
  v_cvt_pk_bf16_f32 v139, v38, v39
  v_cvt_pk_bf16_f32 v140, v40, v41
  v_cvt_pk_bf16_f32 v141, v42, v43
  v_cvt_pk_bf16_f32 v142, v44, v45
  v_cvt_pk_bf16_f32 v143, v46, v47
  s_lshl_b32 s27, s25, 13
  s_add_u32 s27, s27, 80384
  v_add_u32 v9, s27, v5
  ds_write_b128 v9, v[16:19]
  ds_write_b128 v9, v[20:23] offset:1024
  ds_write_b128 v9, v[24:27] offset:2048
  ds_write_b128 v9, v[28:31] offset:3072
  ds_write_b128 v9, v[128:131] offset:4096
  ds_write_b128 v9, v[132:135] offset:5120
  ds_write_b128 v9, v[136:139] offset:6144
  ds_write_b128 v9, v[140:143] offset:7168
  s_waitcnt lgkmcnt(0)
  s_nop 7
L_c_14:
  v_add_u32 v3, 80384, v5
  s_cmp_lt_u32 s24, 3
  s_cbranch_scc1 L_nw_15
  s_barrier
  v_add_u32 v9, 50688, v4
  v_add_u32 v8, 65536, v4
  ds_read_b128 v[16:19], v3
  ds_read_b64_tr_b16 v[148:149], v9
  ds_read_b64_tr_b16 v[150:151], v8
  ds_read_b64_tr_b16 v[152:153], v9 offset:32
  ds_read_b64_tr_b16 v[154:155], v8 offset:32
  ds_read_b64_tr_b16 v[156:157], v9 offset:64
  ds_read_b64_tr_b16 v[158:159], v8 offset:64
  ds_read_b64_tr_b16 v[160:161], v9 offset:96
  ds_read_b64_tr_b16 v[162:163], v8 offset:96
  ds_read_b128 v[20:23], v3 offset:8192
  ds_read_b128 v[24:27], v3 offset:16384
  ds_read_b128 v[28:31], v3 offset:24576
  ds_read_b128 v[164:167], v3 offset:32768
  s_waitcnt lgkmcnt(10)
  v_mfma_f32_16x16x32_bf16 v[48:51], v[148:151], v[16:19], 0
  s_waitcnt lgkmcnt(8)
  v_mfma_f32_16x16x32_bf16 v[52:55], v[152:155], v[16:19], 0
  s_waitcnt lgkmcnt(6)
  v_mfma_f32_16x16x32_bf16 v[56:59], v[156:159], v[16:19], 0
  s_waitcnt lgkmcnt(4)
  v_mfma_f32_16x16x32_bf16 v[60:63], v[160:163], v[16:19], 0
  s_waitcnt lgkmcnt(3)
  v_mfma_f32_16x16x32_bf16 v[64:67], v[148:151], v[20:23], 0
  v_mfma_f32_16x16x32_bf16 v[68:71], v[152:155], v[20:23], 0
  v_mfma_f32_16x16x32_bf16 v[72:75], v[156:159], v[20:23], 0
  v_mfma_f32_16x16x32_bf16 v[76:79], v[160:163], v[20:23], 0
  s_waitcnt lgkmcnt(2)
  v_mfma_f32_16x16x32_bf16 v[80:83], v[148:151], v[24:27], 0
  v_mfma_f32_16x16x32_bf16 v[84:87], v[152:155], v[24:27], 0
  v_mfma_f32_16x16x32_bf16 v[88:91], v[156:159], v[24:27], 0
  v_mfma_f32_16x16x32_bf16 v[92:95], v[160:163], v[24:27], 0
  s_waitcnt lgkmcnt(1)
  v_mfma_f32_16x16x32_bf16 v[96:99], v[148:151], v[28:31], 0
  v_mfma_f32_16x16x32_bf16 v[100:103], v[152:155], v[28:31], 0
  v_mfma_f32_16x16x32_bf16 v[104:107], v[156:159], v[28:31], 0
  v_mfma_f32_16x16x32_bf16 v[108:111], v[160:163], v[28:31], 0
  s_waitcnt lgkmcnt(0)
  v_mfma_f32_16x16x32_bf16 v[112:115], v[148:151], v[164:167], 0
  v_mfma_f32_16x16x32_bf16 v[116:119], v[152:155], v[164:167], 0
  v_mfma_f32_16x16x32_bf16 v[120:123], v[156:159], v[164:167], 0
  v_mfma_f32_16x16x32_bf16 v[124:127], v[160:163], v[164:167], 0
  s_barrier
  v_add_u32 v9, 121344, v4
  v_add_u32 v8, 0, v4
  ds_read_b128 v[128:131], v3 offset:1024
  ds_read_b64_tr_b16 v[32:33], v9
  ds_read_b64_tr_b16 v[34:35], v8
  ds_read_b64_tr_b16 v[36:37], v9 offset:32
  ds_read_b64_tr_b16 v[38:39], v8 offset:32
  ds_read_b64_tr_b16 v[40:41], v9 offset:64
  ds_read_b64_tr_b16 v[42:43], v8 offset:64
  ds_read_b64_tr_b16 v[44:45], v9 offset:96
  ds_read_b64_tr_b16 v[46:47], v8 offset:96
  ds_read_b128 v[132:135], v3 offset:9216
  ds_read_b128 v[136:139], v3 offset:17408
  ds_read_b128 v[140:143], v3 offset:25600
  ds_read_b128 v[144:147], v3 offset:33792
  s_waitcnt lgkmcnt(10)
  v_mfma_f32_16x16x32_bf16 v[48:51], v[32:35], v[128:131], v[48:51]
  s_waitcnt lgkmcnt(8)
  v_mfma_f32_16x16x32_bf16 v[52:55], v[36:39], v[128:131], v[52:55]
  s_waitcnt lgkmcnt(6)
  v_mfma_f32_16x16x32_bf16 v[56:59], v[40:43], v[128:131], v[56:59]
  s_waitcnt lgkmcnt(4)
  v_mfma_f32_16x16x32_bf16 v[60:63], v[44:47], v[128:131], v[60:63]
  s_waitcnt lgkmcnt(3)
  v_mfma_f32_16x16x32_bf16 v[64:67], v[32:35], v[132:135], v[64:67]
  v_mfma_f32_16x16x32_bf16 v[68:71], v[36:39], v[132:135], v[68:71]
  v_mfma_f32_16x16x32_bf16 v[72:75], v[40:43], v[132:135], v[72:75]
  v_mfma_f32_16x16x32_bf16 v[76:79], v[44:47], v[132:135], v[76:79]
  s_waitcnt lgkmcnt(2)
  v_mfma_f32_16x16x32_bf16 v[80:83], v[32:35], v[136:139], v[80:83]
  v_mfma_f32_16x16x32_bf16 v[84:87], v[36:39], v[136:139], v[84:87]
  v_mfma_f32_16x16x32_bf16 v[88:91], v[40:43], v[136:139], v[88:91]
  v_mfma_f32_16x16x32_bf16 v[92:95], v[44:47], v[136:139], v[92:95]
  s_waitcnt lgkmcnt(1)
  v_mfma_f32_16x16x32_bf16 v[96:99], v[32:35], v[140:143], v[96:99]
  v_mfma_f32_16x16x32_bf16 v[100:103], v[36:39], v[140:143], v[100:103]
  v_mfma_f32_16x16x32_bf16 v[104:107], v[40:43], v[140:143], v[104:107]
  v_mfma_f32_16x16x32_bf16 v[108:111], v[44:47], v[140:143], v[108:111]
  s_waitcnt lgkmcnt(0)
  v_mfma_f32_16x16x32_bf16 v[112:115], v[32:35], v[144:147], v[112:115]
  v_mfma_f32_16x16x32_bf16 v[116:119], v[36:39], v[144:147], v[116:119]
  v_mfma_f32_16x16x32_bf16 v[120:123], v[40:43], v[144:147], v[120:123]
  v_mfma_f32_16x16x32_bf16 v[124:127], v[44:47], v[144:147], v[124:127]
  s_barrier
  v_add_u32 v9, 14848, v4
  v_add_u32 v8, 29696, v4
  ds_read_b128 v[16:19], v3 offset:2048
  ds_read_b64_tr_b16 v[148:149], v9
  ds_read_b64_tr_b16 v[150:151], v8
  ds_read_b64_tr_b16 v[152:153], v9 offset:32
  ds_read_b64_tr_b16 v[154:155], v8 offset:32
  ds_read_b64_tr_b16 v[156:157], v9 offset:64
  ds_read_b64_tr_b16 v[158:159], v8 offset:64
  ds_read_b64_tr_b16 v[160:161], v9 offset:96
  ds_read_b64_tr_b16 v[162:163], v8 offset:96
  ds_read_b128 v[20:23], v3 offset:10240
  ds_read_b128 v[24:27], v3 offset:18432
  ds_read_b128 v[28:31], v3 offset:26624
  ds_read_b128 v[164:167], v3 offset:34816
  s_waitcnt lgkmcnt(10)
  v_mfma_f32_16x16x32_bf16 v[48:51], v[148:151], v[16:19], v[48:51]
  s_waitcnt lgkmcnt(8)
  v_mfma_f32_16x16x32_bf16 v[52:55], v[152:155], v[16:19], v[52:55]
  s_waitcnt lgkmcnt(6)
  v_mfma_f32_16x16x32_bf16 v[56:59], v[156:159], v[16:19], v[56:59]
  s_waitcnt lgkmcnt(4)
  v_mfma_f32_16x16x32_bf16 v[60:63], v[160:163], v[16:19], v[60:63]
  s_waitcnt lgkmcnt(3)
  v_mfma_f32_16x16x32_bf16 v[64:67], v[148:151], v[20:23], v[64:67]
  v_mfma_f32_16x16x32_bf16 v[68:71], v[152:155], v[20:23], v[68:71]
  v_mfma_f32_16x16x32_bf16 v[72:75], v[156:159], v[20:23], v[72:75]
  v_mfma_f32_16x16x32_bf16 v[76:79], v[160:163], v[20:23], v[76:79]
  s_waitcnt lgkmcnt(2)
  v_mfma_f32_16x16x32_bf16 v[80:83], v[148:151], v[24:27], v[80:83]
  v_mfma_f32_16x16x32_bf16 v[84:87], v[152:155], v[24:27], v[84:87]
  v_mfma_f32_16x16x32_bf16 v[88:91], v[156:159], v[24:27], v[88:91]
  v_mfma_f32_16x16x32_bf16 v[92:95], v[160:163], v[24:27], v[92:95]
  s_waitcnt lgkmcnt(1)
  v_mfma_f32_16x16x32_bf16 v[96:99], v[148:151], v[28:31], v[96:99]
  v_mfma_f32_16x16x32_bf16 v[100:103], v[152:155], v[28:31], v[100:103]
  v_mfma_f32_16x16x32_bf16 v[104:107], v[156:159], v[28:31], v[104:107]
  v_mfma_f32_16x16x32_bf16 v[108:111], v[160:163], v[28:31], v[108:111]
  s_waitcnt lgkmcnt(0)
  v_mfma_f32_16x16x32_bf16 v[112:115], v[148:151], v[164:167], v[112:115]
  v_mfma_f32_16x16x32_bf16 v[116:119], v[152:155], v[164:167], v[116:119]
  v_mfma_f32_16x16x32_bf16 v[120:123], v[156:159], v[164:167], v[120:123]
  v_mfma_f32_16x16x32_bf16 v[124:127], v[160:163], v[164:167], v[124:127]
  s_barrier
  v_add_u32 v9, 44544, v4
  v_add_u32 v8, 59392, v4
  ds_read_b128 v[128:131], v3 offset:3072
  ds_read_b64_tr_b16 v[32:33], v9
  ds_read_b64_tr_b16 v[34:35], v8
  ds_read_b64_tr_b16 v[36:37], v9 offset:32
  ds_read_b64_tr_b16 v[38:39], v8 offset:32
  ds_read_b64_tr_b16 v[40:41], v9 offset:64
  ds_read_b64_tr_b16 v[42:43], v8 offset:64
  ds_read_b64_tr_b16 v[44:45], v9 offset:96
  ds_read_b64_tr_b16 v[46:47], v8 offset:96
  ds_read_b128 v[132:135], v3 offset:11264
  ds_read_b128 v[136:139], v3 offset:19456
  ds_read_b128 v[140:143], v3 offset:27648
  ds_read_b128 v[144:147], v3 offset:35840
  s_waitcnt lgkmcnt(10)
  v_mfma_f32_16x16x32_bf16 v[48:51], v[32:35], v[128:131], v[48:51]
  s_waitcnt lgkmcnt(8)
  v_mfma_f32_16x16x32_bf16 v[52:55], v[36:39], v[128:131], v[52:55]
  s_waitcnt lgkmcnt(6)
  v_mfma_f32_16x16x32_bf16 v[56:59], v[40:43], v[128:131], v[56:59]
  s_waitcnt lgkmcnt(4)
  v_mfma_f32_16x16x32_bf16 v[60:63], v[44:47], v[128:131], v[60:63]
  s_waitcnt lgkmcnt(3)
  v_mfma_f32_16x16x32_bf16 v[64:67], v[32:35], v[132:135], v[64:67]
  v_mfma_f32_16x16x32_bf16 v[68:71], v[36:39], v[132:135], v[68:71]
  v_mfma_f32_16x16x32_bf16 v[72:75], v[40:43], v[132:135], v[72:75]
  v_mfma_f32_16x16x32_bf16 v[76:79], v[44:47], v[132:135], v[76:79]
  s_waitcnt lgkmcnt(2)
  v_mfma_f32_16x16x32_bf16 v[80:83], v[32:35], v[136:139], v[80:83]
  v_mfma_f32_16x16x32_bf16 v[84:87], v[36:39], v[136:139], v[84:87]
  v_mfma_f32_16x16x32_bf16 v[88:91], v[40:43], v[136:139], v[88:91]
  v_mfma_f32_16x16x32_bf16 v[92:95], v[44:47], v[136:139], v[92:95]
  s_waitcnt lgkmcnt(1)
  v_mfma_f32_16x16x32_bf16 v[96:99], v[32:35], v[140:143], v[96:99]
  v_mfma_f32_16x16x32_bf16 v[100:103], v[36:39], v[140:143], v[100:103]
  v_mfma_f32_16x16x32_bf16 v[104:107], v[40:43], v[140:143], v[104:107]
  v_mfma_f32_16x16x32_bf16 v[108:111], v[44:47], v[140:143], v[108:111]
  s_waitcnt lgkmcnt(0)
  v_mfma_f32_16x16x32_bf16 v[112:115], v[32:35], v[144:147], v[112:115]
  v_mfma_f32_16x16x32_bf16 v[116:119], v[36:39], v[144:147], v[116:119]
  v_mfma_f32_16x16x32_bf16 v[120:123], v[40:43], v[144:147], v[120:123]
  v_mfma_f32_16x16x32_bf16 v[124:127], v[44:47], v[144:147], v[124:127]
  s_barrier
  v_add_u32 v9, 121344, v4
  v_add_u32 v8, 0, v4
  ds_read_b128 v[16:19], v3 offset:4096
  ds_read_b64_tr_b16 v[148:149], v9
  ds_read_b64_tr_b16 v[150:151], v8
  ds_read_b64_tr_b16 v[152:153], v9 offset:32
  ds_read_b64_tr_b16 v[154:155], v8 offset:32
  ds_read_b64_tr_b16 v[156:157], v9 offset:64
  ds_read_b64_tr_b16 v[158:159], v8 offset:64
  ds_read_b64_tr_b16 v[160:161], v9 offset:96
  ds_read_b64_tr_b16 v[162:163], v8 offset:96
  ds_read_b128 v[20:23], v3 offset:12288
  ds_read_b128 v[24:27], v3 offset:20480
  ds_read_b128 v[28:31], v3 offset:28672
  ds_read_b128 v[164:167], v3 offset:36864
  s_waitcnt lgkmcnt(10)
  v_mfma_f32_16x16x32_bf16 v[48:51], v[148:151], v[16:19], v[48:51]
  s_waitcnt lgkmcnt(8)
  v_mfma_f32_16x16x32_bf16 v[52:55], v[152:155], v[16:19], v[52:55]
  s_waitcnt lgkmcnt(6)
  v_mfma_f32_16x16x32_bf16 v[56:59], v[156:159], v[16:19], v[56:59]
  s_waitcnt lgkmcnt(4)
  v_mfma_f32_16x16x32_bf16 v[60:63], v[160:163], v[16:19], v[60:63]
  s_waitcnt lgkmcnt(3)
  v_mfma_f32_16x16x32_bf16 v[64:67], v[148:151], v[20:23], v[64:67]
  v_mfma_f32_16x16x32_bf16 v[68:71], v[152:155], v[20:23], v[68:71]
  v_mfma_f32_16x16x32_bf16 v[72:75], v[156:159], v[20:23], v[72:75]
  v_mfma_f32_16x16x32_bf16 v[76:79], v[160:163], v[20:23], v[76:79]
  s_waitcnt lgkmcnt(2)
  v_mfma_f32_16x16x32_bf16 v[80:83], v[148:151], v[24:27], v[80:83]
  v_mfma_f32_16x16x32_bf16 v[84:87], v[152:155], v[24:27], v[84:87]
  v_mfma_f32_16x16x32_bf16 v[88:91], v[156:159], v[24:27], v[88:91]
  v_mfma_f32_16x16x32_bf16 v[92:95], v[160:163], v[24:27], v[92:95]
  s_waitcnt lgkmcnt(1)
  v_mfma_f32_16x16x32_bf16 v[96:99], v[148:151], v[28:31], v[96:99]
  v_mfma_f32_16x16x32_bf16 v[100:103], v[152:155], v[28:31], v[100:103]
  v_mfma_f32_16x16x32_bf16 v[104:107], v[156:159], v[28:31], v[104:107]
  v_mfma_f32_16x16x32_bf16 v[108:111], v[160:163], v[28:31], v[108:111]
  s_waitcnt lgkmcnt(0)
  v_mfma_f32_16x16x32_bf16 v[112:115], v[148:151], v[164:167], v[112:115]
  v_mfma_f32_16x16x32_bf16 v[116:119], v[152:155], v[164:167], v[116:119]
  v_mfma_f32_16x16x32_bf16 v[120:123], v[156:159], v[164:167], v[120:123]
  v_mfma_f32_16x16x32_bf16 v[124:127], v[160:163], v[164:167], v[124:127]
  s_barrier
  v_add_u32 v9, 14848, v4
  v_add_u32 v8, 29696, v4
  ds_read_b128 v[128:131], v3 offset:5120
  ds_read_b64_tr_b16 v[32:33], v9
  ds_read_b64_tr_b16 v[34:35], v8
  ds_read_b64_tr_b16 v[36:37], v9 offset:32
  ds_read_b64_tr_b16 v[38:39], v8 offset:32
  ds_read_b64_tr_b16 v[40:41], v9 offset:64
  ds_read_b64_tr_b16 v[42:43], v8 offset:64
  ds_read_b64_tr_b16 v[44:45], v9 offset:96
  ds_read_b64_tr_b16 v[46:47], v8 offset:96
  ds_read_b128 v[132:135], v3 offset:13312
  ds_read_b128 v[136:139], v3 offset:21504
  ds_read_b128 v[140:143], v3 offset:29696
  ds_read_b128 v[144:147], v3 offset:37888
  s_waitcnt lgkmcnt(10)
  v_mfma_f32_16x16x32_bf16 v[48:51], v[32:35], v[128:131], v[48:51]
  s_waitcnt lgkmcnt(8)
  v_mfma_f32_16x16x32_bf16 v[52:55], v[36:39], v[128:131], v[52:55]
  s_waitcnt lgkmcnt(6)
  v_mfma_f32_16x16x32_bf16 v[56:59], v[40:43], v[128:131], v[56:59]
  s_waitcnt lgkmcnt(4)
  v_mfma_f32_16x16x32_bf16 v[60:63], v[44:47], v[128:131], v[60:63]
  s_waitcnt lgkmcnt(3)
  v_mfma_f32_16x16x32_bf16 v[64:67], v[32:35], v[132:135], v[64:67]
  v_mfma_f32_16x16x32_bf16 v[68:71], v[36:39], v[132:135], v[68:71]
  v_mfma_f32_16x16x32_bf16 v[72:75], v[40:43], v[132:135], v[72:75]
  v_mfma_f32_16x16x32_bf16 v[76:79], v[44:47], v[132:135], v[76:79]
  s_waitcnt lgkmcnt(2)
  v_mfma_f32_16x16x32_bf16 v[80:83], v[32:35], v[136:139], v[80:83]
  v_mfma_f32_16x16x32_bf16 v[84:87], v[36:39], v[136:139], v[84:87]
  v_mfma_f32_16x16x32_bf16 v[88:91], v[40:43], v[136:139], v[88:91]
  v_mfma_f32_16x16x32_bf16 v[92:95], v[44:47], v[136:139], v[92:95]
  s_waitcnt lgkmcnt(1)
  v_mfma_f32_16x16x32_bf16 v[96:99], v[32:35], v[140:143], v[96:99]
  v_mfma_f32_16x16x32_bf16 v[100:103], v[36:39], v[140:143], v[100:103]
  v_mfma_f32_16x16x32_bf16 v[104:107], v[40:43], v[140:143], v[104:107]
  v_mfma_f32_16x16x32_bf16 v[108:111], v[44:47], v[140:143], v[108:111]
  s_waitcnt lgkmcnt(0)
  v_mfma_f32_16x16x32_bf16 v[112:115], v[32:35], v[144:147], v[112:115]
  v_mfma_f32_16x16x32_bf16 v[116:119], v[36:39], v[144:147], v[116:119]
  v_mfma_f32_16x16x32_bf16 v[120:123], v[40:43], v[144:147], v[120:123]
  v_mfma_f32_16x16x32_bf16 v[124:127], v[44:47], v[144:147], v[124:127]
  s_barrier
  v_add_u32 v9, 44544, v4
  v_add_u32 v8, 59392, v4
  ds_read_b128 v[16:19], v3 offset:6144
  ds_read_b64_tr_b16 v[148:149], v9
  ds_read_b64_tr_b16 v[150:151], v8
  ds_read_b64_tr_b16 v[152:153], v9 offset:32
  ds_read_b64_tr_b16 v[154:155], v8 offset:32
  ds_read_b64_tr_b16 v[156:157], v9 offset:64
  ds_read_b64_tr_b16 v[158:159], v8 offset:64
  ds_read_b64_tr_b16 v[160:161], v9 offset:96
  ds_read_b64_tr_b16 v[162:163], v8 offset:96
  ds_read_b128 v[20:23], v3 offset:14336
  ds_read_b128 v[24:27], v3 offset:22528
  ds_read_b128 v[28:31], v3 offset:30720
  ds_read_b128 v[164:167], v3 offset:38912
  s_waitcnt lgkmcnt(10)
  v_mfma_f32_16x16x32_bf16 v[48:51], v[148:151], v[16:19], v[48:51]
  s_waitcnt lgkmcnt(8)
  v_mfma_f32_16x16x32_bf16 v[52:55], v[152:155], v[16:19], v[52:55]
  s_waitcnt lgkmcnt(6)
  v_mfma_f32_16x16x32_bf16 v[56:59], v[156:159], v[16:19], v[56:59]
  s_waitcnt lgkmcnt(4)
  v_mfma_f32_16x16x32_bf16 v[60:63], v[160:163], v[16:19], v[60:63]
  s_waitcnt lgkmcnt(3)
  v_mfma_f32_16x16x32_bf16 v[64:67], v[148:151], v[20:23], v[64:67]
  v_mfma_f32_16x16x32_bf16 v[68:71], v[152:155], v[20:23], v[68:71]
  v_mfma_f32_16x16x32_bf16 v[72:75], v[156:159], v[20:23], v[72:75]
  v_mfma_f32_16x16x32_bf16 v[76:79], v[160:163], v[20:23], v[76:79]
  s_waitcnt lgkmcnt(2)
  v_mfma_f32_16x16x32_bf16 v[80:83], v[148:151], v[24:27], v[80:83]
  v_mfma_f32_16x16x32_bf16 v[84:87], v[152:155], v[24:27], v[84:87]
  v_mfma_f32_16x16x32_bf16 v[88:91], v[156:159], v[24:27], v[88:91]
  v_mfma_f32_16x16x32_bf16 v[92:95], v[160:163], v[24:27], v[92:95]
  s_waitcnt lgkmcnt(1)
  v_mfma_f32_16x16x32_bf16 v[96:99], v[148:151], v[28:31], v[96:99]
  v_mfma_f32_16x16x32_bf16 v[100:103], v[152:155], v[28:31], v[100:103]
  v_mfma_f32_16x16x32_bf16 v[104:107], v[156:159], v[28:31], v[104:107]
  v_mfma_f32_16x16x32_bf16 v[108:111], v[160:163], v[28:31], v[108:111]
  s_waitcnt lgkmcnt(0)
  v_mfma_f32_16x16x32_bf16 v[112:115], v[148:151], v[164:167], v[112:115]
  v_mfma_f32_16x16x32_bf16 v[116:119], v[152:155], v[164:167], v[116:119]
  v_mfma_f32_16x16x32_bf16 v[120:123], v[156:159], v[164:167], v[120:123]
  v_mfma_f32_16x16x32_bf16 v[124:127], v[160:163], v[164:167], v[124:127]
  s_barrier
  v_add_u32 v9, 121344, v4
  v_add_u32 v8, 0, v4
  ds_read_b128 v[128:131], v3 offset:7168
  ds_read_b64_tr_b16 v[32:33], v9
  ds_read_b64_tr_b16 v[34:35], v8
  ds_read_b64_tr_b16 v[36:37], v9 offset:32
  ds_read_b64_tr_b16 v[38:39], v8 offset:32
  ds_read_b64_tr_b16 v[40:41], v9 offset:64
  ds_read_b64_tr_b16 v[42:43], v8 offset:64
  ds_read_b64_tr_b16 v[44:45], v9 offset:96
  ds_read_b64_tr_b16 v[46:47], v8 offset:96
  ds_read_b128 v[132:135], v3 offset:15360
  ds_read_b128 v[136:139], v3 offset:23552
  ds_read_b128 v[140:143], v3 offset:31744
  ds_read_b128 v[144:147], v3 offset:39936
  s_waitcnt lgkmcnt(10)
  v_mfma_f32_16x16x32_bf16 v[48:51], v[32:35], v[128:131], v[48:51]
  s_waitcnt lgkmcnt(8)
  v_mfma_f32_16x16x32_bf16 v[52:55], v[36:39], v[128:131], v[52:55]
  s_waitcnt lgkmcnt(6)
  v_mfma_f32_16x16x32_bf16 v[56:59], v[40:43], v[128:131], v[56:59]
  s_waitcnt lgkmcnt(4)
  v_mfma_f32_16x16x32_bf16 v[60:63], v[44:47], v[128:131], v[60:63]
  s_waitcnt lgkmcnt(3)
  v_mfma_f32_16x16x32_bf16 v[64:67], v[32:35], v[132:135], v[64:67]
  v_mfma_f32_16x16x32_bf16 v[68:71], v[36:39], v[132:135], v[68:71]
  v_mfma_f32_16x16x32_bf16 v[72:75], v[40:43], v[132:135], v[72:75]
  v_mfma_f32_16x16x32_bf16 v[76:79], v[44:47], v[132:135], v[76:79]
  s_waitcnt lgkmcnt(2)
  v_mfma_f32_16x16x32_bf16 v[80:83], v[32:35], v[136:139], v[80:83]
  v_mfma_f32_16x16x32_bf16 v[84:87], v[36:39], v[136:139], v[84:87]
  v_mfma_f32_16x16x32_bf16 v[88:91], v[40:43], v[136:139], v[88:91]
  v_mfma_f32_16x16x32_bf16 v[92:95], v[44:47], v[136:139], v[92:95]
  s_waitcnt lgkmcnt(1)
  v_mfma_f32_16x16x32_bf16 v[96:99], v[32:35], v[140:143], v[96:99]
  v_mfma_f32_16x16x32_bf16 v[100:103], v[36:39], v[140:143], v[100:103]
  v_mfma_f32_16x16x32_bf16 v[104:107], v[40:43], v[140:143], v[104:107]
  v_mfma_f32_16x16x32_bf16 v[108:111], v[44:47], v[140:143], v[108:111]
  s_waitcnt lgkmcnt(0)
  v_mfma_f32_16x16x32_bf16 v[112:115], v[32:35], v[144:147], v[112:115]
  v_mfma_f32_16x16x32_bf16 v[116:119], v[36:39], v[144:147], v[116:119]
  v_mfma_f32_16x16x32_bf16 v[120:123], v[40:43], v[144:147], v[120:123]
  v_mfma_f32_16x16x32_bf16 v[124:127], v[44:47], v[144:147], v[124:127]
  s_mul_i32 s27, s2, 71680
  s_mul_i32 s28, s31, 10240
  s_add_u32 s27, s27, s28
  s_add_u32 s27, s27, 33554432
  v_cvt_pk_bf16_f32 v128, v48, v49
  v_cvt_pk_bf16_f32 v129, v50, v51
  v_cvt_pk_bf16_f32 v130, v52, v53
  v_cvt_pk_bf16_f32 v131, v54, v55
  buffer_store_dwordx4 v[128:131], v5, s[36:39], s27 offen sc1
  v_cvt_pk_bf16_f32 v132, v56, v57
  v_cvt_pk_bf16_f32 v133, v58, v59
  v_cvt_pk_bf16_f32 v134, v60, v61
  v_cvt_pk_bf16_f32 v135, v62, v63
  buffer_store_dwordx4 v[132:135], v5, s[36:39], s27 offen offset:1024 sc1
  v_cvt_pk_bf16_f32 v136, v64, v65
  v_cvt_pk_bf16_f32 v137, v66, v67
  v_cvt_pk_bf16_f32 v138, v68, v69
  v_cvt_pk_bf16_f32 v139, v70, v71
  buffer_store_dwordx4 v[136:139], v5, s[36:39], s27 offen offset:2048 sc1
  v_cvt_pk_bf16_f32 v140, v72, v73
  v_cvt_pk_bf16_f32 v141, v74, v75
  v_cvt_pk_bf16_f32 v142, v76, v77
  v_cvt_pk_bf16_f32 v143, v78, v79
  buffer_store_dwordx4 v[140:143], v5, s[36:39], s27 offen offset:3072 sc1
  v_cvt_pk_bf16_f32 v144, v80, v81
  v_cvt_pk_bf16_f32 v145, v82, v83
  v_cvt_pk_bf16_f32 v146, v84, v85
  v_cvt_pk_bf16_f32 v147, v86, v87
  s_add_u32 s27, s27, 4096
  buffer_store_dwordx4 v[144:147], v5, s[36:39], s27 offen sc1
  v_cvt_pk_bf16_f32 v148, v88, v89
  v_cvt_pk_bf16_f32 v149, v90, v91
  v_cvt_pk_bf16_f32 v150, v92, v93
  v_cvt_pk_bf16_f32 v151, v94, v95
  buffer_store_dwordx4 v[148:151], v5, s[36:39], s27 offen offset:1024 sc1
  v_cvt_pk_bf16_f32 v152, v96, v97
  v_cvt_pk_bf16_f32 v153, v98, v99
  v_cvt_pk_bf16_f32 v154, v100, v101
  v_cvt_pk_bf16_f32 v155, v102, v103
  buffer_store_dwordx4 v[152:155], v5, s[36:39], s27 offen offset:2048 sc1
  v_cvt_pk_bf16_f32 v156, v104, v105
  v_cvt_pk_bf16_f32 v157, v106, v107
  v_cvt_pk_bf16_f32 v158, v108, v109
  v_cvt_pk_bf16_f32 v159, v110, v111
  buffer_store_dwordx4 v[156:159], v5, s[36:39], s27 offen offset:3072 sc1
  v_cvt_pk_bf16_f32 v160, v112, v113
  v_cvt_pk_bf16_f32 v161, v114, v115
  v_cvt_pk_bf16_f32 v162, v116, v117
  v_cvt_pk_bf16_f32 v163, v118, v119
  s_add_u32 s27, s27, 4096
  buffer_store_dwordx4 v[160:163], v5, s[36:39], s27 offen sc1
  v_cvt_pk_bf16_f32 v164, v120, v121
  v_cvt_pk_bf16_f32 v165, v122, v123
  v_cvt_pk_bf16_f32 v166, v124, v125
  v_cvt_pk_bf16_f32 v167, v126, v127
  buffer_store_dwordx4 v[164:167], v5, s[36:39], s27 offen offset:1024 sc1
  s_waitcnt vmcnt(0)
  s_branch L_wj_16
L_nw_15:
  s_barrier
  s_barrier
  s_barrier
  s_barrier
  s_barrier
  s_barrier
  s_barrier
  s_barrier
L_wj_16:
  s_barrier
  s_cmp_ge_u32 s24, 5
  s_cbranch_scc1 L_end
  s_lshr_b32 s27, s2, 4
  s_lshl_b32 s28, s27, 7
  s_add_u32 s28, s28, 65536
  s_and_b32 s30, s2, 15
  s_cmp_lg_u32 s24, 0
  s_cbranch_scc1 L_17
  s_lshl_b32 s31, s30, 3
  s_add_u32 s31, s31, s28
  v_mov_b32 v144, s42
  v_mov_b32 v145, s43
  v_mov_b32 v146, 0
  buffer_store_dwordx2 v[144:145], v146, s[36:39], s31 offen sc1
L_17:
  s_mul_i32 s31, s30, 280
  s_lshl_b32 s44, s24, 6
  s_add_u32 s31, s31, s44
  v_add_u32 v16, s31, v0
  v_lshlrev_b32 v17, 4, v16
  v_lshrrev_b32 v18, 6, v16
  v_and_b32 v19, 63, v16
  v_mul_u32_u24 v20, 205, v18
  v_lshrrev_b32 v20, 11, v20
  v_mul_u32_u24 v21, 10, v20
  v_sub_u32 v21, v18, v21
  v_lshrrev_b32 v23, 1, v21
  v_and_b32 v22, 1, v21
  v_and_b32 v24, 15, v19
  v_lshl_add_u32 v24, v23, 4, v24
  v_mul_u32_u24 v24, 1792, v24
  v_lshl_add_u32 v24, v20, 7, v24
  v_lshl_add_u32 v24, v22, 6, v24
  v_lshrrev_b32 v25, 4, v19
  v_lshl_add_u32 v24, v25, 3, v24
  s_mul_i32 s44, s6, 143360
  s_mul_i32 s45, s7, 896
  s_add_u32 s44, s44, s45
  s_mov_b32 s60, s56
  s_mov_b32 s61, s57
  s_mov_b32 s62, 1146880
  s_mov_b32 s63, 0x00020000
  v_and_b32 v8, 15, v0
  v_lshlrev_b32 v8, 3, v8
  s_mov_b32 s46, 0
L_poll_18:
  buffer_load_dwordx2 v[148:149], v8, s[36:39], s28 offen sc1
  s_waitcnt vmcnt(0)
  v_cmp_eq_u32 vcc, s42, v148
  v_cmp_eq_u32 s[48:49], s43, v149
  s_and_b64 vcc, vcc, s[48:49]
  s_cmp_eq_u64 vcc, exec
  s_cbranch_scc1 L_pdone_19
  s_sleep 1
  s_add_u32 s46, s46, 1
  s_cmp_lt_u32 s46, 1048576
  s_cbranch_scc1 L_poll_18
L_pdone_19:
  s_lshl_b32 s45, s24, 6
  v_add_u32 v26, s45, v0
  v_cmp_gt_u32 vcc, 280, v26
  s_and_saveexec_b64 s[48:49], vcc
  s_mul_i32 s27, s27, 1146880
  s_add_u32 s27, s27, 33554432
  buffer_load_dwordx4 v[48:51], v17, s[36:39], s27 offen sc1
  s_add_u32 s27, s27, 71680
  buffer_load_dwordx4 v[52:55], v17, s[36:39], s27 offen sc1
  s_add_u32 s27, s27, 71680
  buffer_load_dwordx4 v[56:59], v17, s[36:39], s27 offen sc1
  s_add_u32 s27, s27, 71680
  buffer_load_dwordx4 v[60:63], v17, s[36:39], s27 offen sc1
  s_add_u32 s27, s27, 71680
  buffer_load_dwordx4 v[64:67], v17, s[36:39], s27 offen sc1
  s_add_u32 s27, s27, 71680
  buffer_load_dwordx4 v[68:71], v17, s[36:39], s27 offen sc1
  s_add_u32 s27, s27, 71680
  buffer_load_dwordx4 v[72:75], v17, s[36:39], s27 offen sc1
  s_add_u32 s27, s27, 71680
  buffer_load_dwordx4 v[76:79], v17, s[36:39], s27 offen sc1
  s_add_u32 s27, s27, 71680
  buffer_load_dwordx4 v[80:83], v17, s[36:39], s27 offen sc1
  s_add_u32 s27, s27, 71680
  buffer_load_dwordx4 v[84:87], v17, s[36:39], s27 offen sc1
  s_add_u32 s27, s27, 71680
  buffer_load_dwordx4 v[88:91], v17, s[36:39], s27 offen sc1
  s_add_u32 s27, s27, 71680
  buffer_load_dwordx4 v[92:95], v17, s[36:39], s27 offen sc1
  s_add_u32 s27, s27, 71680
  buffer_load_dwordx4 v[96:99], v17, s[36:39], s27 offen sc1
  s_add_u32 s27, s27, 71680
  buffer_load_dwordx4 v[100:103], v17, s[36:39], s27 offen sc1
  s_add_u32 s27, s27, 71680
  buffer_load_dwordx4 v[104:107], v17, s[36:39], s27 offen sc1
  s_add_u32 s27, s27, 71680
  buffer_load_dwordx4 v[108:111], v17, s[36:39], s27 offen sc1
  s_waitcnt vmcnt(15)
  v_lshlrev_b32 v32, 16, v48
  v_and_b32 v33, 0xffff0000, v48
  v_lshlrev_b32 v34, 16, v49
  v_and_b32 v35, 0xffff0000, v49
  v_lshlrev_b32 v36, 16, v50
  v_and_b32 v37, 0xffff0000, v50
  v_lshlrev_b32 v38, 16, v51
  v_and_b32 v39, 0xffff0000, v51
  s_waitcnt vmcnt(14)
  v_lshlrev_b32 v28, 16, v52
  v_and_b32 v29, 0xffff0000, v52
  v_add_f32 v32, v32, v28
  v_add_f32 v33, v33, v29
  v_lshlrev_b32 v28, 16, v53
  v_and_b32 v29, 0xffff0000, v53
  v_add_f32 v34, v34, v28
  v_add_f32 v35, v35, v29
  v_lshlrev_b32 v28, 16, v54
  v_and_b32 v29, 0xffff0000, v54
  v_add_f32 v36, v36, v28
  v_add_f32 v37, v37, v29
  v_lshlrev_b32 v28, 16, v55
  v_and_b32 v29, 0xffff0000, v55
  v_add_f32 v38, v38, v28
  v_add_f32 v39, v39, v29
  s_waitcnt vmcnt(13)
  v_lshlrev_b32 v28, 16, v56
  v_and_b32 v29, 0xffff0000, v56
  v_add_f32 v32, v32, v28
  v_add_f32 v33, v33, v29
  v_lshlrev_b32 v28, 16, v57
  v_and_b32 v29, 0xffff0000, v57
  v_add_f32 v34, v34, v28
  v_add_f32 v35, v35, v29
  v_lshlrev_b32 v28, 16, v58
  v_and_b32 v29, 0xffff0000, v58
  v_add_f32 v36, v36, v28
  v_add_f32 v37, v37, v29
  v_lshlrev_b32 v28, 16, v59
  v_and_b32 v29, 0xffff0000, v59
  v_add_f32 v38, v38, v28
  v_add_f32 v39, v39, v29
  s_waitcnt vmcnt(12)
  v_lshlrev_b32 v28, 16, v60
  v_and_b32 v29, 0xffff0000, v60
  v_add_f32 v32, v32, v28
  v_add_f32 v33, v33, v29
  v_lshlrev_b32 v28, 16, v61
  v_and_b32 v29, 0xffff0000, v61
  v_add_f32 v34, v34, v28
  v_add_f32 v35, v35, v29
  v_lshlrev_b32 v28, 16, v62
  v_and_b32 v29, 0xffff0000, v62
  v_add_f32 v36, v36, v28
  v_add_f32 v37, v37, v29
  v_lshlrev_b32 v28, 16, v63
  v_and_b32 v29, 0xffff0000, v63
  v_add_f32 v38, v38, v28
  v_add_f32 v39, v39, v29
  s_waitcnt vmcnt(11)
  v_lshlrev_b32 v28, 16, v64
  v_and_b32 v29, 0xffff0000, v64
  v_add_f32 v32, v32, v28
  v_add_f32 v33, v33, v29
  v_lshlrev_b32 v28, 16, v65
  v_and_b32 v29, 0xffff0000, v65
  v_add_f32 v34, v34, v28
  v_add_f32 v35, v35, v29
  v_lshlrev_b32 v28, 16, v66
  v_and_b32 v29, 0xffff0000, v66
  v_add_f32 v36, v36, v28
  v_add_f32 v37, v37, v29
  v_lshlrev_b32 v28, 16, v67
  v_and_b32 v29, 0xffff0000, v67
  v_add_f32 v38, v38, v28
  v_add_f32 v39, v39, v29
  s_waitcnt vmcnt(10)
  v_lshlrev_b32 v28, 16, v68
  v_and_b32 v29, 0xffff0000, v68
  v_add_f32 v32, v32, v28
  v_add_f32 v33, v33, v29
  v_lshlrev_b32 v28, 16, v69
  v_and_b32 v29, 0xffff0000, v69
  v_add_f32 v34, v34, v28
  v_add_f32 v35, v35, v29
  v_lshlrev_b32 v28, 16, v70
  v_and_b32 v29, 0xffff0000, v70
  v_add_f32 v36, v36, v28
  v_add_f32 v37, v37, v29
  v_lshlrev_b32 v28, 16, v71
  v_and_b32 v29, 0xffff0000, v71
  v_add_f32 v38, v38, v28
  v_add_f32 v39, v39, v29
  s_waitcnt vmcnt(9)
  v_lshlrev_b32 v28, 16, v72
  v_and_b32 v29, 0xffff0000, v72
  v_add_f32 v32, v32, v28
  v_add_f32 v33, v33, v29
  v_lshlrev_b32 v28, 16, v73
  v_and_b32 v29, 0xffff0000, v73
  v_add_f32 v34, v34, v28
  v_add_f32 v35, v35, v29
  v_lshlrev_b32 v28, 16, v74
  v_and_b32 v29, 0xffff0000, v74
  v_add_f32 v36, v36, v28
  v_add_f32 v37, v37, v29
  v_lshlrev_b32 v28, 16, v75
  v_and_b32 v29, 0xffff0000, v75
  v_add_f32 v38, v38, v28
  v_add_f32 v39, v39, v29
  s_waitcnt vmcnt(8)
  v_lshlrev_b32 v28, 16, v76
  v_and_b32 v29, 0xffff0000, v76
  v_add_f32 v32, v32, v28
  v_add_f32 v33, v33, v29
  v_lshlrev_b32 v28, 16, v77
  v_and_b32 v29, 0xffff0000, v77
  v_add_f32 v34, v34, v28
  v_add_f32 v35, v35, v29
  v_lshlrev_b32 v28, 16, v78
  v_and_b32 v29, 0xffff0000, v78
  v_add_f32 v36, v36, v28
  v_add_f32 v37, v37, v29
  v_lshlrev_b32 v28, 16, v79
  v_and_b32 v29, 0xffff0000, v79
  v_add_f32 v38, v38, v28
  v_add_f32 v39, v39, v29
  s_waitcnt vmcnt(7)
  v_lshlrev_b32 v28, 16, v80
  v_and_b32 v29, 0xffff0000, v80
  v_add_f32 v32, v32, v28
  v_add_f32 v33, v33, v29
  v_lshlrev_b32 v28, 16, v81
  v_and_b32 v29, 0xffff0000, v81
  v_add_f32 v34, v34, v28
  v_add_f32 v35, v35, v29
  v_lshlrev_b32 v28, 16, v82
  v_and_b32 v29, 0xffff0000, v82
  v_add_f32 v36, v36, v28
  v_add_f32 v37, v37, v29
  v_lshlrev_b32 v28, 16, v83
  v_and_b32 v29, 0xffff0000, v83
  v_add_f32 v38, v38, v28
  v_add_f32 v39, v39, v29
  s_waitcnt vmcnt(6)
  v_lshlrev_b32 v28, 16, v84
  v_and_b32 v29, 0xffff0000, v84
  v_add_f32 v32, v32, v28
  v_add_f32 v33, v33, v29
  v_lshlrev_b32 v28, 16, v85
  v_and_b32 v29, 0xffff0000, v85
  v_add_f32 v34, v34, v28
  v_add_f32 v35, v35, v29
  v_lshlrev_b32 v28, 16, v86
  v_and_b32 v29, 0xffff0000, v86
  v_add_f32 v36, v36, v28
  v_add_f32 v37, v37, v29
  v_lshlrev_b32 v28, 16, v87
  v_and_b32 v29, 0xffff0000, v87
  v_add_f32 v38, v38, v28
  v_add_f32 v39, v39, v29
  s_waitcnt vmcnt(5)
  v_lshlrev_b32 v28, 16, v88
  v_and_b32 v29, 0xffff0000, v88
  v_add_f32 v32, v32, v28
  v_add_f32 v33, v33, v29
  v_lshlrev_b32 v28, 16, v89
  v_and_b32 v29, 0xffff0000, v89
  v_add_f32 v34, v34, v28
  v_add_f32 v35, v35, v29
  v_lshlrev_b32 v28, 16, v90
  v_and_b32 v29, 0xffff0000, v90
  v_add_f32 v36, v36, v28
  v_add_f32 v37, v37, v29
  v_lshlrev_b32 v28, 16, v91
  v_and_b32 v29, 0xffff0000, v91
  v_add_f32 v38, v38, v28
  v_add_f32 v39, v39, v29
  s_waitcnt vmcnt(4)
  v_lshlrev_b32 v28, 16, v92
  v_and_b32 v29, 0xffff0000, v92
  v_add_f32 v32, v32, v28
  v_add_f32 v33, v33, v29
  v_lshlrev_b32 v28, 16, v93
  v_and_b32 v29, 0xffff0000, v93
  v_add_f32 v34, v34, v28
  v_add_f32 v35, v35, v29
  v_lshlrev_b32 v28, 16, v94
  v_and_b32 v29, 0xffff0000, v94
  v_add_f32 v36, v36, v28
  v_add_f32 v37, v37, v29
  v_lshlrev_b32 v28, 16, v95
  v_and_b32 v29, 0xffff0000, v95
  v_add_f32 v38, v38, v28
  v_add_f32 v39, v39, v29
  s_waitcnt vmcnt(3)
  v_lshlrev_b32 v28, 16, v96
  v_and_b32 v29, 0xffff0000, v96
  v_add_f32 v32, v32, v28
  v_add_f32 v33, v33, v29
  v_lshlrev_b32 v28, 16, v97
  v_and_b32 v29, 0xffff0000, v97
  v_add_f32 v34, v34, v28
  v_add_f32 v35, v35, v29
  v_lshlrev_b32 v28, 16, v98
  v_and_b32 v29, 0xffff0000, v98
  v_add_f32 v36, v36, v28
  v_add_f32 v37, v37, v29
  v_lshlrev_b32 v28, 16, v99
  v_and_b32 v29, 0xffff0000, v99
  v_add_f32 v38, v38, v28
  v_add_f32 v39, v39, v29
  s_waitcnt vmcnt(2)
  v_lshlrev_b32 v28, 16, v100
  v_and_b32 v29, 0xffff0000, v100
  v_add_f32 v32, v32, v28
  v_add_f32 v33, v33, v29
  v_lshlrev_b32 v28, 16, v101
  v_and_b32 v29, 0xffff0000, v101
  v_add_f32 v34, v34, v28
  v_add_f32 v35, v35, v29
  v_lshlrev_b32 v28, 16, v102
  v_and_b32 v29, 0xffff0000, v102
  v_add_f32 v36, v36, v28
  v_add_f32 v37, v37, v29
  v_lshlrev_b32 v28, 16, v103
  v_and_b32 v29, 0xffff0000, v103
  v_add_f32 v38, v38, v28
  v_add_f32 v39, v39, v29
  s_waitcnt vmcnt(1)
  v_lshlrev_b32 v28, 16, v104
  v_and_b32 v29, 0xffff0000, v104
  v_add_f32 v32, v32, v28
  v_add_f32 v33, v33, v29
  v_lshlrev_b32 v28, 16, v105
  v_and_b32 v29, 0xffff0000, v105
  v_add_f32 v34, v34, v28
  v_add_f32 v35, v35, v29
  v_lshlrev_b32 v28, 16, v106
  v_and_b32 v29, 0xffff0000, v106
  v_add_f32 v36, v36, v28
  v_add_f32 v37, v37, v29
  v_lshlrev_b32 v28, 16, v107
  v_and_b32 v29, 0xffff0000, v107
  v_add_f32 v38, v38, v28
  v_add_f32 v39, v39, v29
  s_waitcnt vmcnt(0)
  v_lshlrev_b32 v28, 16, v108
  v_and_b32 v29, 0xffff0000, v108
  v_add_f32 v32, v32, v28
  v_add_f32 v33, v33, v29
  v_lshlrev_b32 v28, 16, v109
  v_and_b32 v29, 0xffff0000, v109
  v_add_f32 v34, v34, v28
  v_add_f32 v35, v35, v29
  v_lshlrev_b32 v28, 16, v110
  v_and_b32 v29, 0xffff0000, v110
  v_add_f32 v36, v36, v28
  v_add_f32 v37, v37, v29
  v_lshlrev_b32 v28, 16, v111
  v_and_b32 v29, 0xffff0000, v111
  v_add_f32 v38, v38, v28
  v_add_f32 v39, v39, v29
  v_cvt_pk_bf16_f32 v28, v32, v33
  v_cvt_pk_bf16_f32 v29, v34, v35
  v_cvt_pk_bf16_f32 v30, v36, v37
  v_cvt_pk_bf16_f32 v31, v38, v39
  buffer_store_dwordx2 v[28:29], v24, s[60:63], s44 offen
  buffer_store_dwordx2 v[30:31], v24, s[60:63], s44 offen offset:32
  s_endpgm
L_loader:
  s_setprio 3
  s_sub_u32 s25, s24, 10
  v_and_b32 v1, 31, v0
  v_lshlrev_b32 v1, 4, v1
  v_lshrrev_b32 v2, 5, v0
  v_lshl_add_u32 v3, v2, 15, v1
  v_lshl_add_u32 v1, v2, 12, v1
  v_lshlrev_b32 v4, 4, v0
  v_lshrrev_b32 v6, 3, v0
  v_and_b32 v7, 7, v0
  v_lshlrev_b32 v5, 12, v6
  v_lshl_add_u32 v5, v7, 4, v5
  v_lshrrev_b32 v8, 1, v6
  s_lshl_b32 s27, s25, 2
  v_add_u32 v8, s27, v8
  v_xor_b32 v8, v8, v7
  v_mul_u32_u24 v6, 896, v6
  v_lshl_add_u32 v6, v8, 4, v6
  s_mul_i32 s26, s25, 1056
  s_lshl_b32 s48, s25, 13
  s_lshl_b32 s51, s25, 10
  s_mul_i32 s53, s25, 7168
  s_mov_b32 s30, s29
  s_waitcnt lgkmcnt(0)
  s_lshl_b32 s27, s8, 9
  s_add_u32 s32, s18, s27
  s_addc_u32 s33, s19, 0
  s_sub_u32 s34, 3670016, s27
  s_mov_b32 s35, 0x00020000
  s_mul_i32 s27, s6, 71680
  s_add_u32 s60, s12, s27
  s_addc_u32 s61, s13, 0
  s_mov_b32 s62, 71680
  s_mov_b32 s63, 0x00020000
  s_lshl_b32 s31, s30, 7
  s_add_u32 s31, s31, s53
  s_add_u32 m0, s51, 0
  s_nop 0
  buffer_load_dwordx4 v6, s[60:63], s31 offen lds
  s_add_u32 m0, s51, 2048
  s_add_u32 s31, s31, 14336
  buffer_load_dwordx4 v6, s[60:63], s31 offen lds
  s_add_u32 m0, s51, 4096
  s_add_u32 s31, s31, 14336
  buffer_load_dwordx4 v6, s[60:63], s31 offen lds
  s_add_u32 m0, s51, 6144
  s_add_u32 s31, s31, 14336
  buffer_load_dwordx4 v6, s[60:63], s31 offen lds
  s_add_u32 m0, s51, 8192
  s_add_u32 s31, s31, 14336
  buffer_load_dwordx4 v6, s[60:63], s31 offen lds
  s_lshl_b32 s31, s30, 19
  s_add_u32 s31, s31, s48
  s_add_u32 m0, s26, 10240
  s_nop 0
  buffer_load_dwordx4 v3, s[32:35], s31 offen lds
  s_add_u32 m0, s26, 12352
  s_add_u32 s52, s31, 16384
  buffer_load_dwordx4 v3, s[32:35], s52 offen lds
  s_add_u32 m0, s26, 14464
  s_add_u32 s52, s31, 65536
  buffer_load_dwordx4 v3, s[32:35], s52 offen lds
  s_add_u32 m0, s26, 16576
  s_add_u32 s52, s31, 81920
  buffer_load_dwordx4 v3, s[32:35], s52 offen lds
  s_add_u32 m0, s26, 18688
  s_add_u32 s52, s31, 131072
  buffer_load_dwordx4 v3, s[32:35], s52 offen lds
  s_add_u32 m0, s26, 20800
  s_add_u32 s52, s31, 147456
  buffer_load_dwordx4 v3, s[32:35], s52 offen lds
  s_add_u32 m0, s26, 22912
  s_add_u32 s52, s31, 196608
  buffer_load_dwordx4 v3, s[32:35], s52 offen lds
  s_add_u32 m0, s26, 25024
  s_add_u32 s52, s31, 212992
  buffer_load_dwordx4 v3, s[32:35], s52 offen lds
  s_lshl_b32 s31, s30, 19
  s_add_u32 s31, s31, s48
  s_add_u32 m0, s26, 27136
  s_add_u32 s52, s31, 262144
  buffer_load_dwordx4 v3, s[32:35], s52 offen lds
  s_add_u32 m0, s26, 29248
  s_add_u32 s52, s31, 278528
  buffer_load_dwordx4 v3, s[32:35], s52 offen lds
  s_add_u32 m0, s26, 31360
  s_add_u32 s52, s31, 327680
  buffer_load_dwordx4 v3, s[32:35], s52 offen lds
  s_add_u32 m0, s26, 33472
  s_add_u32 s52, s31, 344064
  buffer_load_dwordx4 v3, s[32:35], s52 offen lds
  s_add_u32 m0, s26, 35584
  s_add_u32 s52, s31, 393216
  buffer_load_dwordx4 v3, s[32:35], s52 offen lds
  s_add_u32 m0, s26, 37696
  s_add_u32 s52, s31, 409600
  buffer_load_dwordx4 v3, s[32:35], s52 offen lds
  s_add_u32 m0, s26, 39808
  s_add_u32 s52, s31, 458752
  buffer_load_dwordx4 v3, s[32:35], s52 offen lds
  s_add_u32 m0, s26, 41920
  s_add_u32 s52, s31, 475136
  buffer_load_dwordx4 v3, s[32:35], s52 offen lds
  s_add_u32 s30, s30, 1
  s_cmp_eq_u32 s30, 7
  s_cselect_b32 s30, 0, s30
  s_lshl_b32 s31, s30, 7
  s_add_u32 s31, s31, s53
  s_add_u32 m0, s51, 44032
  s_nop 0
  buffer_load_dwordx4 v6, s[60:63], s31 offen lds
  s_add_u32 m0, s51, 46080
  s_add_u32 s31, s31, 14336
  buffer_load_dwordx4 v6, s[60:63], s31 offen lds
  s_add_u32 m0, s51, 48128
  s_add_u32 s31, s31, 14336
  buffer_load_dwordx4 v6, s[60:63], s31 offen lds
  s_add_u32 m0, s51, 50176
  s_add_u32 s31, s31, 14336
  buffer_load_dwordx4 v6, s[60:63], s31 offen lds
  s_add_u32 m0, s51, 52224
  s_add_u32 s31, s31, 14336
  buffer_load_dwordx4 v6, s[60:63], s31 offen lds
  s_lshl_b32 s31, s30, 19
  s_add_u32 s31, s31, s48
  s_add_u32 m0, s26, 54272
  s_nop 0
  buffer_load_dwordx4 v3, s[32:35], s31 offen lds
  s_add_u32 m0, s26, 56384
  s_add_u32 s52, s31, 16384
  buffer_load_dwordx4 v3, s[32:35], s52 offen lds
  s_add_u32 m0, s26, 58496
  s_add_u32 s52, s31, 65536
  buffer_load_dwordx4 v3, s[32:35], s52 offen lds
  s_add_u32 m0, s26, 60608
  s_add_u32 s52, s31, 81920
  buffer_load_dwordx4 v3, s[32:35], s52 offen lds
  s_add_u32 m0, s26, 62720
  s_add_u32 s52, s31, 131072
  buffer_load_dwordx4 v3, s[32:35], s52 offen lds
  s_add_u32 m0, s26, 64832
  s_add_u32 s52, s31, 147456
  buffer_load_dwordx4 v3, s[32:35], s52 offen lds
  s_add_u32 m0, s26, 66944
  s_add_u32 s52, s31, 196608
  buffer_load_dwordx4 v3, s[32:35], s52 offen lds
  s_add_u32 m0, s26, 69056
  s_add_u32 s52, s31, 212992
  buffer_load_dwordx4 v3, s[32:35], s52 offen lds
  s_lshl_b32 s31, s30, 19
  s_add_u32 s31, s31, s48
  s_add_u32 m0, s26, 71168
  s_add_u32 s52, s31, 262144
  buffer_load_dwordx4 v3, s[32:35], s52 offen lds
  s_add_u32 m0, s26, 73280
  s_add_u32 s52, s31, 278528
  buffer_load_dwordx4 v3, s[32:35], s52 offen lds
  s_add_u32 m0, s26, 75392
  s_add_u32 s52, s31, 327680
  buffer_load_dwordx4 v3, s[32:35], s52 offen lds
  s_add_u32 m0, s26, 77504
  s_add_u32 s52, s31, 344064
  buffer_load_dwordx4 v3, s[32:35], s52 offen lds
  s_add_u32 m0, s26, 79616
  s_add_u32 s52, s31, 393216
  buffer_load_dwordx4 v3, s[32:35], s52 offen lds
  s_add_u32 m0, s26, 81728
  s_add_u32 s52, s31, 409600
  buffer_load_dwordx4 v3, s[32:35], s52 offen lds
  s_add_u32 m0, s26, 83840
  s_add_u32 s52, s31, 458752
  buffer_load_dwordx4 v3, s[32:35], s52 offen lds
  s_add_u32 m0, s26, 85952
  s_add_u32 s52, s31, 475136
  buffer_load_dwordx4 v3, s[32:35], s52 offen lds
  s_lshl_b32 s27, s6, 3
  s_add_u32 s27, s27, s3
  s_lshl_b32 s27, s27, 19
  s_add_u32 s36, s14, s27
  s_addc_u32 s37, s15, 0
  s_mov_b32 s38, 524288
  s_mov_b32 s39, 0x00020000
  s_add_u32 s40, s16, s27
  s_addc_u32 s41, s17, 0
  s_mov_b32 s42, 524288
  s_mov_b32 s43, 0x00020000
  s_mul_i32 s27, s8, 229376
  s_add_u32 s44, s20, s27
  s_addc_u32 s45, s21, 0
  s_mov_b32 s46, 229376
  s_mov_b32 s47, 0x00020000
  s_lshl_b32 s28, s25, 9
  s_mul_i32 s49, s25, 928
  s_mul_i32 s50, s25, 896
  s_waitcnt vmcnt(21)
  s_barrier
  s_add_u32 s30, s30, 1
  s_cmp_eq_u32 s30, 7
  s_cselect_b32 s30, 0, s30
  s_lshl_b32 s31, s30, 7
  s_add_u32 s31, s31, s53
  s_add_u32 m0, s51, 88064
  s_nop 0
  buffer_load_dwordx4 v6, s[60:63], s31 offen lds
  s_add_u32 m0, s51, 90112
  s_add_u32 s31, s31, 14336
  buffer_load_dwordx4 v6, s[60:63], s31 offen lds
  s_add_u32 m0, s51, 92160
  s_add_u32 s31, s31, 14336
  buffer_load_dwordx4 v6, s[60:63], s31 offen lds
  s_add_u32 m0, s51, 94208
  s_add_u32 s31, s31, 14336
  buffer_load_dwordx4 v6, s[60:63], s31 offen lds
  s_add_u32 m0, s51, 96256
  s_add_u32 s31, s31, 14336
  buffer_load_dwordx4 v6, s[60:63], s31 offen lds
  s_lshl_b32 s31, s30, 19
  s_add_u32 s31, s31, s48
  s_add_u32 m0, s26, 98304
  s_nop 0
  buffer_load_dwordx4 v3, s[32:35], s31 offen lds
  s_add_u32 m0, s26, 100416
  s_add_u32 s52, s31, 16384
  buffer_load_dwordx4 v3, s[32:35], s52 offen lds
  s_add_u32 m0, s26, 102528
  s_add_u32 s52, s31, 65536
  buffer_load_dwordx4 v3, s[32:35], s52 offen lds
  s_add_u32 m0, s26, 104640
  s_add_u32 s52, s31, 81920
  buffer_load_dwordx4 v3, s[32:35], s52 offen lds
  s_add_u32 m0, s26, 106752
  s_add_u32 s52, s31, 131072
  buffer_load_dwordx4 v3, s[32:35], s52 offen lds
  s_add_u32 m0, s26, 108864
  s_add_u32 s52, s31, 147456
  buffer_load_dwordx4 v3, s[32:35], s52 offen lds
  s_add_u32 m0, s26, 110976
  s_add_u32 s52, s31, 196608
  buffer_load_dwordx4 v3, s[32:35], s52 offen lds
  s_add_u32 m0, s26, 113088
  s_add_u32 s52, s31, 212992
  buffer_load_dwordx4 v3, s[32:35], s52 offen lds
  s_lshl_b32 s31, s30, 19
  s_add_u32 s31, s31, s48
  s_add_u32 m0, s26, 115200
  s_add_u32 s52, s31, 262144
  buffer_load_dwordx4 v3, s[32:35], s52 offen lds
  s_add_u32 m0, s26, 117312
  s_add_u32 s52, s31, 278528
  buffer_load_dwordx4 v3, s[32:35], s52 offen lds
  s_add_u32 m0, s26, 119424
  s_add_u32 s52, s31, 327680
  buffer_load_dwordx4 v3, s[32:35], s52 offen lds
  s_add_u32 m0, s26, 121536
  s_add_u32 s52, s31, 344064
  buffer_load_dwordx4 v3, s[32:35], s52 offen lds
  s_add_u32 m0, s26, 123648
  s_add_u32 s52, s31, 393216
  buffer_load_dwordx4 v3, s[32:35], s52 offen lds
  s_add_u32 m0, s26, 125760
  s_add_u32 s52, s31, 409600
  buffer_load_dwordx4 v3, s[32:35], s52 offen lds
  s_add_u32 m0, s26, 127872
  s_add_u32 s52, s31, 458752
  buffer_load_dwordx4 v3, s[32:35], s52 offen lds
  s_add_u32 m0, s26, 129984
  s_add_u32 s52, s31, 475136
  buffer_load_dwordx4 v3, s[32:35], s52 offen lds
  s_waitcnt vmcnt(21)
  s_barrier
  s_add_u32 s30, s30, 1
  s_cmp_eq_u32 s30, 7
  s_cselect_b32 s30, 0, s30
  s_lshl_b32 s31, s30, 7
  s_add_u32 s31, s31, s53
  s_add_u32 m0, s51, 0
  s_nop 0
  buffer_load_dwordx4 v6, s[60:63], s31 offen lds
  s_add_u32 m0, s51, 2048
  s_add_u32 s31, s31, 14336
  buffer_load_dwordx4 v6, s[60:63], s31 offen lds
  s_add_u32 m0, s51, 4096
  s_add_u32 s31, s31, 14336
  buffer_load_dwordx4 v6, s[60:63], s31 offen lds
  s_add_u32 m0, s51, 6144
  s_add_u32 s31, s31, 14336
  buffer_load_dwordx4 v6, s[60:63], s31 offen lds
  s_add_u32 m0, s51, 8192
  s_add_u32 s31, s31, 14336
  buffer_load_dwordx4 v6, s[60:63], s31 offen lds
  s_lshl_b32 s31, s30, 19
  s_add_u32 s31, s31, s48
  s_add_u32 m0, s26, 10240
  s_nop 0
  buffer_load_dwordx4 v3, s[32:35], s31 offen lds
  s_add_u32 m0, s26, 12352
  s_add_u32 s52, s31, 16384
  buffer_load_dwordx4 v3, s[32:35], s52 offen lds
  s_add_u32 m0, s26, 14464
  s_add_u32 s52, s31, 65536
  buffer_load_dwordx4 v3, s[32:35], s52 offen lds
  s_add_u32 m0, s26, 16576
  s_add_u32 s52, s31, 81920
  buffer_load_dwordx4 v3, s[32:35], s52 offen lds
  s_add_u32 m0, s26, 18688
  s_add_u32 s52, s31, 131072
  buffer_load_dwordx4 v3, s[32:35], s52 offen lds
  s_add_u32 m0, s26, 20800
  s_add_u32 s52, s31, 147456
  buffer_load_dwordx4 v3, s[32:35], s52 offen lds
  s_add_u32 m0, s26, 22912
  s_add_u32 s52, s31, 196608
  buffer_load_dwordx4 v3, s[32:35], s52 offen lds
  s_add_u32 m0, s26, 25024
  s_add_u32 s52, s31, 212992
  buffer_load_dwordx4 v3, s[32:35], s52 offen lds
  s_lshl_b32 s31, s30, 19
  s_add_u32 s31, s31, s48
  s_add_u32 m0, s26, 27136
  s_add_u32 s52, s31, 262144
  buffer_load_dwordx4 v3, s[32:35], s52 offen lds
  s_add_u32 m0, s26, 29248
  s_add_u32 s52, s31, 278528
  buffer_load_dwordx4 v3, s[32:35], s52 offen lds
  s_add_u32 m0, s26, 31360
  s_add_u32 s52, s31, 327680
  buffer_load_dwordx4 v3, s[32:35], s52 offen lds
  s_add_u32 m0, s26, 33472
  s_add_u32 s52, s31, 344064
  buffer_load_dwordx4 v3, s[32:35], s52 offen lds
  s_add_u32 m0, s26, 35584
  s_add_u32 s52, s31, 393216
  buffer_load_dwordx4 v3, s[32:35], s52 offen lds
  s_add_u32 m0, s26, 37696
  s_add_u32 s52, s31, 409600
  buffer_load_dwordx4 v3, s[32:35], s52 offen lds
  s_add_u32 m0, s26, 39808
  s_add_u32 s52, s31, 458752
  buffer_load_dwordx4 v3, s[32:35], s52 offen lds
  s_add_u32 m0, s26, 41920
  s_add_u32 s52, s31, 475136
  buffer_load_dwordx4 v3, s[32:35], s52 offen lds
  s_waitcnt vmcnt(21)
  s_barrier
  s_add_u32 s30, s30, 1
  s_cmp_eq_u32 s30, 7
  s_cselect_b32 s30, 0, s30
  s_lshl_b32 s31, s30, 7
  s_add_u32 s31, s31, s53
  s_add_u32 m0, s51, 44032
  s_nop 0
  buffer_load_dwordx4 v6, s[60:63], s31 offen lds
  s_add_u32 m0, s51, 46080
  s_add_u32 s31, s31, 14336
  buffer_load_dwordx4 v6, s[60:63], s31 offen lds
  s_add_u32 m0, s51, 48128
  s_add_u32 s31, s31, 14336
  buffer_load_dwordx4 v6, s[60:63], s31 offen lds
  s_add_u32 m0, s51, 50176
  s_add_u32 s31, s31, 14336
  buffer_load_dwordx4 v6, s[60:63], s31 offen lds
  s_add_u32 m0, s51, 52224
  s_add_u32 s31, s31, 14336
  buffer_load_dwordx4 v6, s[60:63], s31 offen lds
  s_lshl_b32 s31, s30, 19
  s_add_u32 s31, s31, s48
  s_add_u32 m0, s26, 54272
  s_nop 0
  buffer_load_dwordx4 v3, s[32:35], s31 offen lds
  s_add_u32 m0, s26, 56384
  s_add_u32 s52, s31, 16384
  buffer_load_dwordx4 v3, s[32:35], s52 offen lds
  s_add_u32 m0, s26, 58496
  s_add_u32 s52, s31, 65536
  buffer_load_dwordx4 v3, s[32:35], s52 offen lds
  s_add_u32 m0, s26, 60608
  s_add_u32 s52, s31, 81920
  buffer_load_dwordx4 v3, s[32:35], s52 offen lds
  s_add_u32 m0, s26, 62720
  s_add_u32 s52, s31, 131072
  buffer_load_dwordx4 v3, s[32:35], s52 offen lds
  s_add_u32 m0, s26, 64832
  s_add_u32 s52, s31, 147456
  buffer_load_dwordx4 v3, s[32:35], s52 offen lds
  s_add_u32 m0, s26, 66944
  s_add_u32 s52, s31, 196608
  buffer_load_dwordx4 v3, s[32:35], s52 offen lds
  s_add_u32 m0, s26, 69056
  s_add_u32 s52, s31, 212992
  buffer_load_dwordx4 v3, s[32:35], s52 offen lds
  s_lshl_b32 s31, s30, 19
  s_add_u32 s31, s31, s48
  s_add_u32 m0, s26, 71168
  s_add_u32 s52, s31, 262144
  buffer_load_dwordx4 v3, s[32:35], s52 offen lds
  s_add_u32 m0, s26, 73280
  s_add_u32 s52, s31, 278528
  buffer_load_dwordx4 v3, s[32:35], s52 offen lds
  s_add_u32 m0, s26, 75392
  s_add_u32 s52, s31, 327680
  buffer_load_dwordx4 v3, s[32:35], s52 offen lds
  s_add_u32 m0, s26, 77504
  s_add_u32 s52, s31, 344064
  buffer_load_dwordx4 v3, s[32:35], s52 offen lds
  s_add_u32 m0, s26, 79616
  s_add_u32 s52, s31, 393216
  buffer_load_dwordx4 v3, s[32:35], s52 offen lds
  s_add_u32 m0, s26, 81728
  s_add_u32 s52, s31, 409600
  buffer_load_dwordx4 v3, s[32:35], s52 offen lds
  s_add_u32 m0, s26, 83840
  s_add_u32 s52, s31, 458752
  buffer_load_dwordx4 v3, s[32:35], s52 offen lds
  s_add_u32 m0, s26, 85952
  s_add_u32 s52, s31, 475136
  buffer_load_dwordx4 v3, s[32:35], s52 offen lds
  s_waitcnt vmcnt(21)
  s_barrier
  s_add_u32 s30, s30, 1
  s_cmp_eq_u32 s30, 7
  s_cselect_b32 s30, 0, s30
  s_lshl_b32 s31, s30, 7
  s_add_u32 s31, s31, s53
  s_add_u32 m0, s51, 88064
  s_nop 0
  buffer_load_dwordx4 v6, s[60:63], s31 offen lds
  s_add_u32 m0, s51, 90112
  s_add_u32 s31, s31, 14336
  buffer_load_dwordx4 v6, s[60:63], s31 offen lds
  s_add_u32 m0, s51, 92160
  s_add_u32 s31, s31, 14336
  buffer_load_dwordx4 v6, s[60:63], s31 offen lds
  s_add_u32 m0, s51, 94208
  s_add_u32 s31, s31, 14336
  buffer_load_dwordx4 v6, s[60:63], s31 offen lds
  s_add_u32 m0, s51, 96256
  s_add_u32 s31, s31, 14336
  buffer_load_dwordx4 v6, s[60:63], s31 offen lds
  s_lshl_b32 s31, s30, 19
  s_add_u32 s31, s31, s48
  s_add_u32 m0, s26, 98304
  s_nop 0
  buffer_load_dwordx4 v3, s[32:35], s31 offen lds
  s_add_u32 m0, s26, 100416
  s_add_u32 s52, s31, 16384
  buffer_load_dwordx4 v3, s[32:35], s52 offen lds
  s_add_u32 m0, s26, 102528
  s_add_u32 s52, s31, 65536
  buffer_load_dwordx4 v3, s[32:35], s52 offen lds
  s_add_u32 m0, s26, 104640
  s_add_u32 s52, s31, 81920
  buffer_load_dwordx4 v3, s[32:35], s52 offen lds
  s_add_u32 m0, s26, 106752
  s_add_u32 s52, s31, 131072
  buffer_load_dwordx4 v3, s[32:35], s52 offen lds
  s_add_u32 m0, s26, 108864
  s_add_u32 s52, s31, 147456
  buffer_load_dwordx4 v3, s[32:35], s52 offen lds
  s_add_u32 m0, s26, 110976
  s_add_u32 s52, s31, 196608
  buffer_load_dwordx4 v3, s[32:35], s52 offen lds
  s_add_u32 m0, s26, 113088
  s_add_u32 s52, s31, 212992
  buffer_load_dwordx4 v3, s[32:35], s52 offen lds
  s_lshl_b32 s31, s30, 19
  s_add_u32 s31, s31, s48
  s_add_u32 m0, s26, 115200
  s_add_u32 s52, s31, 262144
  buffer_load_dwordx4 v3, s[32:35], s52 offen lds
  s_add_u32 m0, s26, 117312
  s_add_u32 s52, s31, 278528
  buffer_load_dwordx4 v3, s[32:35], s52 offen lds
  s_add_u32 m0, s26, 119424
  s_add_u32 s52, s31, 327680
  buffer_load_dwordx4 v3, s[32:35], s52 offen lds
  s_add_u32 m0, s26, 121536
  s_add_u32 s52, s31, 344064
  buffer_load_dwordx4 v3, s[32:35], s52 offen lds
  s_add_u32 m0, s26, 123648
  s_add_u32 s52, s31, 393216
  buffer_load_dwordx4 v3, s[32:35], s52 offen lds
  s_add_u32 m0, s26, 125760
  s_add_u32 s52, s31, 409600
  buffer_load_dwordx4 v3, s[32:35], s52 offen lds
  s_add_u32 m0, s26, 127872
  s_add_u32 s52, s31, 458752
  buffer_load_dwordx4 v3, s[32:35], s52 offen lds
  s_add_u32 m0, s26, 129984
  s_add_u32 s52, s31, 475136
  buffer_load_dwordx4 v3, s[32:35], s52 offen lds
  s_waitcnt vmcnt(21)
  s_barrier
  s_add_u32 s30, s30, 1
  s_cmp_eq_u32 s30, 7
  s_cselect_b32 s30, 0, s30
  s_lshl_b32 s31, s30, 7
  s_add_u32 s31, s31, s53
  s_add_u32 m0, s51, 0
  s_nop 0
  buffer_load_dwordx4 v6, s[60:63], s31 offen lds
  s_add_u32 m0, s51, 2048
  s_add_u32 s31, s31, 14336
  buffer_load_dwordx4 v6, s[60:63], s31 offen lds
  s_add_u32 m0, s51, 4096
  s_add_u32 s31, s31, 14336
  buffer_load_dwordx4 v6, s[60:63], s31 offen lds
  s_add_u32 m0, s51, 6144
  s_add_u32 s31, s31, 14336
  buffer_load_dwordx4 v6, s[60:63], s31 offen lds
  s_add_u32 m0, s51, 8192
  s_add_u32 s31, s31, 14336
  buffer_load_dwordx4 v6, s[60:63], s31 offen lds
  s_lshl_b32 s31, s30, 19
  s_add_u32 s31, s31, s48
  s_add_u32 m0, s26, 10240
  s_nop 0
  buffer_load_dwordx4 v3, s[32:35], s31 offen lds
  s_add_u32 m0, s26, 12352
  s_add_u32 s52, s31, 16384
  buffer_load_dwordx4 v3, s[32:35], s52 offen lds
  s_add_u32 m0, s26, 14464
  s_add_u32 s52, s31, 65536
  buffer_load_dwordx4 v3, s[32:35], s52 offen lds
  s_add_u32 m0, s26, 16576
  s_add_u32 s52, s31, 81920
  buffer_load_dwordx4 v3, s[32:35], s52 offen lds
  s_add_u32 m0, s26, 18688
  s_add_u32 s52, s31, 131072
  buffer_load_dwordx4 v3, s[32:35], s52 offen lds
  s_add_u32 m0, s26, 20800
  s_add_u32 s52, s31, 147456
  buffer_load_dwordx4 v3, s[32:35], s52 offen lds
  s_add_u32 m0, s26, 22912
  s_add_u32 s52, s31, 196608
  buffer_load_dwordx4 v3, s[32:35], s52 offen lds
  s_add_u32 m0, s26, 25024
  s_add_u32 s52, s31, 212992
  buffer_load_dwordx4 v3, s[32:35], s52 offen lds
  s_lshl_b32 s31, s30, 19
  s_add_u32 s31, s31, s48
  s_add_u32 m0, s26, 27136
  s_add_u32 s52, s31, 262144
  buffer_load_dwordx4 v3, s[32:35], s52 offen lds
  s_add_u32 m0, s26, 29248
  s_add_u32 s52, s31, 278528
  buffer_load_dwordx4 v3, s[32:35], s52 offen lds
  s_add_u32 m0, s26, 31360
  s_add_u32 s52, s31, 327680
  buffer_load_dwordx4 v3, s[32:35], s52 offen lds
  s_add_u32 m0, s26, 33472
  s_add_u32 s52, s31, 344064
  buffer_load_dwordx4 v3, s[32:35], s52 offen lds
  s_add_u32 m0, s26, 35584
  s_add_u32 s52, s31, 393216
  buffer_load_dwordx4 v3, s[32:35], s52 offen lds
  s_add_u32 m0, s26, 37696
  s_add_u32 s52, s31, 409600
  buffer_load_dwordx4 v3, s[32:35], s52 offen lds
  s_add_u32 m0, s26, 39808
  s_add_u32 s52, s31, 458752
  buffer_load_dwordx4 v3, s[32:35], s52 offen lds
  s_add_u32 m0, s26, 41920
  s_add_u32 s52, s31, 475136
  buffer_load_dwordx4 v3, s[32:35], s52 offen lds
  s_waitcnt vmcnt(21)
  s_barrier
  s_add_u32 s31, s28, 0
  s_add_u32 m0, s26, 44032
  s_nop 0
  buffer_load_dwordx4 v1, s[36:39], s31 offen nt lds
  s_add_u32 m0, s26, 45120
  s_nop 0
  buffer_load_dwordx4 v1, s[36:39], s31 offen offset:1024 nt lds
  s_add_u32 m0, s26, 46208
  s_nop 0
  buffer_load_dwordx4 v1, s[36:39], s31 offen offset:2048 nt lds
  s_add_u32 m0, s26, 47296
  s_nop 0
  buffer_load_dwordx4 v1, s[36:39], s31 offen offset:3072 nt lds
  s_add_u32 s31, s28, 8192
  s_add_u32 m0, s26, 52480
  s_nop 0
  buffer_load_dwordx4 v1, s[36:39], s31 offen nt lds
  s_add_u32 m0, s26, 53568
  s_nop 0
  buffer_load_dwordx4 v1, s[36:39], s31 offen offset:1024 nt lds
  s_add_u32 m0, s26, 54656
  s_nop 0
  buffer_load_dwordx4 v1, s[36:39], s31 offen offset:2048 nt lds
  s_add_u32 m0, s26, 55744
  s_nop 0
  buffer_load_dwordx4 v1, s[36:39], s31 offen offset:3072 nt lds
  s_add_u32 s31, s28, 16384
  s_add_u32 m0, s26, 60928
  s_nop 0
  buffer_load_dwordx4 v1, s[36:39], s31 offen nt lds
  s_add_u32 m0, s26, 62016
  s_nop 0
  buffer_load_dwordx4 v1, s[36:39], s31 offen offset:1024 nt lds
  s_add_u32 m0, s26, 63104
  s_nop 0
  buffer_load_dwordx4 v1, s[36:39], s31 offen offset:2048 nt lds
  s_add_u32 m0, s26, 64192
  s_nop 0
  buffer_load_dwordx4 v1, s[36:39], s31 offen offset:3072 nt lds
  s_add_u32 s31, s28, 24576
  s_add_u32 m0, s26, 69376
  s_nop 0
  buffer_load_dwordx4 v1, s[36:39], s31 offen nt lds
  s_add_u32 m0, s26, 70464
  s_nop 0
  buffer_load_dwordx4 v1, s[36:39], s31 offen offset:1024 nt lds
  s_add_u32 m0, s26, 71552
  s_nop 0
  buffer_load_dwordx4 v1, s[36:39], s31 offen offset:2048 nt lds
  s_add_u32 m0, s26, 72640
  s_nop 0
  buffer_load_dwordx4 v1, s[36:39], s31 offen offset:3072 nt lds
  s_waitcnt vmcnt(16)
  s_barrier
  s_add_u32 s31, s28, 32768
  s_add_u32 m0, s26, 77824
  s_nop 0
  buffer_load_dwordx4 v1, s[36:39], s31 offen nt lds
  s_add_u32 m0, s26, 78912
  s_nop 0
  buffer_load_dwordx4 v1, s[36:39], s31 offen offset:1024 nt lds
  s_add_u32 m0, s26, 80000
  s_nop 0
  buffer_load_dwordx4 v1, s[36:39], s31 offen offset:2048 nt lds
  s_add_u32 m0, s26, 81088
  s_nop 0
  buffer_load_dwordx4 v1, s[36:39], s31 offen offset:3072 nt lds
  s_add_u32 s31, s28, 40960
  s_add_u32 m0, s26, 86272
  s_nop 0
  buffer_load_dwordx4 v1, s[36:39], s31 offen nt lds
  s_add_u32 m0, s26, 87360
  s_nop 0
  buffer_load_dwordx4 v1, s[36:39], s31 offen offset:1024 nt lds
  s_add_u32 m0, s26, 88448
  s_nop 0
  buffer_load_dwordx4 v1, s[36:39], s31 offen offset:2048 nt lds
  s_add_u32 m0, s26, 89536
  s_nop 0
  buffer_load_dwordx4 v1, s[36:39], s31 offen offset:3072 nt lds
  s_add_u32 s31, s28, 49152
  s_add_u32 m0, s26, 94720
  s_nop 0
  buffer_load_dwordx4 v1, s[36:39], s31 offen nt lds
  s_add_u32 m0, s26, 95808
  s_nop 0
  buffer_load_dwordx4 v1, s[36:39], s31 offen offset:1024 nt lds
  s_add_u32 m0, s26, 96896
  s_nop 0
  buffer_load_dwordx4 v1, s[36:39], s31 offen offset:2048 nt lds
  s_add_u32 m0, s26, 97984
  s_nop 0
  buffer_load_dwordx4 v1, s[36:39], s31 offen offset:3072 nt lds
  s_add_u32 s31, s28, 57344
  s_add_u32 m0, s26, 103168
  s_nop 0
  buffer_load_dwordx4 v1, s[36:39], s31 offen nt lds
  s_add_u32 m0, s26, 104256
  s_nop 0
  buffer_load_dwordx4 v1, s[36:39], s31 offen offset:1024 nt lds
  s_add_u32 m0, s26, 105344
  s_nop 0
  buffer_load_dwordx4 v1, s[36:39], s31 offen offset:2048 nt lds
  s_add_u32 m0, s26, 106432
  s_nop 0
  buffer_load_dwordx4 v1, s[36:39], s31 offen offset:3072 nt lds
  s_add_u32 s31, s28, 65536
  s_add_u32 m0, s26, 111616
  s_nop 0
  buffer_load_dwordx4 v1, s[36:39], s31 offen nt lds
  s_add_u32 m0, s26, 112704
  s_nop 0
  buffer_load_dwordx4 v1, s[36:39], s31 offen offset:1024 nt lds
  s_add_u32 m0, s26, 113792
  s_nop 0
  buffer_load_dwordx4 v1, s[36:39], s31 offen offset:2048 nt lds
  s_add_u32 m0, s26, 114880
  s_nop 0
  buffer_load_dwordx4 v1, s[36:39], s31 offen offset:3072 nt lds
  s_add_u32 s31, s28, 73728
  s_add_u32 m0, s26, 120064
  s_nop 0
  buffer_load_dwordx4 v1, s[36:39], s31 offen nt lds
  s_add_u32 m0, s26, 121152
  s_nop 0
  buffer_load_dwordx4 v1, s[36:39], s31 offen offset:1024 nt lds
  s_add_u32 m0, s26, 122240
  s_nop 0
  buffer_load_dwordx4 v1, s[36:39], s31 offen offset:2048 nt lds
  s_add_u32 m0, s26, 123328
  s_nop 0
  buffer_load_dwordx4 v1, s[36:39], s31 offen offset:3072 nt lds
  s_barrier
  s_barrier
  s_waitcnt vmcnt(24)
  s_barrier
  s_add_u32 s31, s28, 81920
  s_add_u32 m0, s26, 0
  s_nop 0
  buffer_load_dwordx4 v1, s[36:39], s31 offen nt lds
  s_add_u32 m0, s26, 1088
  s_nop 0
  buffer_load_dwordx4 v1, s[36:39], s31 offen offset:1024 nt lds
  s_add_u32 m0, s26, 2176
  s_nop 0
  buffer_load_dwordx4 v1, s[36:39], s31 offen offset:2048 nt lds
  s_add_u32 m0, s26, 3264
  s_nop 0
  buffer_load_dwordx4 v1, s[36:39], s31 offen offset:3072 nt lds
  s_add_u32 s31, s28, 90112
  s_add_u32 m0, s26, 8448
  s_nop 0
  buffer_load_dwordx4 v1, s[36:39], s31 offen nt lds
  s_add_u32 m0, s26, 9536
  s_nop 0
  buffer_load_dwordx4 v1, s[36:39], s31 offen offset:1024 nt lds
  s_add_u32 m0, s26, 10624
  s_nop 0
  buffer_load_dwordx4 v1, s[36:39], s31 offen offset:2048 nt lds
  s_add_u32 m0, s26, 11712
  s_nop 0
  buffer_load_dwordx4 v1, s[36:39], s31 offen offset:3072 nt lds
  s_add_u32 s31, s28, 98304
  s_add_u32 m0, s26, 16896
  s_nop 0
  buffer_load_dwordx4 v1, s[36:39], s31 offen nt lds
  s_add_u32 m0, s26, 17984
  s_nop 0
  buffer_load_dwordx4 v1, s[36:39], s31 offen offset:1024 nt lds
  s_add_u32 m0, s26, 19072
  s_nop 0
  buffer_load_dwordx4 v1, s[36:39], s31 offen offset:2048 nt lds
  s_add_u32 m0, s26, 20160
  s_nop 0
  buffer_load_dwordx4 v1, s[36:39], s31 offen offset:3072 nt lds
  s_add_u32 s31, s28, 106496
  s_add_u32 m0, s26, 25344
  s_nop 0
  buffer_load_dwordx4 v1, s[36:39], s31 offen nt lds
  s_add_u32 m0, s26, 26432
  s_nop 0
  buffer_load_dwordx4 v1, s[36:39], s31 offen offset:1024 nt lds
  s_add_u32 m0, s26, 27520
  s_nop 0
  buffer_load_dwordx4 v1, s[36:39], s31 offen offset:2048 nt lds
  s_add_u32 m0, s26, 28608
  s_nop 0
  buffer_load_dwordx4 v1, s[36:39], s31 offen offset:3072 nt lds
  s_waitcnt vmcnt(24)
  s_barrier
  s_add_u32 s31, s28, 114688
  s_add_u32 m0, s26, 33792
  s_nop 0
  buffer_load_dwordx4 v1, s[36:39], s31 offen nt lds
  s_add_u32 m0, s26, 34880
  s_nop 0
  buffer_load_dwordx4 v1, s[36:39], s31 offen offset:1024 nt lds
  s_add_u32 m0, s26, 35968
  s_nop 0
  buffer_load_dwordx4 v1, s[36:39], s31 offen offset:2048 nt lds
  s_add_u32 m0, s26, 37056
  s_nop 0
  buffer_load_dwordx4 v1, s[36:39], s31 offen offset:3072 nt lds
  s_add_u32 s31, s28, 122880
  s_add_u32 m0, s26, 42240
  s_nop 0
  buffer_load_dwordx4 v1, s[36:39], s31 offen nt lds
  s_add_u32 m0, s26, 43328
  s_nop 0
  buffer_load_dwordx4 v1, s[36:39], s31 offen offset:1024 nt lds
  s_add_u32 m0, s26, 44416
  s_nop 0
  buffer_load_dwordx4 v1, s[36:39], s31 offen offset:2048 nt lds
  s_add_u32 m0, s26, 45504
  s_nop 0
  buffer_load_dwordx4 v1, s[36:39], s31 offen offset:3072 nt lds
  s_add_u32 s31, s28, 131072
  s_add_u32 m0, s26, 50688
  s_nop 0
  buffer_load_dwordx4 v1, s[36:39], s31 offen nt lds
  s_add_u32 m0, s26, 51776
  s_nop 0
  buffer_load_dwordx4 v1, s[36:39], s31 offen offset:1024 nt lds
  s_add_u32 m0, s26, 52864
  s_nop 0
  buffer_load_dwordx4 v1, s[36:39], s31 offen offset:2048 nt lds
  s_add_u32 m0, s26, 53952
  s_nop 0
  buffer_load_dwordx4 v1, s[36:39], s31 offen offset:3072 nt lds
  s_add_u32 s31, s28, 139264
  s_add_u32 m0, s26, 59136
  s_nop 0
  buffer_load_dwordx4 v1, s[36:39], s31 offen nt lds
  s_add_u32 m0, s26, 60224
  s_nop 0
  buffer_load_dwordx4 v1, s[36:39], s31 offen offset:1024 nt lds
  s_add_u32 m0, s26, 61312
  s_nop 0
  buffer_load_dwordx4 v1, s[36:39], s31 offen offset:2048 nt lds
  s_add_u32 m0, s26, 62400
  s_nop 0
  buffer_load_dwordx4 v1, s[36:39], s31 offen offset:3072 nt lds
  s_waitcnt vmcnt(24)
  s_barrier
  s_add_u32 s31, s28, 147456
  s_add_u32 m0, s26, 67584
  s_nop 0
  buffer_load_dwordx4 v1, s[36:39], s31 offen nt lds
  s_add_u32 m0, s26, 68672
  s_nop 0
  buffer_load_dwordx4 v1, s[36:39], s31 offen offset:1024 nt lds
  s_add_u32 m0, s26, 69760
  s_nop 0
  buffer_load_dwordx4 v1, s[36:39], s31 offen offset:2048 nt lds
  s_add_u32 m0, s26, 70848
  s_nop 0
  buffer_load_dwordx4 v1, s[36:39], s31 offen offset:3072 nt lds
  s_add_u32 s31, s28, 155648
  s_add_u32 m0, s26, 76032
  s_nop 0
  buffer_load_dwordx4 v1, s[36:39], s31 offen nt lds
  s_add_u32 m0, s26, 77120
  s_nop 0
  buffer_load_dwordx4 v1, s[36:39], s31 offen offset:1024 nt lds
  s_add_u32 m0, s26, 78208
  s_nop 0
  buffer_load_dwordx4 v1, s[36:39], s31 offen offset:2048 nt lds
  s_add_u32 m0, s26, 79296
  s_nop 0
  buffer_load_dwordx4 v1, s[36:39], s31 offen offset:3072 nt lds
  s_add_u32 s31, s28, 163840
  s_add_u32 m0, s26, 84480
  s_nop 0
  buffer_load_dwordx4 v1, s[36:39], s31 offen nt lds
  s_add_u32 m0, s26, 85568
  s_nop 0
  buffer_load_dwordx4 v1, s[36:39], s31 offen offset:1024 nt lds
  s_add_u32 m0, s26, 86656
  s_nop 0
  buffer_load_dwordx4 v1, s[36:39], s31 offen offset:2048 nt lds
  s_add_u32 m0, s26, 87744
  s_nop 0
  buffer_load_dwordx4 v1, s[36:39], s31 offen offset:3072 nt lds
  s_add_u32 s31, s28, 172032
  s_add_u32 m0, s26, 92928
  s_nop 0
  buffer_load_dwordx4 v1, s[36:39], s31 offen nt lds
  s_add_u32 m0, s26, 94016
  s_nop 0
  buffer_load_dwordx4 v1, s[36:39], s31 offen offset:1024 nt lds
  s_add_u32 m0, s26, 95104
  s_nop 0
  buffer_load_dwordx4 v1, s[36:39], s31 offen offset:2048 nt lds
  s_add_u32 m0, s26, 96192
  s_nop 0
  buffer_load_dwordx4 v1, s[36:39], s31 offen offset:3072 nt lds
  s_waitcnt vmcnt(24)
  s_barrier
  s_add_u32 s31, s28, 180224
  s_add_u32 m0, s26, 101376
  s_nop 0
  buffer_load_dwordx4 v1, s[36:39], s31 offen nt lds
  s_add_u32 m0, s26, 102464
  s_nop 0
  buffer_load_dwordx4 v1, s[36:39], s31 offen offset:1024 nt lds
  s_add_u32 m0, s26, 103552
  s_nop 0
  buffer_load_dwordx4 v1, s[36:39], s31 offen offset:2048 nt lds
  s_add_u32 m0, s26, 104640
  s_nop 0
  buffer_load_dwordx4 v1, s[36:39], s31 offen offset:3072 nt lds
  s_add_u32 s31, s28, 188416
  s_add_u32 m0, s26, 109824
  s_nop 0
  buffer_load_dwordx4 v1, s[36:39], s31 offen nt lds
  s_add_u32 m0, s26, 110912
  s_nop 0
  buffer_load_dwordx4 v1, s[36:39], s31 offen offset:1024 nt lds
  s_add_u32 m0, s26, 112000
  s_nop 0
  buffer_load_dwordx4 v1, s[36:39], s31 offen offset:2048 nt lds
  s_add_u32 m0, s26, 113088
  s_nop 0
  buffer_load_dwordx4 v1, s[36:39], s31 offen offset:3072 nt lds
  s_add_u32 s31, s28, 196608
  s_add_u32 m0, s26, 118272
  s_nop 0
  buffer_load_dwordx4 v1, s[36:39], s31 offen nt lds
  s_add_u32 m0, s26, 119360
  s_nop 0
  buffer_load_dwordx4 v1, s[36:39], s31 offen offset:1024 nt lds
  s_add_u32 m0, s26, 120448
  s_nop 0
  buffer_load_dwordx4 v1, s[36:39], s31 offen offset:2048 nt lds
  s_add_u32 m0, s26, 121536
  s_nop 0
  buffer_load_dwordx4 v1, s[36:39], s31 offen offset:3072 nt lds
  s_add_u32 s31, s28, 204800
  s_add_u32 m0, s26, 126720
  s_nop 0
  buffer_load_dwordx4 v1, s[36:39], s31 offen nt lds
  s_add_u32 m0, s26, 127808
  s_nop 0
  buffer_load_dwordx4 v1, s[36:39], s31 offen offset:1024 nt lds
  s_add_u32 m0, s26, 128896
  s_nop 0
  buffer_load_dwordx4 v1, s[36:39], s31 offen offset:2048 nt lds
  s_add_u32 m0, s26, 129984
  s_nop 0
  buffer_load_dwordx4 v1, s[36:39], s31 offen offset:3072 nt lds
  s_add_u32 s31, s28, 212992
  s_add_u32 m0, s26, 0
  s_nop 0
  buffer_load_dwordx4 v1, s[36:39], s31 offen nt lds
  s_add_u32 m0, s26, 1088
  s_nop 0
  buffer_load_dwordx4 v1, s[36:39], s31 offen offset:1024 nt lds
  s_add_u32 m0, s26, 2176
  s_nop 0
  buffer_load_dwordx4 v1, s[36:39], s31 offen offset:2048 nt lds
  s_add_u32 m0, s26, 3264
  s_nop 0
  buffer_load_dwordx4 v1, s[36:39], s31 offen offset:3072 nt lds
  s_add_u32 s31, s28, 221184
  s_add_u32 m0, s26, 8448
  s_nop 0
  buffer_load_dwordx4 v1, s[36:39], s31 offen nt lds
  s_add_u32 m0, s26, 9536
  s_nop 0
  buffer_load_dwordx4 v1, s[36:39], s31 offen offset:1024 nt lds
  s_add_u32 m0, s26, 10624
  s_nop 0
  buffer_load_dwordx4 v1, s[36:39], s31 offen offset:2048 nt lds
  s_add_u32 m0, s26, 11712
  s_nop 0
  buffer_load_dwordx4 v1, s[36:39], s31 offen offset:3072 nt lds
  s_waitcnt vmcnt(32)
  s_barrier
  s_add_u32 s31, s28, 229376
  s_add_u32 m0, s26, 16896
  s_nop 0
  buffer_load_dwordx4 v1, s[36:39], s31 offen nt lds
  s_add_u32 m0, s26, 17984
  s_nop 0
  buffer_load_dwordx4 v1, s[36:39], s31 offen offset:1024 nt lds
  s_add_u32 m0, s26, 19072
  s_nop 0
  buffer_load_dwordx4 v1, s[36:39], s31 offen offset:2048 nt lds
  s_add_u32 m0, s26, 20160
  s_nop 0
  buffer_load_dwordx4 v1, s[36:39], s31 offen offset:3072 nt lds
  s_add_u32 s31, s28, 237568
  s_add_u32 m0, s26, 25344
  s_nop 0
  buffer_load_dwordx4 v1, s[36:39], s31 offen nt lds
  s_add_u32 m0, s26, 26432
  s_nop 0
  buffer_load_dwordx4 v1, s[36:39], s31 offen offset:1024 nt lds
  s_add_u32 m0, s26, 27520
  s_nop 0
  buffer_load_dwordx4 v1, s[36:39], s31 offen offset:2048 nt lds
  s_add_u32 m0, s26, 28608
  s_nop 0
  buffer_load_dwordx4 v1, s[36:39], s31 offen offset:3072 nt lds
  s_add_u32 s31, s28, 245760
  s_add_u32 m0, s26, 33792
  s_nop 0
  buffer_load_dwordx4 v1, s[36:39], s31 offen nt lds
  s_add_u32 m0, s26, 34880
  s_nop 0
  buffer_load_dwordx4 v1, s[36:39], s31 offen offset:1024 nt lds
  s_add_u32 m0, s26, 35968
  s_nop 0
  buffer_load_dwordx4 v1, s[36:39], s31 offen offset:2048 nt lds
  s_add_u32 m0, s26, 37056
  s_nop 0
  buffer_load_dwordx4 v1, s[36:39], s31 offen offset:3072 nt lds
  s_add_u32 s31, s28, 253952
  s_add_u32 m0, s26, 42240
  s_nop 0
  buffer_load_dwordx4 v1, s[36:39], s31 offen nt lds
  s_add_u32 m0, s26, 43328
  s_nop 0
  buffer_load_dwordx4 v1, s[36:39], s31 offen offset:1024 nt lds
  s_add_u32 m0, s26, 44416
  s_nop 0
  buffer_load_dwordx4 v1, s[36:39], s31 offen offset:2048 nt lds
  s_add_u32 m0, s26, 45504
  s_nop 0
  buffer_load_dwordx4 v1, s[36:39], s31 offen offset:3072 nt lds
  s_waitcnt vmcnt(32)
  s_barrier
  s_add_u32 s31, s28, 262144
  s_add_u32 m0, s26, 50688
  s_nop 0
  buffer_load_dwordx4 v1, s[36:39], s31 offen nt lds
  s_add_u32 m0, s26, 51776
  s_nop 0
  buffer_load_dwordx4 v1, s[36:39], s31 offen offset:1024 nt lds
  s_add_u32 m0, s26, 52864
  s_nop 0
  buffer_load_dwordx4 v1, s[36:39], s31 offen offset:2048 nt lds
  s_add_u32 m0, s26, 53952
  s_nop 0
  buffer_load_dwordx4 v1, s[36:39], s31 offen offset:3072 nt lds
  s_add_u32 s31, s28, 270336
  s_add_u32 m0, s26, 59136
  s_nop 0
  buffer_load_dwordx4 v1, s[36:39], s31 offen nt lds
  s_add_u32 m0, s26, 60224
  s_nop 0
  buffer_load_dwordx4 v1, s[36:39], s31 offen offset:1024 nt lds
  s_add_u32 m0, s26, 61312
  s_nop 0
  buffer_load_dwordx4 v1, s[36:39], s31 offen offset:2048 nt lds
  s_add_u32 m0, s26, 62400
  s_nop 0
  buffer_load_dwordx4 v1, s[36:39], s31 offen offset:3072 nt lds
  s_add_u32 s31, s28, 278528
  s_add_u32 m0, s26, 67584
  s_nop 0
  buffer_load_dwordx4 v1, s[36:39], s31 offen nt lds
  s_add_u32 m0, s26, 68672
  s_nop 0
  buffer_load_dwordx4 v1, s[36:39], s31 offen offset:1024 nt lds
  s_add_u32 m0, s26, 69760
  s_nop 0
  buffer_load_dwordx4 v1, s[36:39], s31 offen offset:2048 nt lds
  s_add_u32 m0, s26, 70848
  s_nop 0
  buffer_load_dwordx4 v1, s[36:39], s31 offen offset:3072 nt lds
  s_add_u32 s31, s28, 286720
  s_add_u32 m0, s26, 76032
  s_nop 0
  buffer_load_dwordx4 v1, s[36:39], s31 offen nt lds
  s_add_u32 m0, s26, 77120
  s_nop 0
  buffer_load_dwordx4 v1, s[36:39], s31 offen offset:1024 nt lds
  s_add_u32 m0, s26, 78208
  s_nop 0
  buffer_load_dwordx4 v1, s[36:39], s31 offen offset:2048 nt lds
  s_add_u32 m0, s26, 79296
  s_nop 0
  buffer_load_dwordx4 v1, s[36:39], s31 offen offset:3072 nt lds
  s_waitcnt vmcnt(32)
  s_barrier
  s_add_u32 s31, s28, 294912
  s_add_u32 m0, s26, 84480
  s_nop 0
  buffer_load_dwordx4 v1, s[36:39], s31 offen nt lds
  s_add_u32 m0, s26, 85568
  s_nop 0
  buffer_load_dwordx4 v1, s[36:39], s31 offen offset:1024 nt lds
  s_add_u32 m0, s26, 86656
  s_nop 0
  buffer_load_dwordx4 v1, s[36:39], s31 offen offset:2048 nt lds
  s_add_u32 m0, s26, 87744
  s_nop 0
  buffer_load_dwordx4 v1, s[36:39], s31 offen offset:3072 nt lds
  s_add_u32 s31, s28, 303104
  s_add_u32 m0, s26, 92928
  s_nop 0
  buffer_load_dwordx4 v1, s[36:39], s31 offen nt lds
  s_add_u32 m0, s26, 94016
  s_nop 0
  buffer_load_dwordx4 v1, s[36:39], s31 offen offset:1024 nt lds
  s_add_u32 m0, s26, 95104
  s_nop 0
  buffer_load_dwordx4 v1, s[36:39], s31 offen offset:2048 nt lds
  s_add_u32 m0, s26, 96192
  s_nop 0
  buffer_load_dwordx4 v1, s[36:39], s31 offen offset:3072 nt lds
  s_add_u32 s31, s28, 311296
  s_add_u32 m0, s26, 101376
  s_nop 0
  buffer_load_dwordx4 v1, s[36:39], s31 offen nt lds
  s_add_u32 m0, s26, 102464
  s_nop 0
  buffer_load_dwordx4 v1, s[36:39], s31 offen offset:1024 nt lds
  s_add_u32 m0, s26, 103552
  s_nop 0
  buffer_load_dwordx4 v1, s[36:39], s31 offen offset:2048 nt lds
  s_add_u32 m0, s26, 104640
  s_nop 0
  buffer_load_dwordx4 v1, s[36:39], s31 offen offset:3072 nt lds
  s_add_u32 s31, s28, 319488
  s_add_u32 m0, s26, 109824
  s_nop 0
  buffer_load_dwordx4 v1, s[36:39], s31 offen nt lds
  s_add_u32 m0, s26, 110912
  s_nop 0
  buffer_load_dwordx4 v1, s[36:39], s31 offen offset:1024 nt lds
  s_add_u32 m0, s26, 112000
  s_nop 0
  buffer_load_dwordx4 v1, s[36:39], s31 offen offset:2048 nt lds
  s_add_u32 m0, s26, 113088
  s_nop 0
  buffer_load_dwordx4 v1, s[36:39], s31 offen offset:3072 nt lds
  s_waitcnt vmcnt(32)
  s_barrier
  s_add_u32 s31, s28, 327680
  s_add_u32 m0, s26, 118272
  s_nop 0
  buffer_load_dwordx4 v1, s[36:39], s31 offen nt lds
  s_add_u32 m0, s26, 119360
  s_nop 0
  buffer_load_dwordx4 v1, s[36:39], s31 offen offset:1024 nt lds
  s_add_u32 m0, s26, 120448
  s_nop 0
  buffer_load_dwordx4 v1, s[36:39], s31 offen offset:2048 nt lds
  s_add_u32 m0, s26, 121536
  s_nop 0
  buffer_load_dwordx4 v1, s[36:39], s31 offen offset:3072 nt lds
  s_add_u32 s31, s28, 335872
  s_add_u32 m0, s26, 126720
  s_nop 0
  buffer_load_dwordx4 v1, s[36:39], s31 offen nt lds
  s_add_u32 m0, s26, 127808
  s_nop 0
  buffer_load_dwordx4 v1, s[36:39], s31 offen offset:1024 nt lds
  s_add_u32 m0, s26, 128896
  s_nop 0
  buffer_load_dwordx4 v1, s[36:39], s31 offen offset:2048 nt lds
  s_add_u32 m0, s26, 129984
  s_nop 0
  buffer_load_dwordx4 v1, s[36:39], s31 offen offset:3072 nt lds
  s_add_u32 s31, s28, 344064
  s_add_u32 m0, s26, 0
  s_nop 0
  buffer_load_dwordx4 v1, s[36:39], s31 offen nt lds
  s_add_u32 m0, s26, 1088
  s_nop 0
  buffer_load_dwordx4 v1, s[36:39], s31 offen offset:1024 nt lds
  s_add_u32 m0, s26, 2176
  s_nop 0
  buffer_load_dwordx4 v1, s[36:39], s31 offen offset:2048 nt lds
  s_add_u32 m0, s26, 3264
  s_nop 0
  buffer_load_dwordx4 v1, s[36:39], s31 offen offset:3072 nt lds
  s_add_u32 s31, s28, 352256
  s_add_u32 m0, s26, 8448
  s_nop 0
  buffer_load_dwordx4 v1, s[36:39], s31 offen nt lds
  s_add_u32 m0, s26, 9536
  s_nop 0
  buffer_load_dwordx4 v1, s[36:39], s31 offen offset:1024 nt lds
  s_add_u32 m0, s26, 10624
  s_nop 0
  buffer_load_dwordx4 v1, s[36:39], s31 offen offset:2048 nt lds
  s_add_u32 m0, s26, 11712
  s_nop 0
  buffer_load_dwordx4 v1, s[36:39], s31 offen offset:3072 nt lds
  s_waitcnt vmcnt(32)
  s_barrier
  s_add_u32 s31, s28, 360448
  s_add_u32 m0, s26, 16896
  s_nop 0
  buffer_load_dwordx4 v1, s[36:39], s31 offen nt lds
  s_add_u32 m0, s26, 17984
  s_nop 0
  buffer_load_dwordx4 v1, s[36:39], s31 offen offset:1024 nt lds
  s_add_u32 m0, s26, 19072
  s_nop 0
  buffer_load_dwordx4 v1, s[36:39], s31 offen offset:2048 nt lds
  s_add_u32 m0, s26, 20160
  s_nop 0
  buffer_load_dwordx4 v1, s[36:39], s31 offen offset:3072 nt lds
  s_add_u32 s31, s28, 368640
  s_add_u32 m0, s26, 25344
  s_nop 0
  buffer_load_dwordx4 v1, s[36:39], s31 offen nt lds
  s_add_u32 m0, s26, 26432
  s_nop 0
  buffer_load_dwordx4 v1, s[36:39], s31 offen offset:1024 nt lds
  s_add_u32 m0, s26, 27520
  s_nop 0
  buffer_load_dwordx4 v1, s[36:39], s31 offen offset:2048 nt lds
  s_add_u32 m0, s26, 28608
  s_nop 0
  buffer_load_dwordx4 v1, s[36:39], s31 offen offset:3072 nt lds
  s_add_u32 s31, s28, 376832
  s_add_u32 m0, s26, 33792
  s_nop 0
  buffer_load_dwordx4 v1, s[36:39], s31 offen nt lds
  s_add_u32 m0, s26, 34880
  s_nop 0
  buffer_load_dwordx4 v1, s[36:39], s31 offen offset:1024 nt lds
  s_add_u32 m0, s26, 35968
  s_nop 0
  buffer_load_dwordx4 v1, s[36:39], s31 offen offset:2048 nt lds
  s_add_u32 m0, s26, 37056
  s_nop 0
  buffer_load_dwordx4 v1, s[36:39], s31 offen offset:3072 nt lds
  s_add_u32 s31, s28, 385024
  s_add_u32 m0, s26, 42240
  s_nop 0
  buffer_load_dwordx4 v1, s[36:39], s31 offen nt lds
  s_add_u32 m0, s26, 43328
  s_nop 0
  buffer_load_dwordx4 v1, s[36:39], s31 offen offset:1024 nt lds
  s_add_u32 m0, s26, 44416
  s_nop 0
  buffer_load_dwordx4 v1, s[36:39], s31 offen offset:2048 nt lds
  s_add_u32 m0, s26, 45504
  s_nop 0
  buffer_load_dwordx4 v1, s[36:39], s31 offen offset:3072 nt lds
  s_waitcnt vmcnt(32)
  s_barrier
  s_add_u32 s31, s28, 393216
  s_add_u32 m0, s26, 50688
  s_nop 0
  buffer_load_dwordx4 v1, s[36:39], s31 offen nt lds
  s_add_u32 m0, s26, 51776
  s_nop 0
  buffer_load_dwordx4 v1, s[36:39], s31 offen offset:1024 nt lds
  s_add_u32 m0, s26, 52864
  s_nop 0
  buffer_load_dwordx4 v1, s[36:39], s31 offen offset:2048 nt lds
  s_add_u32 m0, s26, 53952
  s_nop 0
  buffer_load_dwordx4 v1, s[36:39], s31 offen offset:3072 nt lds
  s_add_u32 s31, s28, 401408
  s_add_u32 m0, s26, 59136
  s_nop 0
  buffer_load_dwordx4 v1, s[36:39], s31 offen nt lds
  s_add_u32 m0, s26, 60224
  s_nop 0
  buffer_load_dwordx4 v1, s[36:39], s31 offen offset:1024 nt lds
  s_add_u32 m0, s26, 61312
  s_nop 0
  buffer_load_dwordx4 v1, s[36:39], s31 offen offset:2048 nt lds
  s_add_u32 m0, s26, 62400
  s_nop 0
  buffer_load_dwordx4 v1, s[36:39], s31 offen offset:3072 nt lds
  s_add_u32 s31, s28, 409600
  s_add_u32 m0, s26, 67584
  s_nop 0
  buffer_load_dwordx4 v1, s[36:39], s31 offen nt lds
  s_add_u32 m0, s26, 68672
  s_nop 0
  buffer_load_dwordx4 v1, s[36:39], s31 offen offset:1024 nt lds
  s_add_u32 m0, s26, 69760
  s_nop 0
  buffer_load_dwordx4 v1, s[36:39], s31 offen offset:2048 nt lds
  s_add_u32 m0, s26, 70848
  s_nop 0
  buffer_load_dwordx4 v1, s[36:39], s31 offen offset:3072 nt lds
  s_add_u32 s31, s28, 417792
  s_add_u32 m0, s26, 76032
  s_nop 0
  buffer_load_dwordx4 v1, s[36:39], s31 offen nt lds
  s_add_u32 m0, s26, 77120
  s_nop 0
  buffer_load_dwordx4 v1, s[36:39], s31 offen offset:1024 nt lds
  s_add_u32 m0, s26, 78208
  s_nop 0
  buffer_load_dwordx4 v1, s[36:39], s31 offen offset:2048 nt lds
  s_add_u32 m0, s26, 79296
  s_nop 0
  buffer_load_dwordx4 v1, s[36:39], s31 offen offset:3072 nt lds
  s_waitcnt vmcnt(32)
  s_barrier
  s_add_u32 s31, s28, 425984
  s_add_u32 m0, s26, 84480
  s_nop 0
  buffer_load_dwordx4 v1, s[36:39], s31 offen nt lds
  s_add_u32 m0, s26, 85568
  s_nop 0
  buffer_load_dwordx4 v1, s[36:39], s31 offen offset:1024 nt lds
  s_add_u32 m0, s26, 86656
  s_nop 0
  buffer_load_dwordx4 v1, s[36:39], s31 offen offset:2048 nt lds
  s_add_u32 m0, s26, 87744
  s_nop 0
  buffer_load_dwordx4 v1, s[36:39], s31 offen offset:3072 nt lds
  s_add_u32 s31, s28, 434176
  s_add_u32 m0, s26, 92928
  s_nop 0
  buffer_load_dwordx4 v1, s[36:39], s31 offen nt lds
  s_add_u32 m0, s26, 94016
  s_nop 0
  buffer_load_dwordx4 v1, s[36:39], s31 offen offset:1024 nt lds
  s_add_u32 m0, s26, 95104
  s_nop 0
  buffer_load_dwordx4 v1, s[36:39], s31 offen offset:2048 nt lds
  s_add_u32 m0, s26, 96192
  s_nop 0
  buffer_load_dwordx4 v1, s[36:39], s31 offen offset:3072 nt lds
  s_add_u32 s31, s28, 442368
  s_add_u32 m0, s26, 101376
  s_nop 0
  buffer_load_dwordx4 v1, s[36:39], s31 offen nt lds
  s_add_u32 m0, s26, 102464
  s_nop 0
  buffer_load_dwordx4 v1, s[36:39], s31 offen offset:1024 nt lds
  s_add_u32 m0, s26, 103552
  s_nop 0
  buffer_load_dwordx4 v1, s[36:39], s31 offen offset:2048 nt lds
  s_add_u32 m0, s26, 104640
  s_nop 0
  buffer_load_dwordx4 v1, s[36:39], s31 offen offset:3072 nt lds
  s_add_u32 s31, s28, 450560
  s_add_u32 m0, s26, 109824
  s_nop 0
  buffer_load_dwordx4 v1, s[36:39], s31 offen nt lds
  s_add_u32 m0, s26, 110912
  s_nop 0
  buffer_load_dwordx4 v1, s[36:39], s31 offen offset:1024 nt lds
  s_add_u32 m0, s26, 112000
  s_nop 0
  buffer_load_dwordx4 v1, s[36:39], s31 offen offset:2048 nt lds
  s_add_u32 m0, s26, 113088
  s_nop 0
  buffer_load_dwordx4 v1, s[36:39], s31 offen offset:3072 nt lds
  s_waitcnt vmcnt(32)
  s_barrier
  s_add_u32 s31, s28, 458752
  s_add_u32 m0, s26, 118272
  s_nop 0
  buffer_load_dwordx4 v1, s[36:39], s31 offen nt lds
  s_add_u32 m0, s26, 119360
  s_nop 0
  buffer_load_dwordx4 v1, s[36:39], s31 offen offset:1024 nt lds
  s_add_u32 m0, s26, 120448
  s_nop 0
  buffer_load_dwordx4 v1, s[36:39], s31 offen offset:2048 nt lds
  s_add_u32 m0, s26, 121536
  s_nop 0
  buffer_load_dwordx4 v1, s[36:39], s31 offen offset:3072 nt lds
  s_add_u32 s31, s28, 466944
  s_add_u32 m0, s26, 126720
  s_nop 0
  buffer_load_dwordx4 v1, s[36:39], s31 offen nt lds
  s_add_u32 m0, s26, 127808
  s_nop 0
  buffer_load_dwordx4 v1, s[36:39], s31 offen offset:1024 nt lds
  s_add_u32 m0, s26, 128896
  s_nop 0
  buffer_load_dwordx4 v1, s[36:39], s31 offen offset:2048 nt lds
  s_add_u32 m0, s26, 129984
  s_nop 0
  buffer_load_dwordx4 v1, s[36:39], s31 offen offset:3072 nt lds
  s_add_u32 s31, s28, 475136
  s_add_u32 m0, s26, 0
  s_nop 0
  buffer_load_dwordx4 v1, s[36:39], s31 offen nt lds
  s_add_u32 m0, s26, 1088
  s_nop 0
  buffer_load_dwordx4 v1, s[36:39], s31 offen offset:1024 nt lds
  s_add_u32 m0, s26, 2176
  s_nop 0
  buffer_load_dwordx4 v1, s[36:39], s31 offen offset:2048 nt lds
  s_add_u32 m0, s26, 3264
  s_nop 0
  buffer_load_dwordx4 v1, s[36:39], s31 offen offset:3072 nt lds
  s_add_u32 s31, s28, 483328
  s_add_u32 m0, s26, 8448
  s_nop 0
  buffer_load_dwordx4 v1, s[36:39], s31 offen nt lds
  s_add_u32 m0, s26, 9536
  s_nop 0
  buffer_load_dwordx4 v1, s[36:39], s31 offen offset:1024 nt lds
  s_add_u32 m0, s26, 10624
  s_nop 0
  buffer_load_dwordx4 v1, s[36:39], s31 offen offset:2048 nt lds
  s_add_u32 m0, s26, 11712
  s_nop 0
  buffer_load_dwordx4 v1, s[36:39], s31 offen offset:3072 nt lds
  s_waitcnt vmcnt(32)
  s_barrier
  s_add_u32 s31, s28, 491520
  s_add_u32 m0, s26, 16896
  s_nop 0
  buffer_load_dwordx4 v1, s[36:39], s31 offen nt lds
  s_add_u32 m0, s26, 17984
  s_nop 0
  buffer_load_dwordx4 v1, s[36:39], s31 offen offset:1024 nt lds
  s_add_u32 m0, s26, 19072
  s_nop 0
  buffer_load_dwordx4 v1, s[36:39], s31 offen offset:2048 nt lds
  s_add_u32 m0, s26, 20160
  s_nop 0
  buffer_load_dwordx4 v1, s[36:39], s31 offen offset:3072 nt lds
  s_add_u32 s31, s28, 499712
  s_add_u32 m0, s26, 25344
  s_nop 0
  buffer_load_dwordx4 v1, s[36:39], s31 offen nt lds
  s_add_u32 m0, s26, 26432
  s_nop 0
  buffer_load_dwordx4 v1, s[36:39], s31 offen offset:1024 nt lds
  s_add_u32 m0, s26, 27520
  s_nop 0
  buffer_load_dwordx4 v1, s[36:39], s31 offen offset:2048 nt lds
  s_add_u32 m0, s26, 28608
  s_nop 0
  buffer_load_dwordx4 v1, s[36:39], s31 offen offset:3072 nt lds
  s_add_u32 s31, s28, 507904
  s_add_u32 m0, s26, 33792
  s_nop 0
  buffer_load_dwordx4 v1, s[36:39], s31 offen nt lds
  s_add_u32 m0, s26, 34880
  s_nop 0
  buffer_load_dwordx4 v1, s[36:39], s31 offen offset:1024 nt lds
  s_add_u32 m0, s26, 35968
  s_nop 0
  buffer_load_dwordx4 v1, s[36:39], s31 offen offset:2048 nt lds
  s_add_u32 m0, s26, 37056
  s_nop 0
  buffer_load_dwordx4 v1, s[36:39], s31 offen offset:3072 nt lds
  s_add_u32 s31, s28, 516096
  s_add_u32 m0, s26, 42240
  s_nop 0
  buffer_load_dwordx4 v1, s[36:39], s31 offen nt lds
  s_add_u32 m0, s26, 43328
  s_nop 0
  buffer_load_dwordx4 v1, s[36:39], s31 offen offset:1024 nt lds
  s_add_u32 m0, s26, 44416
  s_nop 0
  buffer_load_dwordx4 v1, s[36:39], s31 offen offset:2048 nt lds
  s_add_u32 m0, s26, 45504
  s_nop 0
  buffer_load_dwordx4 v1, s[36:39], s31 offen offset:3072 nt lds
  s_waitcnt vmcnt(32)
  s_barrier
  s_add_u32 s31, s28, 0
  s_add_u32 m0, s26, 50688
  s_nop 0
  buffer_load_dwordx4 v5, s[40:43], s31 offen nt lds
  s_add_u32 m0, s26, 51776
  s_nop 0
  buffer_load_dwordx4 v5, s[40:43], s31 offen offset:1024 nt lds
  s_add_u32 m0, s26, 52864
  s_nop 0
  buffer_load_dwordx4 v5, s[40:43], s31 offen offset:2048 nt lds
  s_add_u32 m0, s26, 53952
  s_nop 0
  buffer_load_dwordx4 v5, s[40:43], s31 offen offset:3072 nt lds
  s_add_u32 s31, s28, 32768
  s_add_u32 m0, s26, 59136
  s_nop 0
  buffer_load_dwordx4 v5, s[40:43], s31 offen nt lds
  s_add_u32 m0, s26, 60224
  s_nop 0
  buffer_load_dwordx4 v5, s[40:43], s31 offen offset:1024 nt lds
  s_add_u32 m0, s26, 61312
  s_nop 0
  buffer_load_dwordx4 v5, s[40:43], s31 offen offset:2048 nt lds
  s_add_u32 m0, s26, 62400
  s_nop 0
  buffer_load_dwordx4 v5, s[40:43], s31 offen offset:3072 nt lds
  s_add_u32 s31, s28, 65536
  s_add_u32 m0, s26, 67584
  s_nop 0
  buffer_load_dwordx4 v5, s[40:43], s31 offen nt lds
  s_add_u32 m0, s26, 68672
  s_nop 0
  buffer_load_dwordx4 v5, s[40:43], s31 offen offset:1024 nt lds
  s_add_u32 m0, s26, 69760
  s_nop 0
  buffer_load_dwordx4 v5, s[40:43], s31 offen offset:2048 nt lds
  s_add_u32 m0, s26, 70848
  s_nop 0
  buffer_load_dwordx4 v5, s[40:43], s31 offen offset:3072 nt lds
  s_add_u32 s31, s28, 98304
  s_add_u32 m0, s26, 76032
  s_nop 0
  buffer_load_dwordx4 v5, s[40:43], s31 offen nt lds
  s_add_u32 m0, s26, 77120
  s_nop 0
  buffer_load_dwordx4 v5, s[40:43], s31 offen offset:1024 nt lds
  s_add_u32 m0, s26, 78208
  s_nop 0
  buffer_load_dwordx4 v5, s[40:43], s31 offen offset:2048 nt lds
  s_add_u32 m0, s26, 79296
  s_nop 0
  buffer_load_dwordx4 v5, s[40:43], s31 offen offset:3072 nt lds
  s_waitcnt vmcnt(32)
  s_barrier
  s_add_u32 s31, s28, 131072
  s_add_u32 m0, s26, 84480
  s_nop 0
  buffer_load_dwordx4 v5, s[40:43], s31 offen nt lds
  s_add_u32 m0, s26, 85568
  s_nop 0
  buffer_load_dwordx4 v5, s[40:43], s31 offen offset:1024 nt lds
  s_add_u32 m0, s26, 86656
  s_nop 0
  buffer_load_dwordx4 v5, s[40:43], s31 offen offset:2048 nt lds
  s_add_u32 m0, s26, 87744
  s_nop 0
  buffer_load_dwordx4 v5, s[40:43], s31 offen offset:3072 nt lds
  s_add_u32 s31, s28, 163840
  s_add_u32 m0, s26, 92928
  s_nop 0
  buffer_load_dwordx4 v5, s[40:43], s31 offen nt lds
  s_add_u32 m0, s26, 94016
  s_nop 0
  buffer_load_dwordx4 v5, s[40:43], s31 offen offset:1024 nt lds
  s_add_u32 m0, s26, 95104
  s_nop 0
  buffer_load_dwordx4 v5, s[40:43], s31 offen offset:2048 nt lds
  s_add_u32 m0, s26, 96192
  s_nop 0
  buffer_load_dwordx4 v5, s[40:43], s31 offen offset:3072 nt lds
  s_add_u32 s31, s28, 196608
  s_add_u32 m0, s26, 101376
  s_nop 0
  buffer_load_dwordx4 v5, s[40:43], s31 offen nt lds
  s_add_u32 m0, s26, 102464
  s_nop 0
  buffer_load_dwordx4 v5, s[40:43], s31 offen offset:1024 nt lds
  s_add_u32 m0, s26, 103552
  s_nop 0
  buffer_load_dwordx4 v5, s[40:43], s31 offen offset:2048 nt lds
  s_add_u32 m0, s26, 104640
  s_nop 0
  buffer_load_dwordx4 v5, s[40:43], s31 offen offset:3072 nt lds
  s_add_u32 s31, s28, 229376
  s_add_u32 m0, s26, 109824
  s_nop 0
  buffer_load_dwordx4 v5, s[40:43], s31 offen nt lds
  s_add_u32 m0, s26, 110912
  s_nop 0
  buffer_load_dwordx4 v5, s[40:43], s31 offen offset:1024 nt lds
  s_add_u32 m0, s26, 112000
  s_nop 0
  buffer_load_dwordx4 v5, s[40:43], s31 offen offset:2048 nt lds
  s_add_u32 m0, s26, 113088
  s_nop 0
  buffer_load_dwordx4 v5, s[40:43], s31 offen offset:3072 nt lds
  s_waitcnt vmcnt(32)
  s_barrier
  s_add_u32 s31, s28, 262144
  s_add_u32 m0, s26, 118272
  s_nop 0
  buffer_load_dwordx4 v5, s[40:43], s31 offen nt lds
  s_add_u32 m0, s26, 119360
  s_nop 0
  buffer_load_dwordx4 v5, s[40:43], s31 offen offset:1024 nt lds
  s_add_u32 m0, s26, 120448
  s_nop 0
  buffer_load_dwordx4 v5, s[40:43], s31 offen offset:2048 nt lds
  s_add_u32 m0, s26, 121536
  s_nop 0
  buffer_load_dwordx4 v5, s[40:43], s31 offen offset:3072 nt lds
  s_add_u32 s31, s28, 294912
  s_add_u32 m0, s26, 126720
  s_nop 0
  buffer_load_dwordx4 v5, s[40:43], s31 offen nt lds
  s_add_u32 m0, s26, 127808
  s_nop 0
  buffer_load_dwordx4 v5, s[40:43], s31 offen offset:1024 nt lds
  s_add_u32 m0, s26, 128896
  s_nop 0
  buffer_load_dwordx4 v5, s[40:43], s31 offen offset:2048 nt lds
  s_add_u32 m0, s26, 129984
  s_nop 0
  buffer_load_dwordx4 v5, s[40:43], s31 offen offset:3072 nt lds
  s_add_u32 s31, s28, 327680
  s_add_u32 m0, s26, 0
  s_nop 0
  buffer_load_dwordx4 v5, s[40:43], s31 offen nt lds
  s_add_u32 m0, s26, 1088
  s_nop 0
  buffer_load_dwordx4 v5, s[40:43], s31 offen offset:1024 nt lds
  s_add_u32 m0, s26, 2176
  s_nop 0
  buffer_load_dwordx4 v5, s[40:43], s31 offen offset:2048 nt lds
  s_add_u32 m0, s26, 3264
  s_nop 0
  buffer_load_dwordx4 v5, s[40:43], s31 offen offset:3072 nt lds
  s_add_u32 s31, s28, 360448
  s_add_u32 m0, s26, 8448
  s_nop 0
  buffer_load_dwordx4 v5, s[40:43], s31 offen nt lds
  s_add_u32 m0, s26, 9536
  s_nop 0
  buffer_load_dwordx4 v5, s[40:43], s31 offen offset:1024 nt lds
  s_add_u32 m0, s26, 10624
  s_nop 0
  buffer_load_dwordx4 v5, s[40:43], s31 offen offset:2048 nt lds
  s_add_u32 m0, s26, 11712
  s_nop 0
  buffer_load_dwordx4 v5, s[40:43], s31 offen offset:3072 nt lds
  s_waitcnt vmcnt(32)
  s_barrier
  s_add_u32 s31, s28, 393216
  s_add_u32 m0, s26, 16896
  s_nop 0
  buffer_load_dwordx4 v5, s[40:43], s31 offen nt lds
  s_add_u32 m0, s26, 17984
  s_nop 0
  buffer_load_dwordx4 v5, s[40:43], s31 offen offset:1024 nt lds
  s_add_u32 m0, s26, 19072
  s_nop 0
  buffer_load_dwordx4 v5, s[40:43], s31 offen offset:2048 nt lds
  s_add_u32 m0, s26, 20160
  s_nop 0
  buffer_load_dwordx4 v5, s[40:43], s31 offen offset:3072 nt lds
  s_add_u32 s31, s28, 425984
  s_add_u32 m0, s26, 25344
  s_nop 0
  buffer_load_dwordx4 v5, s[40:43], s31 offen nt lds
  s_add_u32 m0, s26, 26432
  s_nop 0
  buffer_load_dwordx4 v5, s[40:43], s31 offen offset:1024 nt lds
  s_add_u32 m0, s26, 27520
  s_nop 0
  buffer_load_dwordx4 v5, s[40:43], s31 offen offset:2048 nt lds
  s_add_u32 m0, s26, 28608
  s_nop 0
  buffer_load_dwordx4 v5, s[40:43], s31 offen offset:3072 nt lds
  s_add_u32 s31, s28, 458752
  s_add_u32 m0, s26, 33792
  s_nop 0
  buffer_load_dwordx4 v5, s[40:43], s31 offen nt lds
  s_add_u32 m0, s26, 34880
  s_nop 0
  buffer_load_dwordx4 v5, s[40:43], s31 offen offset:1024 nt lds
  s_add_u32 m0, s26, 35968
  s_nop 0
  buffer_load_dwordx4 v5, s[40:43], s31 offen offset:2048 nt lds
  s_add_u32 m0, s26, 37056
  s_nop 0
  buffer_load_dwordx4 v5, s[40:43], s31 offen offset:3072 nt lds
  s_add_u32 s31, s28, 491520
  s_add_u32 m0, s26, 42240
  s_nop 0
  buffer_load_dwordx4 v5, s[40:43], s31 offen nt lds
  s_add_u32 m0, s26, 43328
  s_nop 0
  buffer_load_dwordx4 v5, s[40:43], s31 offen offset:1024 nt lds
  s_add_u32 m0, s26, 44416
  s_nop 0
  buffer_load_dwordx4 v5, s[40:43], s31 offen offset:2048 nt lds
  s_add_u32 m0, s26, 45504
  s_nop 0
  buffer_load_dwordx4 v5, s[40:43], s31 offen offset:3072 nt lds
  s_waitcnt vmcnt(32)
  s_barrier
  s_add_u32 s31, s28, 128
  s_add_u32 m0, s26, 50688
  s_nop 0
  buffer_load_dwordx4 v5, s[40:43], s31 offen nt lds
  s_add_u32 m0, s26, 51776
  s_nop 0
  buffer_load_dwordx4 v5, s[40:43], s31 offen offset:1024 nt lds
  s_add_u32 m0, s26, 52864
  s_nop 0
  buffer_load_dwordx4 v5, s[40:43], s31 offen offset:2048 nt lds
  s_add_u32 m0, s26, 53952
  s_nop 0
  buffer_load_dwordx4 v5, s[40:43], s31 offen offset:3072 nt lds
  s_add_u32 s31, s28, 32896
  s_add_u32 m0, s26, 59136
  s_nop 0
  buffer_load_dwordx4 v5, s[40:43], s31 offen nt lds
  s_add_u32 m0, s26, 60224
  s_nop 0
  buffer_load_dwordx4 v5, s[40:43], s31 offen offset:1024 nt lds
  s_add_u32 m0, s26, 61312
  s_nop 0
  buffer_load_dwordx4 v5, s[40:43], s31 offen offset:2048 nt lds
  s_add_u32 m0, s26, 62400
  s_nop 0
  buffer_load_dwordx4 v5, s[40:43], s31 offen offset:3072 nt lds
  s_add_u32 s31, s28, 65664
  s_add_u32 m0, s26, 67584
  s_nop 0
  buffer_load_dwordx4 v5, s[40:43], s31 offen nt lds
  s_add_u32 m0, s26, 68672
  s_nop 0
  buffer_load_dwordx4 v5, s[40:43], s31 offen offset:1024 nt lds
  s_add_u32 m0, s26, 69760
  s_nop 0
  buffer_load_dwordx4 v5, s[40:43], s31 offen offset:2048 nt lds
  s_add_u32 m0, s26, 70848
  s_nop 0
  buffer_load_dwordx4 v5, s[40:43], s31 offen offset:3072 nt lds
  s_add_u32 s31, s28, 98432
  s_add_u32 m0, s26, 76032
  s_nop 0
  buffer_load_dwordx4 v5, s[40:43], s31 offen nt lds
  s_add_u32 m0, s26, 77120
  s_nop 0
  buffer_load_dwordx4 v5, s[40:43], s31 offen offset:1024 nt lds
  s_add_u32 m0, s26, 78208
  s_nop 0
  buffer_load_dwordx4 v5, s[40:43], s31 offen offset:2048 nt lds
  s_add_u32 m0, s26, 79296
  s_nop 0
  buffer_load_dwordx4 v5, s[40:43], s31 offen offset:3072 nt lds
  s_waitcnt vmcnt(32)
  s_barrier
  s_add_u32 s31, s28, 131200
  s_add_u32 m0, s26, 84480
  s_nop 0
  buffer_load_dwordx4 v5, s[40:43], s31 offen nt lds
  s_add_u32 m0, s26, 85568
  s_nop 0
  buffer_load_dwordx4 v5, s[40:43], s31 offen offset:1024 nt lds
  s_add_u32 m0, s26, 86656
  s_nop 0
  buffer_load_dwordx4 v5, s[40:43], s31 offen offset:2048 nt lds
  s_add_u32 m0, s26, 87744
  s_nop 0
  buffer_load_dwordx4 v5, s[40:43], s31 offen offset:3072 nt lds
  s_add_u32 s31, s28, 163968
  s_add_u32 m0, s26, 92928
  s_nop 0
  buffer_load_dwordx4 v5, s[40:43], s31 offen nt lds
  s_add_u32 m0, s26, 94016
  s_nop 0
  buffer_load_dwordx4 v5, s[40:43], s31 offen offset:1024 nt lds
  s_add_u32 m0, s26, 95104
  s_nop 0
  buffer_load_dwordx4 v5, s[40:43], s31 offen offset:2048 nt lds
  s_add_u32 m0, s26, 96192
  s_nop 0
  buffer_load_dwordx4 v5, s[40:43], s31 offen offset:3072 nt lds
  s_add_u32 s31, s28, 196736
  s_add_u32 m0, s26, 101376
  s_nop 0
  buffer_load_dwordx4 v5, s[40:43], s31 offen nt lds
  s_add_u32 m0, s26, 102464
  s_nop 0
  buffer_load_dwordx4 v5, s[40:43], s31 offen offset:1024 nt lds
  s_add_u32 m0, s26, 103552
  s_nop 0
  buffer_load_dwordx4 v5, s[40:43], s31 offen offset:2048 nt lds
  s_add_u32 m0, s26, 104640
  s_nop 0
  buffer_load_dwordx4 v5, s[40:43], s31 offen offset:3072 nt lds
  s_add_u32 s31, s28, 229504
  s_add_u32 m0, s26, 109824
  s_nop 0
  buffer_load_dwordx4 v5, s[40:43], s31 offen nt lds
  s_add_u32 m0, s26, 110912
  s_nop 0
  buffer_load_dwordx4 v5, s[40:43], s31 offen offset:1024 nt lds
  s_add_u32 m0, s26, 112000
  s_nop 0
  buffer_load_dwordx4 v5, s[40:43], s31 offen offset:2048 nt lds
  s_add_u32 m0, s26, 113088
  s_nop 0
  buffer_load_dwordx4 v5, s[40:43], s31 offen offset:3072 nt lds
  s_waitcnt vmcnt(32)
  s_barrier
  s_add_u32 s31, s28, 262272
  s_add_u32 m0, s26, 118272
  s_nop 0
  buffer_load_dwordx4 v5, s[40:43], s31 offen nt lds
  s_add_u32 m0, s26, 119360
  s_nop 0
  buffer_load_dwordx4 v5, s[40:43], s31 offen offset:1024 nt lds
  s_add_u32 m0, s26, 120448
  s_nop 0
  buffer_load_dwordx4 v5, s[40:43], s31 offen offset:2048 nt lds
  s_add_u32 m0, s26, 121536
  s_nop 0
  buffer_load_dwordx4 v5, s[40:43], s31 offen offset:3072 nt lds
  s_add_u32 s31, s28, 295040
  s_add_u32 m0, s26, 126720
  s_nop 0
  buffer_load_dwordx4 v5, s[40:43], s31 offen nt lds
  s_add_u32 m0, s26, 127808
  s_nop 0
  buffer_load_dwordx4 v5, s[40:43], s31 offen offset:1024 nt lds
  s_add_u32 m0, s26, 128896
  s_nop 0
  buffer_load_dwordx4 v5, s[40:43], s31 offen offset:2048 nt lds
  s_add_u32 m0, s26, 129984
  s_nop 0
  buffer_load_dwordx4 v5, s[40:43], s31 offen offset:3072 nt lds
  s_add_u32 s31, s28, 327808
  s_add_u32 m0, s26, 0
  s_nop 0
  buffer_load_dwordx4 v5, s[40:43], s31 offen nt lds
  s_add_u32 m0, s26, 1088
  s_nop 0
  buffer_load_dwordx4 v5, s[40:43], s31 offen offset:1024 nt lds
  s_add_u32 m0, s26, 2176
  s_nop 0
  buffer_load_dwordx4 v5, s[40:43], s31 offen offset:2048 nt lds
  s_add_u32 m0, s26, 3264
  s_nop 0
  buffer_load_dwordx4 v5, s[40:43], s31 offen offset:3072 nt lds
  s_add_u32 s31, s28, 360576
  s_add_u32 m0, s26, 8448
  s_nop 0
  buffer_load_dwordx4 v5, s[40:43], s31 offen nt lds
  s_add_u32 m0, s26, 9536
  s_nop 0
  buffer_load_dwordx4 v5, s[40:43], s31 offen offset:1024 nt lds
  s_add_u32 m0, s26, 10624
  s_nop 0
  buffer_load_dwordx4 v5, s[40:43], s31 offen offset:2048 nt lds
  s_add_u32 m0, s26, 11712
  s_nop 0
  buffer_load_dwordx4 v5, s[40:43], s31 offen offset:3072 nt lds
  s_waitcnt vmcnt(32)
  s_barrier
  s_add_u32 s31, s28, 393344
  s_add_u32 m0, s26, 16896
  s_nop 0
  buffer_load_dwordx4 v5, s[40:43], s31 offen nt lds
  s_add_u32 m0, s26, 17984
  s_nop 0
  buffer_load_dwordx4 v5, s[40:43], s31 offen offset:1024 nt lds
  s_add_u32 m0, s26, 19072
  s_nop 0
  buffer_load_dwordx4 v5, s[40:43], s31 offen offset:2048 nt lds
  s_add_u32 m0, s26, 20160
  s_nop 0
  buffer_load_dwordx4 v5, s[40:43], s31 offen offset:3072 nt lds
  s_add_u32 s31, s28, 426112
  s_add_u32 m0, s26, 25344
  s_nop 0
  buffer_load_dwordx4 v5, s[40:43], s31 offen nt lds
  s_add_u32 m0, s26, 26432
  s_nop 0
  buffer_load_dwordx4 v5, s[40:43], s31 offen offset:1024 nt lds
  s_add_u32 m0, s26, 27520
  s_nop 0
  buffer_load_dwordx4 v5, s[40:43], s31 offen offset:2048 nt lds
  s_add_u32 m0, s26, 28608
  s_nop 0
  buffer_load_dwordx4 v5, s[40:43], s31 offen offset:3072 nt lds
  s_add_u32 s31, s28, 458880
  s_add_u32 m0, s26, 33792
  s_nop 0
  buffer_load_dwordx4 v5, s[40:43], s31 offen nt lds
  s_add_u32 m0, s26, 34880
  s_nop 0
  buffer_load_dwordx4 v5, s[40:43], s31 offen offset:1024 nt lds
  s_add_u32 m0, s26, 35968
  s_nop 0
  buffer_load_dwordx4 v5, s[40:43], s31 offen offset:2048 nt lds
  s_add_u32 m0, s26, 37056
  s_nop 0
  buffer_load_dwordx4 v5, s[40:43], s31 offen offset:3072 nt lds
  s_add_u32 s31, s28, 491648
  s_add_u32 m0, s26, 42240
  s_nop 0
  buffer_load_dwordx4 v5, s[40:43], s31 offen nt lds
  s_add_u32 m0, s26, 43328
  s_nop 0
  buffer_load_dwordx4 v5, s[40:43], s31 offen offset:1024 nt lds
  s_add_u32 m0, s26, 44416
  s_nop 0
  buffer_load_dwordx4 v5, s[40:43], s31 offen offset:2048 nt lds
  s_add_u32 m0, s26, 45504
  s_nop 0
  buffer_load_dwordx4 v5, s[40:43], s31 offen offset:3072 nt lds
  s_waitcnt vmcnt(32)
  s_barrier
  s_add_u32 s31, s28, 256
  s_add_u32 m0, s26, 50688
  s_nop 0
  buffer_load_dwordx4 v5, s[40:43], s31 offen nt lds
  s_add_u32 m0, s26, 51776
  s_nop 0
  buffer_load_dwordx4 v5, s[40:43], s31 offen offset:1024 nt lds
  s_add_u32 m0, s26, 52864
  s_nop 0
  buffer_load_dwordx4 v5, s[40:43], s31 offen offset:2048 nt lds
  s_add_u32 m0, s26, 53952
  s_nop 0
  buffer_load_dwordx4 v5, s[40:43], s31 offen offset:3072 nt lds
  s_add_u32 s31, s28, 33024
  s_add_u32 m0, s26, 59136
  s_nop 0
  buffer_load_dwordx4 v5, s[40:43], s31 offen nt lds
  s_add_u32 m0, s26, 60224
  s_nop 0
  buffer_load_dwordx4 v5, s[40:43], s31 offen offset:1024 nt lds
  s_add_u32 m0, s26, 61312
  s_nop 0
  buffer_load_dwordx4 v5, s[40:43], s31 offen offset:2048 nt lds
  s_add_u32 m0, s26, 62400
  s_nop 0
  buffer_load_dwordx4 v5, s[40:43], s31 offen offset:3072 nt lds
  s_add_u32 s31, s28, 65792
  s_add_u32 m0, s26, 67584
  s_nop 0
  buffer_load_dwordx4 v5, s[40:43], s31 offen nt lds
  s_add_u32 m0, s26, 68672
  s_nop 0
  buffer_load_dwordx4 v5, s[40:43], s31 offen offset:1024 nt lds
  s_add_u32 m0, s26, 69760
  s_nop 0
  buffer_load_dwordx4 v5, s[40:43], s31 offen offset:2048 nt lds
  s_add_u32 m0, s26, 70848
  s_nop 0
  buffer_load_dwordx4 v5, s[40:43], s31 offen offset:3072 nt lds
  s_add_u32 s31, s28, 98560
  s_add_u32 m0, s26, 76032
  s_nop 0
  buffer_load_dwordx4 v5, s[40:43], s31 offen nt lds
  s_add_u32 m0, s26, 77120
  s_nop 0
  buffer_load_dwordx4 v5, s[40:43], s31 offen offset:1024 nt lds
  s_add_u32 m0, s26, 78208
  s_nop 0
  buffer_load_dwordx4 v5, s[40:43], s31 offen offset:2048 nt lds
  s_add_u32 m0, s26, 79296
  s_nop 0
  buffer_load_dwordx4 v5, s[40:43], s31 offen offset:3072 nt lds
  s_waitcnt vmcnt(32)
  s_barrier
  s_add_u32 s31, s28, 131328
  s_add_u32 m0, s26, 84480
  s_nop 0
  buffer_load_dwordx4 v5, s[40:43], s31 offen nt lds
  s_add_u32 m0, s26, 85568
  s_nop 0
  buffer_load_dwordx4 v5, s[40:43], s31 offen offset:1024 nt lds
  s_add_u32 m0, s26, 86656
  s_nop 0
  buffer_load_dwordx4 v5, s[40:43], s31 offen offset:2048 nt lds
  s_add_u32 m0, s26, 87744
  s_nop 0
  buffer_load_dwordx4 v5, s[40:43], s31 offen offset:3072 nt lds
  s_add_u32 s31, s28, 164096
  s_add_u32 m0, s26, 92928
  s_nop 0
  buffer_load_dwordx4 v5, s[40:43], s31 offen nt lds
  s_add_u32 m0, s26, 94016
  s_nop 0
  buffer_load_dwordx4 v5, s[40:43], s31 offen offset:1024 nt lds
  s_add_u32 m0, s26, 95104
  s_nop 0
  buffer_load_dwordx4 v5, s[40:43], s31 offen offset:2048 nt lds
  s_add_u32 m0, s26, 96192
  s_nop 0
  buffer_load_dwordx4 v5, s[40:43], s31 offen offset:3072 nt lds
  s_add_u32 s31, s28, 196864
  s_add_u32 m0, s26, 101376
  s_nop 0
  buffer_load_dwordx4 v5, s[40:43], s31 offen nt lds
  s_add_u32 m0, s26, 102464
  s_nop 0
  buffer_load_dwordx4 v5, s[40:43], s31 offen offset:1024 nt lds
  s_add_u32 m0, s26, 103552
  s_nop 0
  buffer_load_dwordx4 v5, s[40:43], s31 offen offset:2048 nt lds
  s_add_u32 m0, s26, 104640
  s_nop 0
  buffer_load_dwordx4 v5, s[40:43], s31 offen offset:3072 nt lds
  s_add_u32 s31, s28, 229632
  s_add_u32 m0, s26, 109824
  s_nop 0
  buffer_load_dwordx4 v5, s[40:43], s31 offen nt lds
  s_add_u32 m0, s26, 110912
  s_nop 0
  buffer_load_dwordx4 v5, s[40:43], s31 offen offset:1024 nt lds
  s_add_u32 m0, s26, 112000
  s_nop 0
  buffer_load_dwordx4 v5, s[40:43], s31 offen offset:2048 nt lds
  s_add_u32 m0, s26, 113088
  s_nop 0
  buffer_load_dwordx4 v5, s[40:43], s31 offen offset:3072 nt lds
  s_waitcnt vmcnt(32)
  s_barrier
  s_add_u32 s31, s28, 262400
  s_add_u32 m0, s26, 118272
  s_nop 0
  buffer_load_dwordx4 v5, s[40:43], s31 offen nt lds
  s_add_u32 m0, s26, 119360
  s_nop 0
  buffer_load_dwordx4 v5, s[40:43], s31 offen offset:1024 nt lds
  s_add_u32 m0, s26, 120448
  s_nop 0
  buffer_load_dwordx4 v5, s[40:43], s31 offen offset:2048 nt lds
  s_add_u32 m0, s26, 121536
  s_nop 0
  buffer_load_dwordx4 v5, s[40:43], s31 offen offset:3072 nt lds
  s_add_u32 s31, s28, 295168
  s_add_u32 m0, s26, 126720
  s_nop 0
  buffer_load_dwordx4 v5, s[40:43], s31 offen nt lds
  s_add_u32 m0, s26, 127808
  s_nop 0
  buffer_load_dwordx4 v5, s[40:43], s31 offen offset:1024 nt lds
  s_add_u32 m0, s26, 128896
  s_nop 0
  buffer_load_dwordx4 v5, s[40:43], s31 offen offset:2048 nt lds
  s_add_u32 m0, s26, 129984
  s_nop 0
  buffer_load_dwordx4 v5, s[40:43], s31 offen offset:3072 nt lds
  s_add_u32 s31, s28, 327936
  s_add_u32 m0, s26, 0
  s_nop 0
  buffer_load_dwordx4 v5, s[40:43], s31 offen nt lds
  s_add_u32 m0, s26, 1088
  s_nop 0
  buffer_load_dwordx4 v5, s[40:43], s31 offen offset:1024 nt lds
  s_add_u32 m0, s26, 2176
  s_nop 0
  buffer_load_dwordx4 v5, s[40:43], s31 offen offset:2048 nt lds
  s_add_u32 m0, s26, 3264
  s_nop 0
  buffer_load_dwordx4 v5, s[40:43], s31 offen offset:3072 nt lds
  s_add_u32 s31, s28, 360704
  s_add_u32 m0, s26, 8448
  s_nop 0
  buffer_load_dwordx4 v5, s[40:43], s31 offen nt lds
  s_add_u32 m0, s26, 9536
  s_nop 0
  buffer_load_dwordx4 v5, s[40:43], s31 offen offset:1024 nt lds
  s_add_u32 m0, s26, 10624
  s_nop 0
  buffer_load_dwordx4 v5, s[40:43], s31 offen offset:2048 nt lds
  s_add_u32 m0, s26, 11712
  s_nop 0
  buffer_load_dwordx4 v5, s[40:43], s31 offen offset:3072 nt lds
  s_waitcnt vmcnt(32)
  s_barrier
  s_add_u32 s31, s28, 393472
  s_add_u32 m0, s26, 16896
  s_nop 0
  buffer_load_dwordx4 v5, s[40:43], s31 offen nt lds
  s_add_u32 m0, s26, 17984
  s_nop 0
  buffer_load_dwordx4 v5, s[40:43], s31 offen offset:1024 nt lds
  s_add_u32 m0, s26, 19072
  s_nop 0
  buffer_load_dwordx4 v5, s[40:43], s31 offen offset:2048 nt lds
  s_add_u32 m0, s26, 20160
  s_nop 0
  buffer_load_dwordx4 v5, s[40:43], s31 offen offset:3072 nt lds
  s_add_u32 s31, s28, 426240
  s_add_u32 m0, s26, 25344
  s_nop 0
  buffer_load_dwordx4 v5, s[40:43], s31 offen nt lds
  s_add_u32 m0, s26, 26432
  s_nop 0
  buffer_load_dwordx4 v5, s[40:43], s31 offen offset:1024 nt lds
  s_add_u32 m0, s26, 27520
  s_nop 0
  buffer_load_dwordx4 v5, s[40:43], s31 offen offset:2048 nt lds
  s_add_u32 m0, s26, 28608
  s_nop 0
  buffer_load_dwordx4 v5, s[40:43], s31 offen offset:3072 nt lds
  s_add_u32 s31, s28, 459008
  s_add_u32 m0, s26, 33792
  s_nop 0
  buffer_load_dwordx4 v5, s[40:43], s31 offen nt lds
  s_add_u32 m0, s26, 34880
  s_nop 0
  buffer_load_dwordx4 v5, s[40:43], s31 offen offset:1024 nt lds
  s_add_u32 m0, s26, 35968
  s_nop 0
  buffer_load_dwordx4 v5, s[40:43], s31 offen offset:2048 nt lds
  s_add_u32 m0, s26, 37056
  s_nop 0
  buffer_load_dwordx4 v5, s[40:43], s31 offen offset:3072 nt lds
  s_add_u32 s31, s28, 491776
  s_add_u32 m0, s26, 42240
  s_nop 0
  buffer_load_dwordx4 v5, s[40:43], s31 offen nt lds
  s_add_u32 m0, s26, 43328
  s_nop 0
  buffer_load_dwordx4 v5, s[40:43], s31 offen offset:1024 nt lds
  s_add_u32 m0, s26, 44416
  s_nop 0
  buffer_load_dwordx4 v5, s[40:43], s31 offen offset:2048 nt lds
  s_add_u32 m0, s26, 45504
  s_nop 0
  buffer_load_dwordx4 v5, s[40:43], s31 offen offset:3072 nt lds
  s_waitcnt vmcnt(32)
  s_barrier
  s_add_u32 s31, s28, 384
  s_add_u32 m0, s26, 50688
  s_nop 0
  buffer_load_dwordx4 v5, s[40:43], s31 offen nt lds
  s_add_u32 m0, s26, 51776
  s_nop 0
  buffer_load_dwordx4 v5, s[40:43], s31 offen offset:1024 nt lds
  s_add_u32 m0, s26, 52864
  s_nop 0
  buffer_load_dwordx4 v5, s[40:43], s31 offen offset:2048 nt lds
  s_add_u32 m0, s26, 53952
  s_nop 0
  buffer_load_dwordx4 v5, s[40:43], s31 offen offset:3072 nt lds
  s_add_u32 s31, s28, 33152
  s_add_u32 m0, s26, 59136
  s_nop 0
  buffer_load_dwordx4 v5, s[40:43], s31 offen nt lds
  s_add_u32 m0, s26, 60224
  s_nop 0
  buffer_load_dwordx4 v5, s[40:43], s31 offen offset:1024 nt lds
  s_add_u32 m0, s26, 61312
  s_nop 0
  buffer_load_dwordx4 v5, s[40:43], s31 offen offset:2048 nt lds
  s_add_u32 m0, s26, 62400
  s_nop 0
  buffer_load_dwordx4 v5, s[40:43], s31 offen offset:3072 nt lds
  s_add_u32 s31, s28, 65920
  s_add_u32 m0, s26, 67584
  s_nop 0
  buffer_load_dwordx4 v5, s[40:43], s31 offen nt lds
  s_add_u32 m0, s26, 68672
  s_nop 0
  buffer_load_dwordx4 v5, s[40:43], s31 offen offset:1024 nt lds
  s_add_u32 m0, s26, 69760
  s_nop 0
  buffer_load_dwordx4 v5, s[40:43], s31 offen offset:2048 nt lds
  s_add_u32 m0, s26, 70848
  s_nop 0
  buffer_load_dwordx4 v5, s[40:43], s31 offen offset:3072 nt lds
  s_add_u32 s31, s28, 98688
  s_add_u32 m0, s26, 76032
  s_nop 0
  buffer_load_dwordx4 v5, s[40:43], s31 offen nt lds
  s_add_u32 m0, s26, 77120
  s_nop 0
  buffer_load_dwordx4 v5, s[40:43], s31 offen offset:1024 nt lds
  s_add_u32 m0, s26, 78208
  s_nop 0
  buffer_load_dwordx4 v5, s[40:43], s31 offen offset:2048 nt lds
  s_add_u32 m0, s26, 79296
  s_nop 0
  buffer_load_dwordx4 v5, s[40:43], s31 offen offset:3072 nt lds
  s_waitcnt vmcnt(32)
  s_barrier
  s_add_u32 s31, s28, 131456
  s_add_u32 m0, s26, 84480
  s_nop 0
  buffer_load_dwordx4 v5, s[40:43], s31 offen nt lds
  s_add_u32 m0, s26, 85568
  s_nop 0
  buffer_load_dwordx4 v5, s[40:43], s31 offen offset:1024 nt lds
  s_add_u32 m0, s26, 86656
  s_nop 0
  buffer_load_dwordx4 v5, s[40:43], s31 offen offset:2048 nt lds
  s_add_u32 m0, s26, 87744
  s_nop 0
  buffer_load_dwordx4 v5, s[40:43], s31 offen offset:3072 nt lds
  s_add_u32 s31, s28, 164224
  s_add_u32 m0, s26, 92928
  s_nop 0
  buffer_load_dwordx4 v5, s[40:43], s31 offen nt lds
  s_add_u32 m0, s26, 94016
  s_nop 0
  buffer_load_dwordx4 v5, s[40:43], s31 offen offset:1024 nt lds
  s_add_u32 m0, s26, 95104
  s_nop 0
  buffer_load_dwordx4 v5, s[40:43], s31 offen offset:2048 nt lds
  s_add_u32 m0, s26, 96192
  s_nop 0
  buffer_load_dwordx4 v5, s[40:43], s31 offen offset:3072 nt lds
  s_add_u32 s31, s28, 196992
  s_add_u32 m0, s26, 101376
  s_nop 0
  buffer_load_dwordx4 v5, s[40:43], s31 offen nt lds
  s_add_u32 m0, s26, 102464
  s_nop 0
  buffer_load_dwordx4 v5, s[40:43], s31 offen offset:1024 nt lds
  s_add_u32 m0, s26, 103552
  s_nop 0
  buffer_load_dwordx4 v5, s[40:43], s31 offen offset:2048 nt lds
  s_add_u32 m0, s26, 104640
  s_nop 0
  buffer_load_dwordx4 v5, s[40:43], s31 offen offset:3072 nt lds
  s_add_u32 s31, s28, 229760
  s_add_u32 m0, s26, 109824
  s_nop 0
  buffer_load_dwordx4 v5, s[40:43], s31 offen nt lds
  s_add_u32 m0, s26, 110912
  s_nop 0
  buffer_load_dwordx4 v5, s[40:43], s31 offen offset:1024 nt lds
  s_add_u32 m0, s26, 112000
  s_nop 0
  buffer_load_dwordx4 v5, s[40:43], s31 offen offset:2048 nt lds
  s_add_u32 m0, s26, 113088
  s_nop 0
  buffer_load_dwordx4 v5, s[40:43], s31 offen offset:3072 nt lds
  s_waitcnt vmcnt(32)
  s_barrier
  s_add_u32 s31, s28, 262528
  s_add_u32 m0, s26, 118272
  s_nop 0
  buffer_load_dwordx4 v5, s[40:43], s31 offen nt lds
  s_add_u32 m0, s26, 119360
  s_nop 0
  buffer_load_dwordx4 v5, s[40:43], s31 offen offset:1024 nt lds
  s_add_u32 m0, s26, 120448
  s_nop 0
  buffer_load_dwordx4 v5, s[40:43], s31 offen offset:2048 nt lds
  s_add_u32 m0, s26, 121536
  s_nop 0
  buffer_load_dwordx4 v5, s[40:43], s31 offen offset:3072 nt lds
  s_add_u32 s31, s28, 295296
  s_add_u32 m0, s26, 126720
  s_nop 0
  buffer_load_dwordx4 v5, s[40:43], s31 offen nt lds
  s_add_u32 m0, s26, 127808
  s_nop 0
  buffer_load_dwordx4 v5, s[40:43], s31 offen offset:1024 nt lds
  s_add_u32 m0, s26, 128896
  s_nop 0
  buffer_load_dwordx4 v5, s[40:43], s31 offen offset:2048 nt lds
  s_add_u32 m0, s26, 129984
  s_nop 0
  buffer_load_dwordx4 v5, s[40:43], s31 offen offset:3072 nt lds
  s_add_u32 s31, s28, 328064
  s_add_u32 m0, s26, 0
  s_nop 0
  buffer_load_dwordx4 v5, s[40:43], s31 offen nt lds
  s_add_u32 m0, s26, 1088
  s_nop 0
  buffer_load_dwordx4 v5, s[40:43], s31 offen offset:1024 nt lds
  s_add_u32 m0, s26, 2176
  s_nop 0
  buffer_load_dwordx4 v5, s[40:43], s31 offen offset:2048 nt lds
  s_add_u32 m0, s26, 3264
  s_nop 0
  buffer_load_dwordx4 v5, s[40:43], s31 offen offset:3072 nt lds
  s_add_u32 s31, s28, 360832
  s_add_u32 m0, s26, 8448
  s_nop 0
  buffer_load_dwordx4 v5, s[40:43], s31 offen nt lds
  s_add_u32 m0, s26, 9536
  s_nop 0
  buffer_load_dwordx4 v5, s[40:43], s31 offen offset:1024 nt lds
  s_add_u32 m0, s26, 10624
  s_nop 0
  buffer_load_dwordx4 v5, s[40:43], s31 offen offset:2048 nt lds
  s_add_u32 m0, s26, 11712
  s_nop 0
  buffer_load_dwordx4 v5, s[40:43], s31 offen offset:3072 nt lds
  s_waitcnt vmcnt(32)
  s_barrier
  s_add_u32 s31, s28, 393600
  s_add_u32 m0, s26, 16896
  s_nop 0
  buffer_load_dwordx4 v5, s[40:43], s31 offen nt lds
  s_add_u32 m0, s26, 17984
  s_nop 0
  buffer_load_dwordx4 v5, s[40:43], s31 offen offset:1024 nt lds
  s_add_u32 m0, s26, 19072
  s_nop 0
  buffer_load_dwordx4 v5, s[40:43], s31 offen offset:2048 nt lds
  s_add_u32 m0, s26, 20160
  s_nop 0
  buffer_load_dwordx4 v5, s[40:43], s31 offen offset:3072 nt lds
  s_add_u32 s31, s28, 426368
  s_add_u32 m0, s26, 25344
  s_nop 0
  buffer_load_dwordx4 v5, s[40:43], s31 offen nt lds
  s_add_u32 m0, s26, 26432
  s_nop 0
  buffer_load_dwordx4 v5, s[40:43], s31 offen offset:1024 nt lds
  s_add_u32 m0, s26, 27520
  s_nop 0
  buffer_load_dwordx4 v5, s[40:43], s31 offen offset:2048 nt lds
  s_add_u32 m0, s26, 28608
  s_nop 0
  buffer_load_dwordx4 v5, s[40:43], s31 offen offset:3072 nt lds
  s_add_u32 s31, s28, 459136
  s_add_u32 m0, s26, 33792
  s_nop 0
  buffer_load_dwordx4 v5, s[40:43], s31 offen nt lds
  s_add_u32 m0, s26, 34880
  s_nop 0
  buffer_load_dwordx4 v5, s[40:43], s31 offen offset:1024 nt lds
  s_add_u32 m0, s26, 35968
  s_nop 0
  buffer_load_dwordx4 v5, s[40:43], s31 offen offset:2048 nt lds
  s_add_u32 m0, s26, 37056
  s_nop 0
  buffer_load_dwordx4 v5, s[40:43], s31 offen offset:3072 nt lds
  s_add_u32 s31, s28, 491904
  s_add_u32 m0, s26, 42240
  s_nop 0
  buffer_load_dwordx4 v5, s[40:43], s31 offen nt lds
  s_add_u32 m0, s26, 43328
  s_nop 0
  buffer_load_dwordx4 v5, s[40:43], s31 offen offset:1024 nt lds
  s_add_u32 m0, s26, 44416
  s_nop 0
  buffer_load_dwordx4 v5, s[40:43], s31 offen offset:2048 nt lds
  s_add_u32 m0, s26, 45504
  s_nop 0
  buffer_load_dwordx4 v5, s[40:43], s31 offen offset:3072 nt lds
  s_waitcnt vmcnt(32)
  s_barrier
  s_mov_b32 exec_hi, 0x00ffffff
  s_add_u32 s31, s50, 0
  s_add_u32 m0, s49, 50688
  s_nop 0
  buffer_load_dwordx4 v4, s[44:47], s31 offen lds
  s_add_u32 m0, s49, 50752
  s_nop 0
  buffer_load_dwordx4 v4, s[44:47], s31 offen offset:1792 lds
  s_add_u32 s31, s50, 3584
  s_add_u32 m0, s49, 54400
  s_nop 0
  buffer_load_dwordx4 v4, s[44:47], s31 offen lds
  s_add_u32 m0, s49, 54464
  s_nop 0
  buffer_load_dwordx4 v4, s[44:47], s31 offen offset:1792 lds
  s_add_u32 s31, s50, 7168
  s_add_u32 m0, s49, 58112
  s_nop 0
  buffer_load_dwordx4 v4, s[44:47], s31 offen lds
  s_add_u32 m0, s49, 58176
  s_nop 0
  buffer_load_dwordx4 v4, s[44:47], s31 offen offset:1792 lds
  s_add_u32 s31, s50, 10752
  s_add_u32 m0, s49, 61824
  s_nop 0
  buffer_load_dwordx4 v4, s[44:47], s31 offen lds
  s_add_u32 m0, s49, 61888
  s_nop 0
  buffer_load_dwordx4 v4, s[44:47], s31 offen offset:1792 lds
  s_add_u32 s31, s50, 14336
  s_add_u32 m0, s49, 65536
  s_nop 0
  buffer_load_dwordx4 v4, s[44:47], s31 offen lds
  s_add_u32 m0, s49, 65600
  s_nop 0
  buffer_load_dwordx4 v4, s[44:47], s31 offen offset:1792 lds
  s_add_u32 s31, s50, 17920
  s_add_u32 m0, s49, 69248
  s_nop 0
  buffer_load_dwordx4 v4, s[44:47], s31 offen lds
  s_add_u32 m0, s49, 69312
  s_nop 0
  buffer_load_dwordx4 v4, s[44:47], s31 offen offset:1792 lds
  s_add_u32 s31, s50, 21504
  s_add_u32 m0, s49, 72960
  s_nop 0
  buffer_load_dwordx4 v4, s[44:47], s31 offen lds
  s_add_u32 m0, s49, 73024
  s_nop 0
  buffer_load_dwordx4 v4, s[44:47], s31 offen offset:1792 lds
  s_add_u32 s31, s50, 25088
  s_add_u32 m0, s49, 76672
  s_nop 0
  buffer_load_dwordx4 v4, s[44:47], s31 offen lds
  s_add_u32 m0, s49, 76736
  s_nop 0
  buffer_load_dwordx4 v4, s[44:47], s31 offen offset:1792 lds
  s_waitcnt vmcnt(32)
  s_barrier
  s_waitcnt vmcnt(16)
  s_barrier
  s_add_u32 s31, s50, 28672
  s_add_u32 m0, s49, 121344
  s_nop 0
  buffer_load_dwordx4 v4, s[44:47], s31 offen lds
  s_add_u32 m0, s49, 121408
  s_nop 0
  buffer_load_dwordx4 v4, s[44:47], s31 offen offset:1792 lds
  s_add_u32 s31, s50, 32256
  s_add_u32 m0, s49, 125056
  s_nop 0
  buffer_load_dwordx4 v4, s[44:47], s31 offen lds
  s_add_u32 m0, s49, 125120
  s_nop 0
  buffer_load_dwordx4 v4, s[44:47], s31 offen offset:1792 lds
  s_add_u32 s31, s50, 35840
  s_add_u32 m0, s49, 128768
  s_nop 0
  buffer_load_dwordx4 v4, s[44:47], s31 offen lds
  s_add_u32 m0, s49, 128832
  s_nop 0
  buffer_load_dwordx4 v4, s[44:47], s31 offen offset:1792 lds
  s_add_u32 s31, s50, 39424
  s_add_u32 m0, s49, 132480
  s_nop 0
  buffer_load_dwordx4 v4, s[44:47], s31 offen lds
  s_add_u32 m0, s49, 132544
  s_nop 0
  buffer_load_dwordx4 v4, s[44:47], s31 offen offset:1792 lds
  s_add_u32 s31, s50, 43008
  s_add_u32 m0, s49, 0
  s_nop 0
  buffer_load_dwordx4 v4, s[44:47], s31 offen lds
  s_add_u32 m0, s49, 64
  s_nop 0
  buffer_load_dwordx4 v4, s[44:47], s31 offen offset:1792 lds
  s_add_u32 s31, s50, 46592
  s_add_u32 m0, s49, 3712
  s_nop 0
  buffer_load_dwordx4 v4, s[44:47], s31 offen lds
  s_add_u32 m0, s49, 3776
  s_nop 0
  buffer_load_dwordx4 v4, s[44:47], s31 offen offset:1792 lds
  s_add_u32 s31, s50, 50176
  s_add_u32 m0, s49, 7424
  s_nop 0
  buffer_load_dwordx4 v4, s[44:47], s31 offen lds
  s_add_u32 m0, s49, 7488
  s_nop 0
  buffer_load_dwordx4 v4, s[44:47], s31 offen offset:1792 lds
  s_add_u32 s31, s50, 53760
  s_add_u32 m0, s49, 11136
  s_nop 0
  buffer_load_dwordx4 v4, s[44:47], s31 offen lds
  s_add_u32 m0, s49, 11200
  s_nop 0
  buffer_load_dwordx4 v4, s[44:47], s31 offen offset:1792 lds
  s_barrier
  s_add_u32 s31, s50, 57344
  s_add_u32 m0, s49, 14848
  s_nop 0
  buffer_load_dwordx4 v4, s[44:47], s31 offen lds
  s_add_u32 m0, s49, 14912
  s_nop 0
  buffer_load_dwordx4 v4, s[44:47], s31 offen offset:1792 lds
  s_add_u32 s31, s50, 60928
  s_add_u32 m0, s49, 18560
  s_nop 0
  buffer_load_dwordx4 v4, s[44:47], s31 offen lds
  s_add_u32 m0, s49, 18624
  s_nop 0
  buffer_load_dwordx4 v4, s[44:47], s31 offen offset:1792 lds
  s_add_u32 s31, s50, 64512
  s_add_u32 m0, s49, 22272
  s_nop 0
  buffer_load_dwordx4 v4, s[44:47], s31 offen lds
  s_add_u32 m0, s49, 22336
  s_nop 0
  buffer_load_dwordx4 v4, s[44:47], s31 offen offset:1792 lds
  s_add_u32 s31, s50, 68096
  s_add_u32 m0, s49, 25984
  s_nop 0
  buffer_load_dwordx4 v4, s[44:47], s31 offen lds
  s_add_u32 m0, s49, 26048
  s_nop 0
  buffer_load_dwordx4 v4, s[44:47], s31 offen offset:1792 lds
  s_add_u32 s31, s50, 71680
  s_add_u32 m0, s49, 29696
  s_nop 0
  buffer_load_dwordx4 v4, s[44:47], s31 offen lds
  s_add_u32 m0, s49, 29760
  s_nop 0
  buffer_load_dwordx4 v4, s[44:47], s31 offen offset:1792 lds
  s_add_u32 s31, s50, 75264
  s_add_u32 m0, s49, 33408
  s_nop 0
  buffer_load_dwordx4 v4, s[44:47], s31 offen lds
  s_add_u32 m0, s49, 33472
  s_nop 0
  buffer_load_dwordx4 v4, s[44:47], s31 offen offset:1792 lds
  s_add_u32 s31, s50, 78848
  s_add_u32 m0, s49, 37120
  s_nop 0
  buffer_load_dwordx4 v4, s[44:47], s31 offen lds
  s_add_u32 m0, s49, 37184
  s_nop 0
  buffer_load_dwordx4 v4, s[44:47], s31 offen offset:1792 lds
  s_add_u32 s31, s50, 82432
  s_add_u32 m0, s49, 40832
  s_nop 0
  buffer_load_dwordx4 v4, s[44:47], s31 offen lds
  s_add_u32 m0, s49, 40896
  s_nop 0
  buffer_load_dwordx4 v4, s[44:47], s31 offen offset:1792 lds
  s_waitcnt vmcnt(32)
  s_barrier
  s_waitcnt vmcnt(16)
  s_barrier
  s_add_u32 s31, s50, 86016
  s_add_u32 m0, s49, 44544
  s_nop 0
  buffer_load_dwordx4 v4, s[44:47], s31 offen lds
  s_add_u32 m0, s49, 44608
  s_nop 0
  buffer_load_dwordx4 v4, s[44:47], s31 offen offset:1792 lds
  s_add_u32 s31, s50, 89600
  s_add_u32 m0, s49, 48256
  s_nop 0
  buffer_load_dwordx4 v4, s[44:47], s31 offen lds
  s_add_u32 m0, s49, 48320
  s_nop 0
  buffer_load_dwordx4 v4, s[44:47], s31 offen offset:1792 lds
  s_add_u32 s31, s50, 93184
  s_add_u32 m0, s49, 51968
  s_nop 0
  buffer_load_dwordx4 v4, s[44:47], s31 offen lds
  s_add_u32 m0, s49, 52032
  s_nop 0
  buffer_load_dwordx4 v4, s[44:47], s31 offen offset:1792 lds
  s_add_u32 s31, s50, 96768
  s_add_u32 m0, s49, 55680
  s_nop 0
  buffer_load_dwordx4 v4, s[44:47], s31 offen lds
  s_add_u32 m0, s49, 55744
  s_nop 0
  buffer_load_dwordx4 v4, s[44:47], s31 offen offset:1792 lds
  s_add_u32 s31, s50, 100352
  s_add_u32 m0, s49, 59392
  s_nop 0
  buffer_load_dwordx4 v4, s[44:47], s31 offen lds
  s_add_u32 m0, s49, 59456
  s_nop 0
  buffer_load_dwordx4 v4, s[44:47], s31 offen offset:1792 lds
  s_add_u32 s31, s50, 103936
  s_add_u32 m0, s49, 63104
  s_nop 0
  buffer_load_dwordx4 v4, s[44:47], s31 offen lds
  s_add_u32 m0, s49, 63168
  s_nop 0
  buffer_load_dwordx4 v4, s[44:47], s31 offen offset:1792 lds
  s_add_u32 s31, s50, 107520
  s_add_u32 m0, s49, 66816
  s_nop 0
  buffer_load_dwordx4 v4, s[44:47], s31 offen lds
  s_add_u32 m0, s49, 66880
  s_nop 0
  buffer_load_dwordx4 v4, s[44:47], s31 offen offset:1792 lds
  s_add_u32 s31, s50, 111104
  s_add_u32 m0, s49, 70528
  s_nop 0
  buffer_load_dwordx4 v4, s[44:47], s31 offen lds
  s_add_u32 m0, s49, 70592
  s_nop 0
  buffer_load_dwordx4 v4, s[44:47], s31 offen offset:1792 lds
  s_waitcnt vmcnt(16)
  s_barrier
  s_add_u32 s31, s50, 114688
  s_add_u32 m0, s49, 121344
  s_nop 0
  buffer_load_dwordx4 v4, s[44:47], s31 offen lds
  s_add_u32 m0, s49, 121408
  s_nop 0
  buffer_load_dwordx4 v4, s[44:47], s31 offen offset:1792 lds
  s_add_u32 s31, s50, 118272
  s_add_u32 m0, s49, 125056
  s_nop 0
  buffer_load_dwordx4 v4, s[44:47], s31 offen lds
  s_add_u32 m0, s49, 125120
  s_nop 0
  buffer_load_dwordx4 v4, s[44:47], s31 offen offset:1792 lds
  s_add_u32 s31, s50, 121856
  s_add_u32 m0, s49, 128768
  s_nop 0
  buffer_load_dwordx4 v4, s[44:47], s31 offen lds
  s_add_u32 m0, s49, 128832
  s_nop 0
  buffer_load_dwordx4 v4, s[44:47], s31 offen offset:1792 lds
  s_add_u32 s31, s50, 125440
  s_add_u32 m0, s49, 132480
  s_nop 0
  buffer_load_dwordx4 v4, s[44:47], s31 offen lds
  s_add_u32 m0, s49, 132544
  s_nop 0
  buffer_load_dwordx4 v4, s[44:47], s31 offen offset:1792 lds
  s_add_u32 s31, s50, 129024
  s_add_u32 m0, s49, 0
  s_nop 0
  buffer_load_dwordx4 v4, s[44:47], s31 offen lds
  s_add_u32 m0, s49, 64
  s_nop 0
  buffer_load_dwordx4 v4, s[44:47], s31 offen offset:1792 lds
  s_add_u32 s31, s50, 132608
  s_add_u32 m0, s49, 3712
  s_nop 0
  buffer_load_dwordx4 v4, s[44:47], s31 offen lds
  s_add_u32 m0, s49, 3776
  s_nop 0
  buffer_load_dwordx4 v4, s[44:47], s31 offen offset:1792 lds
  s_add_u32 s31, s50, 136192
  s_add_u32 m0, s49, 7424
  s_nop 0
  buffer_load_dwordx4 v4, s[44:47], s31 offen lds
  s_add_u32 m0, s49, 7488
  s_nop 0
  buffer_load_dwordx4 v4, s[44:47], s31 offen offset:1792 lds
  s_add_u32 s31, s50, 139776
  s_add_u32 m0, s49, 11136
  s_nop 0
  buffer_load_dwordx4 v4, s[44:47], s31 offen lds
  s_add_u32 m0, s49, 11200
  s_nop 0
  buffer_load_dwordx4 v4, s[44:47], s31 offen offset:1792 lds
  s_waitcnt vmcnt(16)
  s_barrier
  s_add_u32 s31, s50, 143360
  s_add_u32 m0, s49, 14848
  s_nop 0
  buffer_load_dwordx4 v4, s[44:47], s31 offen lds
  s_add_u32 m0, s49, 14912
  s_nop 0
  buffer_load_dwordx4 v4, s[44:47], s31 offen offset:1792 lds
  s_add_u32 s31, s50, 146944
  s_add_u32 m0, s49, 18560
  s_nop 0
  buffer_load_dwordx4 v4, s[44:47], s31 offen lds
  s_add_u32 m0, s49, 18624
  s_nop 0
  buffer_load_dwordx4 v4, s[44:47], s31 offen offset:1792 lds
  s_add_u32 s31, s50, 150528
  s_add_u32 m0, s49, 22272
  s_nop 0
  buffer_load_dwordx4 v4, s[44:47], s31 offen lds
  s_add_u32 m0, s49, 22336
  s_nop 0
  buffer_load_dwordx4 v4, s[44:47], s31 offen offset:1792 lds
  s_add_u32 s31, s50, 154112
  s_add_u32 m0, s49, 25984
  s_nop 0
  buffer_load_dwordx4 v4, s[44:47], s31 offen lds
  s_add_u32 m0, s49, 26048
  s_nop 0
  buffer_load_dwordx4 v4, s[44:47], s31 offen offset:1792 lds
  s_add_u32 s31, s50, 157696
  s_add_u32 m0, s49, 29696
  s_nop 0
  buffer_load_dwordx4 v4, s[44:47], s31 offen lds
  s_add_u32 m0, s49, 29760
  s_nop 0
  buffer_load_dwordx4 v4, s[44:47], s31 offen offset:1792 lds
  s_add_u32 s31, s50, 161280
  s_add_u32 m0, s49, 33408
  s_nop 0
  buffer_load_dwordx4 v4, s[44:47], s31 offen lds
  s_add_u32 m0, s49, 33472
  s_nop 0
  buffer_load_dwordx4 v4, s[44:47], s31 offen offset:1792 lds
  s_add_u32 s31, s50, 164864
  s_add_u32 m0, s49, 37120
  s_nop 0
  buffer_load_dwordx4 v4, s[44:47], s31 offen lds
  s_add_u32 m0, s49, 37184
  s_nop 0
  buffer_load_dwordx4 v4, s[44:47], s31 offen offset:1792 lds
  s_add_u32 s31, s50, 168448
  s_add_u32 m0, s49, 40832
  s_nop 0
  buffer_load_dwordx4 v4, s[44:47], s31 offen lds
  s_add_u32 m0, s49, 40896
  s_nop 0
  buffer_load_dwordx4 v4, s[44:47], s31 offen offset:1792 lds
  s_waitcnt vmcnt(16)
  s_barrier
  s_add_u32 s31, s50, 172032
  s_add_u32 m0, s49, 44544
  s_nop 0
  buffer_load_dwordx4 v4, s[44:47], s31 offen lds
  s_add_u32 m0, s49, 44608
  s_nop 0
  buffer_load_dwordx4 v4, s[44:47], s31 offen offset:1792 lds
  s_add_u32 s31, s50, 175616
  s_add_u32 m0, s49, 48256
  s_nop 0
  buffer_load_dwordx4 v4, s[44:47], s31 offen lds
  s_add_u32 m0, s49, 48320
  s_nop 0
  buffer_load_dwordx4 v4, s[44:47], s31 offen offset:1792 lds
  s_add_u32 s31, s50, 179200
  s_add_u32 m0, s49, 51968
  s_nop 0
  buffer_load_dwordx4 v4, s[44:47], s31 offen lds
  s_add_u32 m0, s49, 52032
  s_nop 0
  buffer_load_dwordx4 v4, s[44:47], s31 offen offset:1792 lds
  s_add_u32 s31, s50, 182784
  s_add_u32 m0, s49, 55680
  s_nop 0
  buffer_load_dwordx4 v4, s[44:47], s31 offen lds
  s_add_u32 m0, s49, 55744
  s_nop 0
  buffer_load_dwordx4 v4, s[44:47], s31 offen offset:1792 lds
  s_add_u32 s31, s50, 186368
  s_add_u32 m0, s49, 59392
  s_nop 0
  buffer_load_dwordx4 v4, s[44:47], s31 offen lds
  s_add_u32 m0, s49, 59456
  s_nop 0
  buffer_load_dwordx4 v4, s[44:47], s31 offen offset:1792 lds
  s_add_u32 s31, s50, 189952
  s_add_u32 m0, s49, 63104
  s_nop 0
  buffer_load_dwordx4 v4, s[44:47], s31 offen lds
  s_add_u32 m0, s49, 63168
  s_nop 0
  buffer_load_dwordx4 v4, s[44:47], s31 offen offset:1792 lds
  s_add_u32 s31, s50, 193536
  s_add_u32 m0, s49, 66816
  s_nop 0
  buffer_load_dwordx4 v4, s[44:47], s31 offen lds
  s_add_u32 m0, s49, 66880
  s_nop 0
  buffer_load_dwordx4 v4, s[44:47], s31 offen offset:1792 lds
  s_add_u32 s31, s50, 197120
  s_add_u32 m0, s49, 70528
  s_nop 0
  buffer_load_dwordx4 v4, s[44:47], s31 offen lds
  s_add_u32 m0, s49, 70592
  s_nop 0
  buffer_load_dwordx4 v4, s[44:47], s31 offen offset:1792 lds
  s_waitcnt vmcnt(16)
  s_barrier
  s_add_u32 s31, s50, 200704
  s_add_u32 m0, s49, 121344
  s_nop 0
  buffer_load_dwordx4 v4, s[44:47], s31 offen lds
  s_add_u32 m0, s49, 121408
  s_nop 0
  buffer_load_dwordx4 v4, s[44:47], s31 offen offset:1792 lds
  s_add_u32 s31, s50, 204288
  s_add_u32 m0, s49, 125056
  s_nop 0
  buffer_load_dwordx4 v4, s[44:47], s31 offen lds
  s_add_u32 m0, s49, 125120
  s_nop 0
  buffer_load_dwordx4 v4, s[44:47], s31 offen offset:1792 lds
  s_add_u32 s31, s50, 207872
  s_add_u32 m0, s49, 128768
  s_nop 0
  buffer_load_dwordx4 v4, s[44:47], s31 offen lds
  s_add_u32 m0, s49, 128832
  s_nop 0
  buffer_load_dwordx4 v4, s[44:47], s31 offen offset:1792 lds
  s_add_u32 s31, s50, 211456
  s_add_u32 m0, s49, 132480
  s_nop 0
  buffer_load_dwordx4 v4, s[44:47], s31 offen lds
  s_add_u32 m0, s49, 132544
  s_nop 0
  buffer_load_dwordx4 v4, s[44:47], s31 offen offset:1792 lds
  s_add_u32 s31, s50, 215040
  s_add_u32 m0, s49, 0
  s_nop 0
  buffer_load_dwordx4 v4, s[44:47], s31 offen lds
  s_add_u32 m0, s49, 64
  s_nop 0
  buffer_load_dwordx4 v4, s[44:47], s31 offen offset:1792 lds
  s_add_u32 s31, s50, 218624
  s_add_u32 m0, s49, 3712
  s_nop 0
  buffer_load_dwordx4 v4, s[44:47], s31 offen lds
  s_add_u32 m0, s49, 3776
  s_nop 0
  buffer_load_dwordx4 v4, s[44:47], s31 offen offset:1792 lds
  s_add_u32 s31, s50, 222208
  s_add_u32 m0, s49, 7424
  s_nop 0
  buffer_load_dwordx4 v4, s[44:47], s31 offen lds
  s_add_u32 m0, s49, 7488
  s_nop 0
  buffer_load_dwordx4 v4, s[44:47], s31 offen offset:1792 lds
  s_add_u32 s31, s50, 225792
  s_add_u32 m0, s49, 11136
  s_nop 0
  buffer_load_dwordx4 v4, s[44:47], s31 offen lds
  s_add_u32 m0, s49, 11200
  s_nop 0
  buffer_load_dwordx4 v4, s[44:47], s31 offen offset:1792 lds
  s_waitcnt vmcnt(16)
  s_barrier
  s_waitcnt vmcnt(0)
  s_barrier
  s_barrier
L_end:
  s_endpgm
.section .rodata,"a"
.p2align 6
.amdhsa_kernel concat_heads__gqa_block_cached__gqa_block_cached__near_ridge_kernel
  .amdhsa_next_free_vgpr 168
  .amdhsa_next_free_sgpr 100
  .amdhsa_accum_offset 168
  .amdhsa_group_segment_fixed_size 0
  .amdhsa_kernarg_size 104
  .amdhsa_user_sgpr_count 2
  .amdhsa_user_sgpr_kernarg_segment_ptr 1
  .amdhsa_system_sgpr_workgroup_id_x 1
.end_amdhsa_kernel
```
